```python
import torch

def _softmax(x, axis=-1):
    return torch.softmax(x, dim=axis)

def _gelu(x):
    return torch.nn.functional.gelu(x, approximate='tanh')

def _silu(x):
    return torch.nn.functional.silu(x)

def _sigmoid(x):
    return torch.sigmoid(x)

def _layernorm(x, axis=-1, eps=1e-05):
    m = x.mean(dim=axis, keepdim=True)
    v = x.var(dim=axis, keepdim=True, unbiased=False)
    return (x - m) / torch.sqrt(v + eps)

def _scatter_add(tgt, idx, src, axis=0):
    return tgt.clone().index_add_(axis, idx, src)

def _segment_sum(src, seg, n):
    out = torch.zeros((n,) + src.shape[1:], dtype=src.dtype)
    return out.index_add_(0, seg, src)

def _pad(x, pw):
    flat = tuple((v for pair in reversed(pw) for v in pair))
    return torch.nn.functional.pad(x, flat)
kernel_name = 'interleave_layers__ssm_conv_h3__mixer_gmlp__prompt'

def setup_inputs():

    _w = lambda a: (lambda t: t.to(torch.bfloat16) if t.is_floating_point() else t)(torch.as_tensor(a))

    def _A_setup():
        B, S, D = (1, 2048, 640)
        ks = 4
        return {'q': _w((lambda *s: torch.randn(*s, dtype=torch.bfloat16) * 0.05)(B, S, D)), 'k': _w((lambda *s: torch.randn(*s, dtype=torch.bfloat16) * 1.6)(B, S, D)), 'v': _w((lambda *s: torch.randn(*s, dtype=torch.bfloat16) * 1.6)(B, S, D)), 'shift_k': _w((lambda *s: torch.randn(*s, dtype=torch.bfloat16) * 1.6)(D, ks) * 0.5), 'ssm_k': _w((lambda *s: torch.randn(*s, dtype=torch.bfloat16) * 1.6)(D, S) * (1.0 / S ** 0.5)), 'ssm_D': _w((lambda *s: torch.randn(*s, dtype=torch.bfloat16) * 1.6)(D))}
    _A_in = _A_setup()

    def _B_setup():
        B, S, D, F = (1, 2048, 640, 1728)
        Fh = F // 2
        return {'x': _w((lambda *s: torch.randn(*s, dtype=torch.bfloat16) * 0.05)(B, S, D)), 'w_in': _w((lambda *s: torch.randn(*s, dtype=torch.bfloat16) * 1.6)(D, 2 * Fh)), 'w_sp': _w(0.01 * (lambda *s: torch.randn(*s, dtype=torch.bfloat16) * 1.6)(S, S)), 'b_sp': _w(1.0 + 0.01 * (lambda *s: torch.randn(*s, dtype=torch.bfloat16) * 0.2)(S)), 'w_out': _w((lambda *s: torch.randn(*s, dtype=torch.bfloat16) * 0.2)(Fh, D))}
    _B_in = _B_setup()
    return {'A_q': _A_in['q'], 'A_k': _A_in['k'], 'A_v': _A_in['v'], 'A_shift_k': _A_in['shift_k'], 'A_ssm_k': _A_in['ssm_k'], 'A_ssm_D': _A_in['ssm_D'], 'B_x': _B_in['x'], 'B_w_in': _B_in['w_in'], 'B_w_sp': _B_in['w_sp'], 'B_b_sp': _B_in['b_sp'], 'B_w_out': _B_in['w_out']}

def reference(A_q, A_k, A_v, A_shift_k, A_ssm_k, A_ssm_D, B_x, B_w_in, B_w_sp, B_b_sp, B_w_out):

    def _A_ref(q, k, v, shift_k, ssm_k, ssm_D):
        B, S, D = q.shape
        ks = shift_k.shape[-1]
        k_pad = _pad(k, ((0, 0), (ks - 1, 0), (0, 0)))
        k_shift = torch.zeros_like(k)
        for t in range(ks):
            k_shift = k_shift + k_pad[:, t:t + S, :] * shift_k[:, ks - 1 - t][None, None, :]
        kv = k_shift * v
        L = 2 * S
        kv_pad = _pad(kv, ((0, 0), (0, S), (0, 0)))
        kf_pad = _pad(ssm_k, ((0, 0), (0, S)))
        kv_f = (lambda x, axes=(-2, -1): torch.fft.rfft2(x.float(), dim=axes))(kv_pad[:, None, :, :], axes=(1, 2))
        kf_f = (lambda x, axes=(-2, -1): torch.fft.rfft2(x.float(), dim=axes))(kf_pad[:, None, :], axes=(1, 2))
        kf_f = (lambda x, *d: x.permute(*d))(kf_f, 1, 2, 0)
        y_f = kv_f * kf_f[None, :, :, :]
        y = (lambda x, s, axes=(-2, -1): torch.fft.irfft2(x, s=s, dim=axes).to(torch.bfloat16))(y_f, (1, L), axes=(1, 2))[:, 0, :S, :]
        y = y + kv * ssm_D[None, None, :]
        return q * y

    def _B_ref(x, w_in, w_sp, b_sp, w_out):
        B, S, D = x.shape
        F = w_in.shape[-1]
        Fh = F // 2
        z = _gelu(torch.einsum('bsd,df->bsf', x, w_in))
        z1 = z[..., :Fh].clone()
        z2 = _layernorm(z[..., Fh:], axis=-1)
        g = torch.einsum('ts,bsf->btf', w_sp, z2) + b_sp[None, :, None]
        return torch.einsum('bsf,fd->bsd', z1 * g, w_out)
    x = A_q
    x = x + _A_ref(_layernorm(x, axis=-1), A_k, A_v, A_shift_k, A_ssm_k, A_ssm_D)
    x = x + _B_ref(_layernorm(x, axis=-1), B_w_in, B_w_sp, B_b_sp, B_w_out)
    x = x + _A_ref(_layernorm(x, axis=-1), A_k, A_v, A_shift_k, A_ssm_k, A_ssm_D)
    x = x + _B_ref(_layernorm(x, axis=-1), B_w_in, B_w_sp, B_b_sp, B_w_out)
    return x
```

```asm
; @launch kernel=prepa_kernel grid=(256,1,1) block=(320,1,1) lds=0
; @launch kernel=conv_kernel grid=(256,1,1) block=(512,1,1) lds=163840
; @launch kernel=e1_kernel grid=(128,1,1) block=(1024,1,1) lds=23040
; @launch kernel=g1_kernel grid=(256,1,1) block=(512,1,1) lds=153600
; @launch kernel=ln2_kernel grid=(128,1,1) block=(1024,1,1) lds=256
; @launch kernel=g2_kernel grid=(256,1,1) block=(512,1,1) lds=135168
; @launch kernel=g3a_kernel grid=(256,1,1) block=(512,1,1) lds=129024
; @launch kernel=e2_kernel grid=(128,1,1) block=(1024,1,1) lds=23040
; @launch kernel=g1_kernel grid=(256,1,1) block=(512,1,1) lds=153600
; @launch kernel=ln2_kernel grid=(128,1,1) block=(1024,1,1) lds=256
; @launch kernel=g2_kernel grid=(256,1,1) block=(512,1,1) lds=135168
; @launch kernel=g3b_kernel grid=(256,1,1) block=(512,1,1) lds=129024
.amdgcn_target "amdgcn-amd-amdhsa--gfx950"
.text
.p2align 8
.type prepa_kernel,@function
prepa_kernel:
    s_cmp_ge_u32 s2, 256
    s_cbranch_scc1 Lend_1
    s_cmp_ge_u32 s2, 128
    s_cbranch_scc1 Lwarm_2
    s_load_dwordx2 s[4:5], s[0:1], 104
    s_load_dwordx2 s[6:7], s[0:1], 8
    s_load_dwordx2 s[8:9], s[0:1], 16
    s_load_dwordx2 s[10:11], s[0:1], 24
    s_waitcnt lgkmcnt(0)
    s_mov_b32 s16, s6
    s_mov_b32 s17, s7
    s_mov_b32 s18, 0x280000
    s_mov_b32 s19, 0x00020000
    s_mov_b32 s20, s8
    s_mov_b32 s21, s9
    s_mov_b32 s22, 0x280000
    s_mov_b32 s23, 0x00020000
    s_mov_b32 s24, s10
    s_mov_b32 s25, s11
    s_mov_b32 s26, 0x1400
    s_mov_b32 s27, 0x00020000
    s_add_u32 s28, s4, 0x1d34000
    s_addc_u32 s29, s5, 0
    s_mov_b32 s30, 0x320000
    s_mov_b32 s31, 0x00020000
    s_mul_i32 s3, s2, 20480
    v_lshlrev_b32 v1, 2, v0
    v_add_u32 v1, s3, v1
    v_subrev_u32 v2, 3840, v1
    v_lshlrev_b32 v3, 4, v0
    buffer_load_dwordx4 v[4:7], v3, s[24:27], 0 offen
    buffer_load_dword v16, v2, s[16:19], 0 offen offset:0
    buffer_load_dword v17, v2, s[16:19], 0 offen offset:1280
    buffer_load_dword v18, v2, s[16:19], 0 offen offset:2560
    v_add_u32 v2, 3840, v2
    buffer_load_dword v19, v2, s[16:19], 0 offen offset:0
    buffer_load_dword v20, v2, s[16:19], 0 offen offset:1280
    buffer_load_dword v21, v2, s[16:19], 0 offen offset:2560
    v_add_u32 v2, 3840, v2
    buffer_load_dword v22, v2, s[16:19], 0 offen offset:0
    buffer_load_dword v23, v2, s[16:19], 0 offen offset:1280
    buffer_load_dword v24, v2, s[16:19], 0 offen offset:2560
    v_add_u32 v2, 3840, v2
    buffer_load_dword v25, v2, s[16:19], 0 offen offset:0
    buffer_load_dword v26, v2, s[16:19], 0 offen offset:1280
    buffer_load_dword v27, v2, s[16:19], 0 offen offset:2560
    v_add_u32 v2, 3840, v2
    buffer_load_dword v28, v2, s[16:19], 0 offen offset:0
    buffer_load_dword v29, v2, s[16:19], 0 offen offset:1280
    buffer_load_dword v30, v2, s[16:19], 0 offen offset:2560
    v_add_u32 v2, 3840, v2
    buffer_load_dword v31, v2, s[16:19], 0 offen offset:0
    buffer_load_dword v32, v2, s[16:19], 0 offen offset:1280
    buffer_load_dword v33, v2, s[16:19], 0 offen offset:2560
    v_add_u32 v2, 3840, v2
    buffer_load_dword v34, v2, s[16:19], 0 offen offset:0
    buffer_load_dword v35, v1, s[20:23], 0 offen offset:0
    buffer_load_dword v36, v1, s[20:23], 0 offen offset:1280
    buffer_load_dword v37, v1, s[20:23], 0 offen offset:2560
    v_add_u32 v1, 3840, v1
    buffer_load_dword v38, v1, s[20:23], 0 offen offset:0
    buffer_load_dword v39, v1, s[20:23], 0 offen offset:1280
    buffer_load_dword v40, v1, s[20:23], 0 offen offset:2560
    v_add_u32 v1, 3840, v1
    buffer_load_dword v41, v1, s[20:23], 0 offen offset:0
    buffer_load_dword v42, v1, s[20:23], 0 offen offset:1280
    buffer_load_dword v43, v1, s[20:23], 0 offen offset:2560
    v_add_u32 v1, 3840, v1
    buffer_load_dword v44, v1, s[20:23], 0 offen offset:0
    buffer_load_dword v45, v1, s[20:23], 0 offen offset:1280
    buffer_load_dword v46, v1, s[20:23], 0 offen offset:2560
    v_add_u32 v1, 3840, v1
    buffer_load_dword v47, v1, s[20:23], 0 offen offset:0
    buffer_load_dword v48, v1, s[20:23], 0 offen offset:1280
    buffer_load_dword v49, v1, s[20:23], 0 offen offset:2560
    v_add_u32 v1, 3840, v1
    buffer_load_dword v50, v1, s[20:23], 0 offen offset:0
    s_waitcnt vmcnt(0)
    v_lshlrev_b32 v60, 16, v4
    v_and_b32 v61, 0xffff0000, v4
    v_lshlrev_b32 v62, 16, v5
    v_and_b32 v63, 0xffff0000, v5
    v_lshlrev_b32 v64, 16, v6
    v_and_b32 v65, 0xffff0000, v6
    v_lshlrev_b32 v66, 16, v7
    v_and_b32 v67, 0xffff0000, v7
    v_lshlrev_b32 v70, 16, v16
    v_and_b32 v89, 0xffff0000, v16
    v_lshlrev_b32 v71, 16, v17
    v_and_b32 v90, 0xffff0000, v17
    v_lshlrev_b32 v72, 16, v18
    v_and_b32 v91, 0xffff0000, v18
    v_lshlrev_b32 v73, 16, v19
    v_and_b32 v92, 0xffff0000, v19
    v_lshlrev_b32 v74, 16, v20
    v_and_b32 v93, 0xffff0000, v20
    v_lshlrev_b32 v75, 16, v21
    v_and_b32 v94, 0xffff0000, v21
    v_lshlrev_b32 v76, 16, v22
    v_and_b32 v95, 0xffff0000, v22
    v_lshlrev_b32 v77, 16, v23
    v_and_b32 v96, 0xffff0000, v23
    v_lshlrev_b32 v78, 16, v24
    v_and_b32 v97, 0xffff0000, v24
    v_lshlrev_b32 v79, 16, v25
    v_and_b32 v98, 0xffff0000, v25
    v_lshlrev_b32 v80, 16, v26
    v_and_b32 v99, 0xffff0000, v26
    v_lshlrev_b32 v81, 16, v27
    v_and_b32 v100, 0xffff0000, v27
    v_lshlrev_b32 v82, 16, v28
    v_and_b32 v101, 0xffff0000, v28
    v_lshlrev_b32 v83, 16, v29
    v_and_b32 v102, 0xffff0000, v29
    v_lshlrev_b32 v84, 16, v30
    v_and_b32 v103, 0xffff0000, v30
    v_lshlrev_b32 v85, 16, v31
    v_and_b32 v104, 0xffff0000, v31
    v_lshlrev_b32 v86, 16, v32
    v_and_b32 v105, 0xffff0000, v32
    v_lshlrev_b32 v87, 16, v33
    v_and_b32 v106, 0xffff0000, v33
    v_lshlrev_b32 v88, 16, v34
    v_and_b32 v107, 0xffff0000, v34
    v_mul_f32 v8, v63, v70
    v_mul_f32 v9, v67, v89
    v_cvt_pk_bf16_f32 v10, v8, v9
    v_lshlrev_b32 v8, 16, v10
    v_and_b32 v9, 0xffff0000, v10
    v_mov_b32 v108, v8
    v_mov_b32 v124, v9
    v_mul_f32 v8, v62, v71
    v_mul_f32 v9, v66, v90
    v_cvt_pk_bf16_f32 v10, v8, v9
    v_lshlrev_b32 v8, 16, v10
    v_and_b32 v9, 0xffff0000, v10
    v_add_f32 v108, v108, v8
    v_add_f32 v124, v124, v9
    v_cvt_pk_bf16_f32 v10, v108, v124
    v_lshlrev_b32 v108, 16, v10
    v_and_b32 v124, 0xffff0000, v10
    v_mul_f32 v8, v61, v72
    v_mul_f32 v9, v65, v91
    v_cvt_pk_bf16_f32 v10, v8, v9
    v_lshlrev_b32 v8, 16, v10
    v_and_b32 v9, 0xffff0000, v10
    v_add_f32 v108, v108, v8
    v_add_f32 v124, v124, v9
    v_cvt_pk_bf16_f32 v10, v108, v124
    v_lshlrev_b32 v108, 16, v10
    v_and_b32 v124, 0xffff0000, v10
    v_mul_f32 v8, v60, v73
    v_mul_f32 v9, v64, v92
    v_cvt_pk_bf16_f32 v10, v8, v9
    v_lshlrev_b32 v8, 16, v10
    v_and_b32 v9, 0xffff0000, v10
    v_add_f32 v108, v108, v8
    v_add_f32 v124, v124, v9
    v_cvt_pk_bf16_f32 v10, v108, v124
    v_lshlrev_b32 v108, 16, v10
    v_and_b32 v124, 0xffff0000, v10
    v_lshlrev_b32 v8, 16, v35
    v_and_b32 v9, 0xffff0000, v35
    v_mul_f32 v108, v108, v8
    v_mul_f32 v124, v124, v9
    v_mul_f32 v8, v63, v71
    v_mul_f32 v9, v67, v90
    v_cvt_pk_bf16_f32 v10, v8, v9
    v_lshlrev_b32 v8, 16, v10
    v_and_b32 v9, 0xffff0000, v10
    v_mov_b32 v109, v8
    v_mov_b32 v125, v9
    v_mul_f32 v8, v62, v72
    v_mul_f32 v9, v66, v91
    v_cvt_pk_bf16_f32 v10, v8, v9
    v_lshlrev_b32 v8, 16, v10
    v_and_b32 v9, 0xffff0000, v10
    v_add_f32 v109, v109, v8
    v_add_f32 v125, v125, v9
    v_cvt_pk_bf16_f32 v10, v109, v125
    v_lshlrev_b32 v109, 16, v10
    v_and_b32 v125, 0xffff0000, v10
    v_mul_f32 v8, v61, v73
    v_mul_f32 v9, v65, v92
    v_cvt_pk_bf16_f32 v10, v8, v9
    v_lshlrev_b32 v8, 16, v10
    v_and_b32 v9, 0xffff0000, v10
    v_add_f32 v109, v109, v8
    v_add_f32 v125, v125, v9
    v_cvt_pk_bf16_f32 v10, v109, v125
    v_lshlrev_b32 v109, 16, v10
    v_and_b32 v125, 0xffff0000, v10
    v_mul_f32 v8, v60, v74
    v_mul_f32 v9, v64, v93
    v_cvt_pk_bf16_f32 v10, v8, v9
    v_lshlrev_b32 v8, 16, v10
    v_and_b32 v9, 0xffff0000, v10
    v_add_f32 v109, v109, v8
    v_add_f32 v125, v125, v9
    v_cvt_pk_bf16_f32 v10, v109, v125
    v_lshlrev_b32 v109, 16, v10
    v_and_b32 v125, 0xffff0000, v10
    v_lshlrev_b32 v8, 16, v36
    v_and_b32 v9, 0xffff0000, v36
    v_mul_f32 v109, v109, v8
    v_mul_f32 v125, v125, v9
    v_mul_f32 v8, v63, v72
    v_mul_f32 v9, v67, v91
    v_cvt_pk_bf16_f32 v10, v8, v9
    v_lshlrev_b32 v8, 16, v10
    v_and_b32 v9, 0xffff0000, v10
    v_mov_b32 v110, v8
    v_mov_b32 v126, v9
    v_mul_f32 v8, v62, v73
    v_mul_f32 v9, v66, v92
    v_cvt_pk_bf16_f32 v10, v8, v9
    v_lshlrev_b32 v8, 16, v10
    v_and_b32 v9, 0xffff0000, v10
    v_add_f32 v110, v110, v8
    v_add_f32 v126, v126, v9
    v_cvt_pk_bf16_f32 v10, v110, v126
    v_lshlrev_b32 v110, 16, v10
    v_and_b32 v126, 0xffff0000, v10
    v_mul_f32 v8, v61, v74
    v_mul_f32 v9, v65, v93
    v_cvt_pk_bf16_f32 v10, v8, v9
    v_lshlrev_b32 v8, 16, v10
    v_and_b32 v9, 0xffff0000, v10
    v_add_f32 v110, v110, v8
    v_add_f32 v126, v126, v9
    v_cvt_pk_bf16_f32 v10, v110, v126
    v_lshlrev_b32 v110, 16, v10
    v_and_b32 v126, 0xffff0000, v10
    v_mul_f32 v8, v60, v75
    v_mul_f32 v9, v64, v94
    v_cvt_pk_bf16_f32 v10, v8, v9
    v_lshlrev_b32 v8, 16, v10
    v_and_b32 v9, 0xffff0000, v10
    v_add_f32 v110, v110, v8
    v_add_f32 v126, v126, v9
    v_cvt_pk_bf16_f32 v10, v110, v126
    v_lshlrev_b32 v110, 16, v10
    v_and_b32 v126, 0xffff0000, v10
    v_lshlrev_b32 v8, 16, v37
    v_and_b32 v9, 0xffff0000, v37
    v_mul_f32 v110, v110, v8
    v_mul_f32 v126, v126, v9
    v_mul_f32 v8, v63, v73
    v_mul_f32 v9, v67, v92
    v_cvt_pk_bf16_f32 v10, v8, v9
    v_lshlrev_b32 v8, 16, v10
    v_and_b32 v9, 0xffff0000, v10
    v_mov_b32 v111, v8
    v_mov_b32 v127, v9
    v_mul_f32 v8, v62, v74
    v_mul_f32 v9, v66, v93
    v_cvt_pk_bf16_f32 v10, v8, v9
    v_lshlrev_b32 v8, 16, v10
    v_and_b32 v9, 0xffff0000, v10
    v_add_f32 v111, v111, v8
    v_add_f32 v127, v127, v9
    v_cvt_pk_bf16_f32 v10, v111, v127
    v_lshlrev_b32 v111, 16, v10
    v_and_b32 v127, 0xffff0000, v10
    v_mul_f32 v8, v61, v75
    v_mul_f32 v9, v65, v94
    v_cvt_pk_bf16_f32 v10, v8, v9
    v_lshlrev_b32 v8, 16, v10
    v_and_b32 v9, 0xffff0000, v10
    v_add_f32 v111, v111, v8
    v_add_f32 v127, v127, v9
    v_cvt_pk_bf16_f32 v10, v111, v127
    v_lshlrev_b32 v111, 16, v10
    v_and_b32 v127, 0xffff0000, v10
    v_mul_f32 v8, v60, v76
    v_mul_f32 v9, v64, v95
    v_cvt_pk_bf16_f32 v10, v8, v9
    v_lshlrev_b32 v8, 16, v10
    v_and_b32 v9, 0xffff0000, v10
    v_add_f32 v111, v111, v8
    v_add_f32 v127, v127, v9
    v_cvt_pk_bf16_f32 v10, v111, v127
    v_lshlrev_b32 v111, 16, v10
    v_and_b32 v127, 0xffff0000, v10
    v_lshlrev_b32 v8, 16, v38
    v_and_b32 v9, 0xffff0000, v38
    v_mul_f32 v111, v111, v8
    v_mul_f32 v127, v127, v9
    v_mul_f32 v8, v63, v74
    v_mul_f32 v9, v67, v93
    v_cvt_pk_bf16_f32 v10, v8, v9
    v_lshlrev_b32 v8, 16, v10
    v_and_b32 v9, 0xffff0000, v10
    v_mov_b32 v112, v8
    v_mov_b32 v128, v9
    v_mul_f32 v8, v62, v75
    v_mul_f32 v9, v66, v94
    v_cvt_pk_bf16_f32 v10, v8, v9
    v_lshlrev_b32 v8, 16, v10
    v_and_b32 v9, 0xffff0000, v10
    v_add_f32 v112, v112, v8
    v_add_f32 v128, v128, v9
    v_cvt_pk_bf16_f32 v10, v112, v128
    v_lshlrev_b32 v112, 16, v10
    v_and_b32 v128, 0xffff0000, v10
    v_mul_f32 v8, v61, v76
    v_mul_f32 v9, v65, v95
    v_cvt_pk_bf16_f32 v10, v8, v9
    v_lshlrev_b32 v8, 16, v10
    v_and_b32 v9, 0xffff0000, v10
    v_add_f32 v112, v112, v8
    v_add_f32 v128, v128, v9
    v_cvt_pk_bf16_f32 v10, v112, v128
    v_lshlrev_b32 v112, 16, v10
    v_and_b32 v128, 0xffff0000, v10
    v_mul_f32 v8, v60, v77
    v_mul_f32 v9, v64, v96
    v_cvt_pk_bf16_f32 v10, v8, v9
    v_lshlrev_b32 v8, 16, v10
    v_and_b32 v9, 0xffff0000, v10
    v_add_f32 v112, v112, v8
    v_add_f32 v128, v128, v9
    v_cvt_pk_bf16_f32 v10, v112, v128
    v_lshlrev_b32 v112, 16, v10
    v_and_b32 v128, 0xffff0000, v10
    v_lshlrev_b32 v8, 16, v39
    v_and_b32 v9, 0xffff0000, v39
    v_mul_f32 v112, v112, v8
    v_mul_f32 v128, v128, v9
    v_mul_f32 v8, v63, v75
    v_mul_f32 v9, v67, v94
    v_cvt_pk_bf16_f32 v10, v8, v9
    v_lshlrev_b32 v8, 16, v10
    v_and_b32 v9, 0xffff0000, v10
    v_mov_b32 v113, v8
    v_mov_b32 v129, v9
    v_mul_f32 v8, v62, v76
    v_mul_f32 v9, v66, v95
    v_cvt_pk_bf16_f32 v10, v8, v9
    v_lshlrev_b32 v8, 16, v10
    v_and_b32 v9, 0xffff0000, v10
    v_add_f32 v113, v113, v8
    v_add_f32 v129, v129, v9
    v_cvt_pk_bf16_f32 v10, v113, v129
    v_lshlrev_b32 v113, 16, v10
    v_and_b32 v129, 0xffff0000, v10
    v_mul_f32 v8, v61, v77
    v_mul_f32 v9, v65, v96
    v_cvt_pk_bf16_f32 v10, v8, v9
    v_lshlrev_b32 v8, 16, v10
    v_and_b32 v9, 0xffff0000, v10
    v_add_f32 v113, v113, v8
    v_add_f32 v129, v129, v9
    v_cvt_pk_bf16_f32 v10, v113, v129
    v_lshlrev_b32 v113, 16, v10
    v_and_b32 v129, 0xffff0000, v10
    v_mul_f32 v8, v60, v78
    v_mul_f32 v9, v64, v97
    v_cvt_pk_bf16_f32 v10, v8, v9
    v_lshlrev_b32 v8, 16, v10
    v_and_b32 v9, 0xffff0000, v10
    v_add_f32 v113, v113, v8
    v_add_f32 v129, v129, v9
    v_cvt_pk_bf16_f32 v10, v113, v129
    v_lshlrev_b32 v113, 16, v10
    v_and_b32 v129, 0xffff0000, v10
    v_lshlrev_b32 v8, 16, v40
    v_and_b32 v9, 0xffff0000, v40
    v_mul_f32 v113, v113, v8
    v_mul_f32 v129, v129, v9
    v_mul_f32 v8, v63, v76
    v_mul_f32 v9, v67, v95
    v_cvt_pk_bf16_f32 v10, v8, v9
    v_lshlrev_b32 v8, 16, v10
    v_and_b32 v9, 0xffff0000, v10
    v_mov_b32 v114, v8
    v_mov_b32 v130, v9
    v_mul_f32 v8, v62, v77
    v_mul_f32 v9, v66, v96
    v_cvt_pk_bf16_f32 v10, v8, v9
    v_lshlrev_b32 v8, 16, v10
    v_and_b32 v9, 0xffff0000, v10
    v_add_f32 v114, v114, v8
    v_add_f32 v130, v130, v9
    v_cvt_pk_bf16_f32 v10, v114, v130
    v_lshlrev_b32 v114, 16, v10
    v_and_b32 v130, 0xffff0000, v10
    v_mul_f32 v8, v61, v78
    v_mul_f32 v9, v65, v97
    v_cvt_pk_bf16_f32 v10, v8, v9
    v_lshlrev_b32 v8, 16, v10
    v_and_b32 v9, 0xffff0000, v10
    v_add_f32 v114, v114, v8
    v_add_f32 v130, v130, v9
    v_cvt_pk_bf16_f32 v10, v114, v130
    v_lshlrev_b32 v114, 16, v10
    v_and_b32 v130, 0xffff0000, v10
    v_mul_f32 v8, v60, v79
    v_mul_f32 v9, v64, v98
    v_cvt_pk_bf16_f32 v10, v8, v9
    v_lshlrev_b32 v8, 16, v10
    v_and_b32 v9, 0xffff0000, v10
    v_add_f32 v114, v114, v8
    v_add_f32 v130, v130, v9
    v_cvt_pk_bf16_f32 v10, v114, v130
    v_lshlrev_b32 v114, 16, v10
    v_and_b32 v130, 0xffff0000, v10
    v_lshlrev_b32 v8, 16, v41
    v_and_b32 v9, 0xffff0000, v41
    v_mul_f32 v114, v114, v8
    v_mul_f32 v130, v130, v9
    v_mul_f32 v8, v63, v77
    v_mul_f32 v9, v67, v96
    v_cvt_pk_bf16_f32 v10, v8, v9
    v_lshlrev_b32 v8, 16, v10
    v_and_b32 v9, 0xffff0000, v10
    v_mov_b32 v115, v8
    v_mov_b32 v131, v9
    v_mul_f32 v8, v62, v78
    v_mul_f32 v9, v66, v97
    v_cvt_pk_bf16_f32 v10, v8, v9
    v_lshlrev_b32 v8, 16, v10
    v_and_b32 v9, 0xffff0000, v10
    v_add_f32 v115, v115, v8
    v_add_f32 v131, v131, v9
    v_cvt_pk_bf16_f32 v10, v115, v131
    v_lshlrev_b32 v115, 16, v10
    v_and_b32 v131, 0xffff0000, v10
    v_mul_f32 v8, v61, v79
    v_mul_f32 v9, v65, v98
    v_cvt_pk_bf16_f32 v10, v8, v9
    v_lshlrev_b32 v8, 16, v10
    v_and_b32 v9, 0xffff0000, v10
    v_add_f32 v115, v115, v8
    v_add_f32 v131, v131, v9
    v_cvt_pk_bf16_f32 v10, v115, v131
    v_lshlrev_b32 v115, 16, v10
    v_and_b32 v131, 0xffff0000, v10
    v_mul_f32 v8, v60, v80
    v_mul_f32 v9, v64, v99
    v_cvt_pk_bf16_f32 v10, v8, v9
    v_lshlrev_b32 v8, 16, v10
    v_and_b32 v9, 0xffff0000, v10
    v_add_f32 v115, v115, v8
    v_add_f32 v131, v131, v9
    v_cvt_pk_bf16_f32 v10, v115, v131
    v_lshlrev_b32 v115, 16, v10
    v_and_b32 v131, 0xffff0000, v10
    v_lshlrev_b32 v8, 16, v42
    v_and_b32 v9, 0xffff0000, v42
    v_mul_f32 v115, v115, v8
    v_mul_f32 v131, v131, v9
    v_mul_f32 v8, v63, v78
    v_mul_f32 v9, v67, v97
    v_cvt_pk_bf16_f32 v10, v8, v9
    v_lshlrev_b32 v8, 16, v10
    v_and_b32 v9, 0xffff0000, v10
    v_mov_b32 v116, v8
    v_mov_b32 v132, v9
    v_mul_f32 v8, v62, v79
    v_mul_f32 v9, v66, v98
    v_cvt_pk_bf16_f32 v10, v8, v9
    v_lshlrev_b32 v8, 16, v10
    v_and_b32 v9, 0xffff0000, v10
    v_add_f32 v116, v116, v8
    v_add_f32 v132, v132, v9
    v_cvt_pk_bf16_f32 v10, v116, v132
    v_lshlrev_b32 v116, 16, v10
    v_and_b32 v132, 0xffff0000, v10
    v_mul_f32 v8, v61, v80
    v_mul_f32 v9, v65, v99
    v_cvt_pk_bf16_f32 v10, v8, v9
    v_lshlrev_b32 v8, 16, v10
    v_and_b32 v9, 0xffff0000, v10
    v_add_f32 v116, v116, v8
    v_add_f32 v132, v132, v9
    v_cvt_pk_bf16_f32 v10, v116, v132
    v_lshlrev_b32 v116, 16, v10
    v_and_b32 v132, 0xffff0000, v10
    v_mul_f32 v8, v60, v81
    v_mul_f32 v9, v64, v100
    v_cvt_pk_bf16_f32 v10, v8, v9
    v_lshlrev_b32 v8, 16, v10
    v_and_b32 v9, 0xffff0000, v10
    v_add_f32 v116, v116, v8
    v_add_f32 v132, v132, v9
    v_cvt_pk_bf16_f32 v10, v116, v132
    v_lshlrev_b32 v116, 16, v10
    v_and_b32 v132, 0xffff0000, v10
    v_lshlrev_b32 v8, 16, v43
    v_and_b32 v9, 0xffff0000, v43
    v_mul_f32 v116, v116, v8
    v_mul_f32 v132, v132, v9
    v_mul_f32 v8, v63, v79
    v_mul_f32 v9, v67, v98
    v_cvt_pk_bf16_f32 v10, v8, v9
    v_lshlrev_b32 v8, 16, v10
    v_and_b32 v9, 0xffff0000, v10
    v_mov_b32 v117, v8
    v_mov_b32 v133, v9
    v_mul_f32 v8, v62, v80
    v_mul_f32 v9, v66, v99
    v_cvt_pk_bf16_f32 v10, v8, v9
    v_lshlrev_b32 v8, 16, v10
    v_and_b32 v9, 0xffff0000, v10
    v_add_f32 v117, v117, v8
    v_add_f32 v133, v133, v9
    v_cvt_pk_bf16_f32 v10, v117, v133
    v_lshlrev_b32 v117, 16, v10
    v_and_b32 v133, 0xffff0000, v10
    v_mul_f32 v8, v61, v81
    v_mul_f32 v9, v65, v100
    v_cvt_pk_bf16_f32 v10, v8, v9
    v_lshlrev_b32 v8, 16, v10
    v_and_b32 v9, 0xffff0000, v10
    v_add_f32 v117, v117, v8
    v_add_f32 v133, v133, v9
    v_cvt_pk_bf16_f32 v10, v117, v133
    v_lshlrev_b32 v117, 16, v10
    v_and_b32 v133, 0xffff0000, v10
    v_mul_f32 v8, v60, v82
    v_mul_f32 v9, v64, v101
    v_cvt_pk_bf16_f32 v10, v8, v9
    v_lshlrev_b32 v8, 16, v10
    v_and_b32 v9, 0xffff0000, v10
    v_add_f32 v117, v117, v8
    v_add_f32 v133, v133, v9
    v_cvt_pk_bf16_f32 v10, v117, v133
    v_lshlrev_b32 v117, 16, v10
    v_and_b32 v133, 0xffff0000, v10
    v_lshlrev_b32 v8, 16, v44
    v_and_b32 v9, 0xffff0000, v44
    v_mul_f32 v117, v117, v8
    v_mul_f32 v133, v133, v9
    v_mul_f32 v8, v63, v80
    v_mul_f32 v9, v67, v99
    v_cvt_pk_bf16_f32 v10, v8, v9
    v_lshlrev_b32 v8, 16, v10
    v_and_b32 v9, 0xffff0000, v10
    v_mov_b32 v118, v8
    v_mov_b32 v134, v9
    v_mul_f32 v8, v62, v81
    v_mul_f32 v9, v66, v100
    v_cvt_pk_bf16_f32 v10, v8, v9
    v_lshlrev_b32 v8, 16, v10
    v_and_b32 v9, 0xffff0000, v10
    v_add_f32 v118, v118, v8
    v_add_f32 v134, v134, v9
    v_cvt_pk_bf16_f32 v10, v118, v134
    v_lshlrev_b32 v118, 16, v10
    v_and_b32 v134, 0xffff0000, v10
    v_mul_f32 v8, v61, v82
    v_mul_f32 v9, v65, v101
    v_cvt_pk_bf16_f32 v10, v8, v9
    v_lshlrev_b32 v8, 16, v10
    v_and_b32 v9, 0xffff0000, v10
    v_add_f32 v118, v118, v8
    v_add_f32 v134, v134, v9
    v_cvt_pk_bf16_f32 v10, v118, v134
    v_lshlrev_b32 v118, 16, v10
    v_and_b32 v134, 0xffff0000, v10
    v_mul_f32 v8, v60, v83
    v_mul_f32 v9, v64, v102
    v_cvt_pk_bf16_f32 v10, v8, v9
    v_lshlrev_b32 v8, 16, v10
    v_and_b32 v9, 0xffff0000, v10
    v_add_f32 v118, v118, v8
    v_add_f32 v134, v134, v9
    v_cvt_pk_bf16_f32 v10, v118, v134
    v_lshlrev_b32 v118, 16, v10
    v_and_b32 v134, 0xffff0000, v10
    v_lshlrev_b32 v8, 16, v45
    v_and_b32 v9, 0xffff0000, v45
    v_mul_f32 v118, v118, v8
    v_mul_f32 v134, v134, v9
    v_mul_f32 v8, v63, v81
    v_mul_f32 v9, v67, v100
    v_cvt_pk_bf16_f32 v10, v8, v9
    v_lshlrev_b32 v8, 16, v10
    v_and_b32 v9, 0xffff0000, v10
    v_mov_b32 v119, v8
    v_mov_b32 v135, v9
    v_mul_f32 v8, v62, v82
    v_mul_f32 v9, v66, v101
    v_cvt_pk_bf16_f32 v10, v8, v9
    v_lshlrev_b32 v8, 16, v10
    v_and_b32 v9, 0xffff0000, v10
    v_add_f32 v119, v119, v8
    v_add_f32 v135, v135, v9
    v_cvt_pk_bf16_f32 v10, v119, v135
    v_lshlrev_b32 v119, 16, v10
    v_and_b32 v135, 0xffff0000, v10
    v_mul_f32 v8, v61, v83
    v_mul_f32 v9, v65, v102
    v_cvt_pk_bf16_f32 v10, v8, v9
    v_lshlrev_b32 v8, 16, v10
    v_and_b32 v9, 0xffff0000, v10
    v_add_f32 v119, v119, v8
    v_add_f32 v135, v135, v9
    v_cvt_pk_bf16_f32 v10, v119, v135
    v_lshlrev_b32 v119, 16, v10
    v_and_b32 v135, 0xffff0000, v10
    v_mul_f32 v8, v60, v84
    v_mul_f32 v9, v64, v103
    v_cvt_pk_bf16_f32 v10, v8, v9
    v_lshlrev_b32 v8, 16, v10
    v_and_b32 v9, 0xffff0000, v10
    v_add_f32 v119, v119, v8
    v_add_f32 v135, v135, v9
    v_cvt_pk_bf16_f32 v10, v119, v135
    v_lshlrev_b32 v119, 16, v10
    v_and_b32 v135, 0xffff0000, v10
    v_lshlrev_b32 v8, 16, v46
    v_and_b32 v9, 0xffff0000, v46
    v_mul_f32 v119, v119, v8
    v_mul_f32 v135, v135, v9
    v_mul_f32 v8, v63, v82
    v_mul_f32 v9, v67, v101
    v_cvt_pk_bf16_f32 v10, v8, v9
    v_lshlrev_b32 v8, 16, v10
    v_and_b32 v9, 0xffff0000, v10
    v_mov_b32 v120, v8
    v_mov_b32 v136, v9
    v_mul_f32 v8, v62, v83
    v_mul_f32 v9, v66, v102
    v_cvt_pk_bf16_f32 v10, v8, v9
    v_lshlrev_b32 v8, 16, v10
    v_and_b32 v9, 0xffff0000, v10
    v_add_f32 v120, v120, v8
    v_add_f32 v136, v136, v9
    v_cvt_pk_bf16_f32 v10, v120, v136
    v_lshlrev_b32 v120, 16, v10
    v_and_b32 v136, 0xffff0000, v10
    v_mul_f32 v8, v61, v84
    v_mul_f32 v9, v65, v103
    v_cvt_pk_bf16_f32 v10, v8, v9
    v_lshlrev_b32 v8, 16, v10
    v_and_b32 v9, 0xffff0000, v10
    v_add_f32 v120, v120, v8
    v_add_f32 v136, v136, v9
    v_cvt_pk_bf16_f32 v10, v120, v136
    v_lshlrev_b32 v120, 16, v10
    v_and_b32 v136, 0xffff0000, v10
    v_mul_f32 v8, v60, v85
    v_mul_f32 v9, v64, v104
    v_cvt_pk_bf16_f32 v10, v8, v9
    v_lshlrev_b32 v8, 16, v10
    v_and_b32 v9, 0xffff0000, v10
    v_add_f32 v120, v120, v8
    v_add_f32 v136, v136, v9
    v_cvt_pk_bf16_f32 v10, v120, v136
    v_lshlrev_b32 v120, 16, v10
    v_and_b32 v136, 0xffff0000, v10
    v_lshlrev_b32 v8, 16, v47
    v_and_b32 v9, 0xffff0000, v47
    v_mul_f32 v120, v120, v8
    v_mul_f32 v136, v136, v9
    v_mul_f32 v8, v63, v83
    v_mul_f32 v9, v67, v102
    v_cvt_pk_bf16_f32 v10, v8, v9
    v_lshlrev_b32 v8, 16, v10
    v_and_b32 v9, 0xffff0000, v10
    v_mov_b32 v121, v8
    v_mov_b32 v137, v9
    v_mul_f32 v8, v62, v84
    v_mul_f32 v9, v66, v103
    v_cvt_pk_bf16_f32 v10, v8, v9
    v_lshlrev_b32 v8, 16, v10
    v_and_b32 v9, 0xffff0000, v10
    v_add_f32 v121, v121, v8
    v_add_f32 v137, v137, v9
    v_cvt_pk_bf16_f32 v10, v121, v137
    v_lshlrev_b32 v121, 16, v10
    v_and_b32 v137, 0xffff0000, v10
    v_mul_f32 v8, v61, v85
    v_mul_f32 v9, v65, v104
    v_cvt_pk_bf16_f32 v10, v8, v9
    v_lshlrev_b32 v8, 16, v10
    v_and_b32 v9, 0xffff0000, v10
    v_add_f32 v121, v121, v8
    v_add_f32 v137, v137, v9
    v_cvt_pk_bf16_f32 v10, v121, v137
    v_lshlrev_b32 v121, 16, v10
    v_and_b32 v137, 0xffff0000, v10
    v_mul_f32 v8, v60, v86
    v_mul_f32 v9, v64, v105
    v_cvt_pk_bf16_f32 v10, v8, v9
    v_lshlrev_b32 v8, 16, v10
    v_and_b32 v9, 0xffff0000, v10
    v_add_f32 v121, v121, v8
    v_add_f32 v137, v137, v9
    v_cvt_pk_bf16_f32 v10, v121, v137
    v_lshlrev_b32 v121, 16, v10
    v_and_b32 v137, 0xffff0000, v10
    v_lshlrev_b32 v8, 16, v48
    v_and_b32 v9, 0xffff0000, v48
    v_mul_f32 v121, v121, v8
    v_mul_f32 v137, v137, v9
    v_mul_f32 v8, v63, v84
    v_mul_f32 v9, v67, v103
    v_cvt_pk_bf16_f32 v10, v8, v9
    v_lshlrev_b32 v8, 16, v10
    v_and_b32 v9, 0xffff0000, v10
    v_mov_b32 v122, v8
    v_mov_b32 v138, v9
    v_mul_f32 v8, v62, v85
    v_mul_f32 v9, v66, v104
    v_cvt_pk_bf16_f32 v10, v8, v9
    v_lshlrev_b32 v8, 16, v10
    v_and_b32 v9, 0xffff0000, v10
    v_add_f32 v122, v122, v8
    v_add_f32 v138, v138, v9
    v_cvt_pk_bf16_f32 v10, v122, v138
    v_lshlrev_b32 v122, 16, v10
    v_and_b32 v138, 0xffff0000, v10
    v_mul_f32 v8, v61, v86
    v_mul_f32 v9, v65, v105
    v_cvt_pk_bf16_f32 v10, v8, v9
    v_lshlrev_b32 v8, 16, v10
    v_and_b32 v9, 0xffff0000, v10
    v_add_f32 v122, v122, v8
    v_add_f32 v138, v138, v9
    v_cvt_pk_bf16_f32 v10, v122, v138
    v_lshlrev_b32 v122, 16, v10
    v_and_b32 v138, 0xffff0000, v10
    v_mul_f32 v8, v60, v87
    v_mul_f32 v9, v64, v106
    v_cvt_pk_bf16_f32 v10, v8, v9
    v_lshlrev_b32 v8, 16, v10
    v_and_b32 v9, 0xffff0000, v10
    v_add_f32 v122, v122, v8
    v_add_f32 v138, v138, v9
    v_cvt_pk_bf16_f32 v10, v122, v138
    v_lshlrev_b32 v122, 16, v10
    v_and_b32 v138, 0xffff0000, v10
    v_lshlrev_b32 v8, 16, v49
    v_and_b32 v9, 0xffff0000, v49
    v_mul_f32 v122, v122, v8
    v_mul_f32 v138, v138, v9
    v_mul_f32 v8, v63, v85
    v_mul_f32 v9, v67, v104
    v_cvt_pk_bf16_f32 v10, v8, v9
    v_lshlrev_b32 v8, 16, v10
    v_and_b32 v9, 0xffff0000, v10
    v_mov_b32 v123, v8
    v_mov_b32 v139, v9
    v_mul_f32 v8, v62, v86
    v_mul_f32 v9, v66, v105
    v_cvt_pk_bf16_f32 v10, v8, v9
    v_lshlrev_b32 v8, 16, v10
    v_and_b32 v9, 0xffff0000, v10
    v_add_f32 v123, v123, v8
    v_add_f32 v139, v139, v9
    v_cvt_pk_bf16_f32 v10, v123, v139
    v_lshlrev_b32 v123, 16, v10
    v_and_b32 v139, 0xffff0000, v10
    v_mul_f32 v8, v61, v87
    v_mul_f32 v9, v65, v106
    v_cvt_pk_bf16_f32 v10, v8, v9
    v_lshlrev_b32 v8, 16, v10
    v_and_b32 v9, 0xffff0000, v10
    v_add_f32 v123, v123, v8
    v_add_f32 v139, v139, v9
    v_cvt_pk_bf16_f32 v10, v123, v139
    v_lshlrev_b32 v123, 16, v10
    v_and_b32 v139, 0xffff0000, v10
    v_mul_f32 v8, v60, v88
    v_mul_f32 v9, v64, v107
    v_cvt_pk_bf16_f32 v10, v8, v9
    v_lshlrev_b32 v8, 16, v10
    v_and_b32 v9, 0xffff0000, v10
    v_add_f32 v123, v123, v8
    v_add_f32 v139, v139, v9
    v_cvt_pk_bf16_f32 v10, v123, v139
    v_lshlrev_b32 v123, 16, v10
    v_and_b32 v139, 0xffff0000, v10
    v_lshlrev_b32 v8, 16, v50
    v_and_b32 v9, 0xffff0000, v50
    v_mul_f32 v123, v123, v8
    v_mul_f32 v139, v139, v9
    v_cvt_pk_bf16_f32 v16, v123, v122
    v_cvt_pk_bf16_f32 v17, v121, v120
    v_cvt_pk_bf16_f32 v18, v119, v118
    v_cvt_pk_bf16_f32 v19, v117, v116
    v_cvt_pk_bf16_f32 v20, v115, v114
    v_cvt_pk_bf16_f32 v21, v113, v112
    v_cvt_pk_bf16_f32 v22, v111, v110
    v_cvt_pk_bf16_f32 v23, v109, v108
    v_cvt_pk_bf16_f32 v24, v139, v138
    v_cvt_pk_bf16_f32 v25, v137, v136
    v_cvt_pk_bf16_f32 v26, v135, v134
    v_cvt_pk_bf16_f32 v27, v133, v132
    v_cvt_pk_bf16_f32 v28, v131, v130
    v_cvt_pk_bf16_f32 v29, v129, v128
    v_cvt_pk_bf16_f32 v30, v127, v126
    v_cvt_pk_bf16_f32 v31, v125, v124
    s_lshr_b32 s3, s2, 1
    s_mul_i32 s3, s3, 40960
    s_and_b32 s12, s2, 1
    s_xor_b32 s12, s12, 1
    s_lshl_b32 s12, s12, 5
    s_add_u32 s3, s3, s12
    v_lshlrev_b32 v3, 7, v0
    v_add_u32 v3, s3, v3
    buffer_store_dwordx4 v[16:19], v3, s[28:31], 0 offen offset:0
    buffer_store_dwordx4 v[20:23], v3, s[28:31], 0 offen offset:16
    buffer_store_dwordx4 v[24:27], v3, s[28:31], 0 offen offset:64
    buffer_store_dwordx4 v[28:31], v3, s[28:31], 0 offen offset:80
    s_branch Lend_1
Lwarm_2:
    s_load_dwordx2 s[4:5], s[0:1], 32
    s_load_dwordx2 s[6:7], s[0:1], 56
    s_load_dwordx2 s[8:9], s[0:1], 80
    s_load_dwordx2 s[10:11], s[0:1], 0
    s_waitcnt lgkmcnt(0)
    s_mov_b32 s16, s4
    s_mov_b32 s17, s5
    s_mov_b32 s18, 0x280000
    s_mov_b32 s19, 0x00020000
    s_mov_b32 s20, s6
    s_mov_b32 s21, s7
    s_mov_b32 s22, 0x21c000
    s_mov_b32 s23, 0x00020000
    s_mov_b32 s24, s8
    s_mov_b32 s25, s9
    s_mov_b32 s26, 0x10e000
    s_mov_b32 s27, 0x00020000
    s_mov_b32 s28, s10
    s_mov_b32 s29, s11
    s_mov_b32 s30, 0x280000
    s_mov_b32 s31, 0x00020000
    s_sub_u32 s3, s2, 128
    s_mul_i32 s3, s3, 25600
    v_lshlrev_b32 v1, 4, v0
    buffer_load_dwordx4 v[8:11], v1, s[16:19], s3 offen
    buffer_load_dwordx4 v[8:11], v1, s[20:23], s3 offen
    buffer_load_dwordx4 v[8:11], v1, s[24:27], s3 offen
    buffer_load_dwordx4 v[8:11], v1, s[28:31], s3 offen
    s_add_u32 s3, s3, 5120
    buffer_load_dwordx4 v[8:11], v1, s[16:19], s3 offen
    buffer_load_dwordx4 v[8:11], v1, s[20:23], s3 offen
    buffer_load_dwordx4 v[8:11], v1, s[24:27], s3 offen
    buffer_load_dwordx4 v[8:11], v1, s[28:31], s3 offen
    s_add_u32 s3, s3, 5120
    buffer_load_dwordx4 v[8:11], v1, s[16:19], s3 offen
    buffer_load_dwordx4 v[8:11], v1, s[20:23], s3 offen
    buffer_load_dwordx4 v[8:11], v1, s[24:27], s3 offen
    buffer_load_dwordx4 v[8:11], v1, s[28:31], s3 offen
    s_add_u32 s3, s3, 5120
    buffer_load_dwordx4 v[8:11], v1, s[16:19], s3 offen
    buffer_load_dwordx4 v[8:11], v1, s[20:23], s3 offen
    buffer_load_dwordx4 v[8:11], v1, s[24:27], s3 offen
    buffer_load_dwordx4 v[8:11], v1, s[28:31], s3 offen
    s_add_u32 s3, s3, 5120
    buffer_load_dwordx4 v[8:11], v1, s[16:19], s3 offen
    buffer_load_dwordx4 v[8:11], v1, s[20:23], s3 offen
    buffer_load_dwordx4 v[8:11], v1, s[24:27], s3 offen
    buffer_load_dwordx4 v[8:11], v1, s[28:31], s3 offen
    s_add_u32 s3, s3, 5120
Lend_1:
    s_endpgm
.p2align 8
.type conv_kernel,@function
conv_kernel:
    s_cmp_ge_u32 s2, 256
    s_cbranch_scc1 Lend_3
    s_load_dwordx2 s[4:5], s[0:1], 104
    s_cmp_ge_u32 s2, 160
    s_cbranch_scc1 Ltr_4
    s_load_dwordx2 s[12:13], s[0:1], 32
    s_load_dwordx2 s[14:15], s[0:1], 40
    s_waitcnt lgkmcnt(0)
    s_add_u32 s16, s4, 0x1d34000
    s_addc_u32 s17, s5, 0
    s_mov_b32 s18, 0x320000
    s_mov_b32 s19, 0x00020000
    s_lshl_b32 s3, s2, 3
    s_add_u32 s14, s14, s3
    s_addc_u32 s15, s15, 0
    s_load_dwordx2 s[44:45], s[14:15], 0
    s_mov_b32 s24, s12
    s_mov_b32 s25, s13
    s_mov_b32 s26, 0x280000
    s_mov_b32 s27, 0x00020000
    s_mov_b32 s28, s4
    s_mov_b32 s29, s5
    s_mov_b32 s30, 0x280000
    s_mov_b32 s31, 0x00020000
    v_lshrrev_b32 v1, 6, v0
    s_nop 0
    v_readfirstlane_b32 s46, v1
    v_and_b32 v2, 63, v0
    s_and_b32 s47, s46, 3
    s_lshr_b32 s48, s46, 2
    s_mul_i32 s49, s47, 40960
    s_lshl_b32 s3, s2, 2
    s_add_u32 s3, s3, s47
    s_lshl_b32 s50, s3, 6
    s_mul_i32 s51, s48, 3072
    s_add_u32 s51, s51, s49
    s_add_u32 s51, s51, 33280
    s_mul_i32 s52, s48, 192
    v_add_u32 v4, s52, v2
    v_mul_u32_u24 v5, 0xcccd, v4
    v_lshrrev_b32 v5, 18, v5
    v_mul_u32_u24 v6, 5, v5
    v_sub_u32 v6, v4, v6
    v_min_u32 v6, 3, v6
    v_sub_u32 v5, 63, v5
    v_mul_u32_u24 v5, 40960, v5
    v_lshl_add_u32 v90, v6, 4, v5
    v_add_u32 v4, s52, v2
    v_add_u32 v4, 64, v4
    v_mul_u32_u24 v5, 0xcccd, v4
    v_lshrrev_b32 v5, 18, v5
    v_mul_u32_u24 v6, 5, v5
    v_sub_u32 v6, v4, v6
    v_min_u32 v6, 3, v6
    v_sub_u32 v5, 63, v5
    v_mul_u32_u24 v5, 40960, v5
    v_lshl_add_u32 v91, v6, 4, v5
    v_add_u32 v4, s52, v2
    v_add_u32 v4, 128, v4
    v_mul_u32_u24 v5, 0xcccd, v4
    v_lshrrev_b32 v5, 18, v5
    v_mul_u32_u24 v6, 5, v5
    v_sub_u32 v6, v4, v6
    v_min_u32 v6, 3, v6
    v_sub_u32 v5, 63, v5
    v_mul_u32_u24 v5, 40960, v5
    v_lshl_add_u32 v92, v6, 4, v5
    s_add_u32 m0, s51, 0
    s_nop 0
    buffer_load_dwordx4 v90, s[16:19], s50 offen lds
    s_add_u32 m0, s51, 1024
    s_nop 0
    buffer_load_dwordx4 v91, s[16:19], s50 offen lds
    s_cmp_eq_u32 s48, 1
    s_cbranch_scc1 Lsk_5
    s_add_u32 m0, s51, 2048
    s_nop 0
    buffer_load_dwordx4 v92, s[16:19], s50 offen lds
Lsk_5:
    v_mov_b32 v84, 0
    v_mov_b32 v85, 0
    v_mov_b32 v86, 0
    v_mov_b32 v87, 0
    v_add_u32 v4, 0, v0
    v_mul_u32_u24 v5, 0xcccd, v4
    v_lshrrev_b32 v5, 23, v5
    v_mul_u32_u24 v6, 160, v5
    v_sub_u32 v6, v4, v6
    v_mul_u32_u24 v5, 40960, v5
    v_lshl_add_u32 v5, v6, 4, v5
    v_add_u32 v5, 38400, v5
    ds_write_b128 v5, v[84:87]
    v_cmp_gt_u32 vcc, 128, v0
    s_and_saveexec_b64 s[58:59], vcc
    v_add_u32 v4, 512, v0
    v_mul_u32_u24 v5, 0xcccd, v4
    v_lshrrev_b32 v5, 23, v5
    v_mul_u32_u24 v6, 160, v5
    v_sub_u32 v6, v4, v6
    v_mul_u32_u24 v5, 40960, v5
    v_lshl_add_u32 v5, v6, 4, v5
    v_add_u32 v5, 38400, v5
    ds_write_b128 v5, v[84:87]
    s_mov_b64 exec, -1
    s_lshl_b32 s3, s2, 14
    v_mov_b32 v12, 0
    v_mov_b32 v13, 0
    v_mov_b32 v14, 0
    v_mov_b32 v15, 0
    v_mov_b32 v16, 0
    v_mov_b32 v17, 0
    v_mov_b32 v18, 0
    v_mov_b32 v19, 0
    v_add_u32 v4, 0, v0
    v_mul_u32_u24 v5, 0xfc10, v4
    v_lshrrev_b32 v5, 24, v5
    v_mul_u32_u24 v6, 260, v5
    v_sub_u32 v6, v4, v6
    v_mul_u32_u24 v7, 40960, v5
    v_lshl_add_u32 v40, v6, 4, v7
    v_lshlrev_b32 v7, 12, v5
    v_add_u32 v7, s3, v7
    v_subrev_u32 v9, 4, v6
    v_lshl_add_u32 v10, v9, 4, v7
    v_cmp_gt_u32 s[60:61], 4, v5
    v_cmp_gt_u32 vcc, 256, v9
    s_and_b64 vcc, vcc, s[60:61]
    s_and_saveexec_b64 s[62:63], vcc
    buffer_load_dwordx4 v[12:15], v10, s[24:27], 0 offen
    s_mov_b64 exec, -1
    v_add_u32 v9, 1, v9
    v_cmp_gt_u32 vcc, 256, v9
    s_and_b64 vcc, vcc, s[60:61]
    s_and_saveexec_b64 s[62:63], vcc
    buffer_load_dwordx4 v[16:19], v10, s[24:27], 0 offen offset:16
    s_mov_b64 exec, -1
    v_mov_b32 v20, 0
    v_mov_b32 v21, 0
    v_mov_b32 v22, 0
    v_mov_b32 v23, 0
    v_mov_b32 v24, 0
    v_mov_b32 v25, 0
    v_mov_b32 v26, 0
    v_mov_b32 v27, 0
    v_add_u32 v4, 512, v0
    v_mul_u32_u24 v5, 0xfc10, v4
    v_lshrrev_b32 v5, 24, v5
    v_mul_u32_u24 v6, 260, v5
    v_sub_u32 v6, v4, v6
    v_mul_u32_u24 v7, 40960, v5
    v_lshl_add_u32 v41, v6, 4, v7
    v_lshlrev_b32 v7, 12, v5
    v_add_u32 v7, s3, v7
    v_subrev_u32 v9, 4, v6
    v_lshl_add_u32 v10, v9, 4, v7
    v_cmp_gt_u32 s[60:61], 4, v5
    v_cmp_gt_u32 vcc, 256, v9
    s_and_b64 vcc, vcc, s[60:61]
    s_and_saveexec_b64 s[62:63], vcc
    buffer_load_dwordx4 v[20:23], v10, s[24:27], 0 offen
    s_mov_b64 exec, -1
    v_add_u32 v9, 1, v9
    v_cmp_gt_u32 vcc, 256, v9
    s_and_b64 vcc, vcc, s[60:61]
    s_and_saveexec_b64 s[62:63], vcc
    buffer_load_dwordx4 v[24:27], v10, s[24:27], 0 offen offset:16
    s_mov_b64 exec, -1
    v_mov_b32 v28, 0
    v_mov_b32 v29, 0
    v_mov_b32 v30, 0
    v_mov_b32 v31, 0
    v_mov_b32 v32, 0
    v_mov_b32 v33, 0
    v_mov_b32 v34, 0
    v_mov_b32 v35, 0
    v_add_u32 v4, 1024, v0
    v_mul_u32_u24 v5, 0xfc10, v4
    v_lshrrev_b32 v5, 24, v5
    v_mul_u32_u24 v6, 260, v5
    v_sub_u32 v6, v4, v6
    v_mul_u32_u24 v7, 40960, v5
    v_lshl_add_u32 v42, v6, 4, v7
    v_lshlrev_b32 v7, 12, v5
    v_add_u32 v7, s3, v7
    v_subrev_u32 v9, 4, v6
    v_lshl_add_u32 v10, v9, 4, v7
    v_cmp_gt_u32 s[60:61], 4, v5
    v_cmp_gt_u32 vcc, 256, v9
    s_and_b64 vcc, vcc, s[60:61]
    s_and_saveexec_b64 s[62:63], vcc
    buffer_load_dwordx4 v[28:31], v10, s[24:27], 0 offen
    s_mov_b64 exec, -1
    v_add_u32 v9, 1, v9
    v_cmp_gt_u32 vcc, 256, v9
    s_and_b64 vcc, vcc, s[60:61]
    s_and_saveexec_b64 s[62:63], vcc
    buffer_load_dwordx4 v[32:35], v10, s[24:27], 0 offen offset:16
    s_mov_b64 exec, -1
    s_waitcnt vmcnt(0) lgkmcnt(0)
    v_alignbit_b32 v44, v13, v12, 16
    v_alignbit_b32 v45, v14, v13, 16
    v_alignbit_b32 v46, v15, v14, 16
    v_alignbit_b32 v47, v16, v15, 16
    ds_write_b128 v40, v[44:47] offset:0
    v_mov_b32 v48, v13
    v_mov_b32 v49, v14
    v_mov_b32 v50, v15
    v_mov_b32 v51, v16
    ds_write_b128 v40, v[48:51] offset:4160
    v_alignbit_b32 v44, v14, v13, 16
    v_alignbit_b32 v45, v15, v14, 16
    v_alignbit_b32 v46, v16, v15, 16
    v_alignbit_b32 v47, v17, v16, 16
    ds_write_b128 v40, v[44:47] offset:8320
    v_mov_b32 v48, v14
    v_mov_b32 v49, v15
    v_mov_b32 v50, v16
    v_mov_b32 v51, v17
    ds_write_b128 v40, v[48:51] offset:12480
    v_alignbit_b32 v44, v15, v14, 16
    v_alignbit_b32 v45, v16, v15, 16
    v_alignbit_b32 v46, v17, v16, 16
    v_alignbit_b32 v47, v18, v17, 16
    ds_write_b128 v40, v[44:47] offset:16640
    v_mov_b32 v48, v15
    v_mov_b32 v49, v16
    v_mov_b32 v50, v17
    v_mov_b32 v51, v18
    ds_write_b128 v40, v[48:51] offset:20800
    v_alignbit_b32 v44, v16, v15, 16
    v_alignbit_b32 v45, v17, v16, 16
    v_alignbit_b32 v46, v18, v17, 16
    v_alignbit_b32 v47, v19, v18, 16
    ds_write_b128 v40, v[44:47] offset:24960
    v_mov_b32 v48, v16
    v_mov_b32 v49, v17
    v_mov_b32 v50, v18
    v_mov_b32 v51, v19
    ds_write_b128 v40, v[48:51] offset:29120
    v_alignbit_b32 v44, v21, v20, 16
    v_alignbit_b32 v45, v22, v21, 16
    v_alignbit_b32 v46, v23, v22, 16
    v_alignbit_b32 v47, v24, v23, 16
    ds_write_b128 v41, v[44:47] offset:0
    v_mov_b32 v48, v21
    v_mov_b32 v49, v22
    v_mov_b32 v50, v23
    v_mov_b32 v51, v24
    ds_write_b128 v41, v[48:51] offset:4160
    v_alignbit_b32 v44, v22, v21, 16
    v_alignbit_b32 v45, v23, v22, 16
    v_alignbit_b32 v46, v24, v23, 16
    v_alignbit_b32 v47, v25, v24, 16
    ds_write_b128 v41, v[44:47] offset:8320
    v_mov_b32 v48, v22
    v_mov_b32 v49, v23
    v_mov_b32 v50, v24
    v_mov_b32 v51, v25
    ds_write_b128 v41, v[48:51] offset:12480
    v_alignbit_b32 v44, v23, v22, 16
    v_alignbit_b32 v45, v24, v23, 16
    v_alignbit_b32 v46, v25, v24, 16
    v_alignbit_b32 v47, v26, v25, 16
    ds_write_b128 v41, v[44:47] offset:16640
    v_mov_b32 v48, v23
    v_mov_b32 v49, v24
    v_mov_b32 v50, v25
    v_mov_b32 v51, v26
    ds_write_b128 v41, v[48:51] offset:20800
    v_alignbit_b32 v44, v24, v23, 16
    v_alignbit_b32 v45, v25, v24, 16
    v_alignbit_b32 v46, v26, v25, 16
    v_alignbit_b32 v47, v27, v26, 16
    ds_write_b128 v41, v[44:47] offset:24960
    v_mov_b32 v48, v24
    v_mov_b32 v49, v25
    v_mov_b32 v50, v26
    v_mov_b32 v51, v27
    ds_write_b128 v41, v[48:51] offset:29120
    v_cmp_gt_u32 vcc, 16, v0
    s_and_saveexec_b64 s[58:59], vcc
    s_cbranch_execz Lsk_8
    v_alignbit_b32 v44, v29, v28, 16
    v_alignbit_b32 v45, v30, v29, 16
    v_alignbit_b32 v46, v31, v30, 16
    v_alignbit_b32 v47, v32, v31, 16
    ds_write_b128 v42, v[44:47] offset:0
    v_mov_b32 v48, v29
    v_mov_b32 v49, v30
    v_mov_b32 v50, v31
    v_mov_b32 v51, v32
    ds_write_b128 v42, v[48:51] offset:4160
    v_alignbit_b32 v44, v30, v29, 16
    v_alignbit_b32 v45, v31, v30, 16
    v_alignbit_b32 v46, v32, v31, 16
    v_alignbit_b32 v47, v33, v32, 16
    ds_write_b128 v42, v[44:47] offset:8320
    v_mov_b32 v48, v30
    v_mov_b32 v49, v31
    v_mov_b32 v50, v32
    v_mov_b32 v51, v33
    ds_write_b128 v42, v[48:51] offset:12480
    v_alignbit_b32 v44, v31, v30, 16
    v_alignbit_b32 v45, v32, v31, 16
    v_alignbit_b32 v46, v33, v32, 16
    v_alignbit_b32 v47, v34, v33, 16
    ds_write_b128 v42, v[44:47] offset:16640
    v_mov_b32 v48, v31
    v_mov_b32 v49, v32
    v_mov_b32 v50, v33
    v_mov_b32 v51, v34
    ds_write_b128 v42, v[48:51] offset:20800
    v_alignbit_b32 v44, v32, v31, 16
    v_alignbit_b32 v45, v33, v32, 16
    v_alignbit_b32 v46, v34, v33, 16
    v_alignbit_b32 v47, v35, v34, 16
    ds_write_b128 v42, v[44:47] offset:24960
    v_mov_b32 v48, v32
    v_mov_b32 v49, v33
    v_mov_b32 v50, v34
    v_mov_b32 v51, v35
    ds_write_b128 v42, v[48:51] offset:29120
Lsk_8:
    s_mov_b64 exec, -1
    s_waitcnt vmcnt(0) lgkmcnt(0)
    s_barrier
    v_and_b32 v3, 31, v2
    v_lshrrev_b32 v4, 5, v2
    v_and_b32 v5, 7, v3
    v_mul_u32_u24 v5, 4160, v5
    v_and_b32 v6, 24, v3
    v_lshl_add_u32 v6, v4, 3, v6
    v_lshl_add_u32 v5, v6, 1, v5
    v_add_u32 v5, s49, v5
    s_lshl_b32 s52, s48, 5
    v_add_u32 v7, s52, v3
    v_sub_u32 v8, 63, v7
    v_mul_u32_u24 v8, 80, v8
    v_lshl_add_u32 v8, v4, 4, v8
    v_add_u32 v8, s49, v8
    v_add_u32 v8, 33280, v8
    v_mov_b32 v96, 0
    v_mov_b32 v97, 0
    v_mov_b32 v98, 0
    v_mov_b32 v99, 0
    v_mov_b32 v100, 0
    v_mov_b32 v101, 0
    v_mov_b32 v102, 0
    v_mov_b32 v103, 0
    v_mov_b32 v104, 0
    v_mov_b32 v105, 0
    v_mov_b32 v106, 0
    v_mov_b32 v107, 0
    v_mov_b32 v108, 0
    v_mov_b32 v109, 0
    v_mov_b32 v110, 0
    v_mov_b32 v111, 0
    s_lshl_b32 s53, s48, 3
    s_add_u32 s53, s53, 8
    ds_read_b128 v[32:35], v5 offset:0
    ds_read_b128 v[48:51], v8 offset:0
    ds_read_b128 v[36:39], v5 offset:32
    ds_read_b128 v[52:55], v8 offset:32
    ds_read_b128 v[40:43], v5 offset:64
    ds_read_b128 v[56:59], v8 offset:80
    ds_read_b128 v[44:47], v5 offset:96
    ds_read_b128 v[60:63], v8 offset:112
Lconv_9:
    ds_read_b128 v[64:67], v5 offset:128
    ds_read_b128 v[80:83], v8 offset:160
    ds_read_b128 v[68:71], v5 offset:160
    ds_read_b128 v[84:87], v8 offset:192
    ds_read_b128 v[72:75], v5 offset:192
    ds_read_b128 v[88:91], v8 offset:240
    ds_read_b128 v[76:79], v5 offset:224
    ds_read_b128 v[92:95], v8 offset:272
    s_waitcnt lgkmcnt(8)
    v_mfma_f32_32x32x16_bf16 v[96:111], v[32:35], v[48:51], v[96:111]
    v_mfma_f32_32x32x16_bf16 v[96:111], v[36:39], v[52:55], v[96:111]
    v_mfma_f32_32x32x16_bf16 v[96:111], v[40:43], v[56:59], v[96:111]
    v_mfma_f32_32x32x16_bf16 v[96:111], v[44:47], v[60:63], v[96:111]
    ds_read_b128 v[32:35], v5 offset:256
    ds_read_b128 v[48:51], v8 offset:320
    ds_read_b128 v[36:39], v5 offset:288
    ds_read_b128 v[52:55], v8 offset:352
    ds_read_b128 v[40:43], v5 offset:320
    ds_read_b128 v[56:59], v8 offset:400
    ds_read_b128 v[44:47], v5 offset:352
    ds_read_b128 v[60:63], v8 offset:432
    s_waitcnt lgkmcnt(8)
    v_mfma_f32_32x32x16_bf16 v[96:111], v[64:67], v[80:83], v[96:111]
    v_mfma_f32_32x32x16_bf16 v[96:111], v[68:71], v[84:87], v[96:111]
    v_mfma_f32_32x32x16_bf16 v[96:111], v[72:75], v[88:91], v[96:111]
    v_mfma_f32_32x32x16_bf16 v[96:111], v[76:79], v[92:95], v[96:111]
    v_add_u32 v5, 256, v5
    v_add_u32 v8, 320, v8
    s_sub_u32 s53, s53, 1
    s_cmp_lg_u32 s53, 0
    s_cbranch_scc1 Lconv_9
    s_waitcnt lgkmcnt(0)
    s_nop 15
    v_sub_u32 v9, 63, v7
    v_mul_u32_u24 v9, 80, v9
    v_add_u32 v9, s49, v9
    v_lshlrev_b32 v10, 3, v4
    v_sub_u32 v9, v9, v10
    v_add_u32 v9, 33288, v9
    ds_read_b64 v[48:49], v9 offset:48
    ds_read_b64 v[50:51], v9 offset:32
    ds_read_b64 v[52:53], v9 offset:16
    ds_read_b64 v[54:55], v9 offset:0
    s_lshr_b32 s54, s47, 1
    s_cmp_eq_u32 s54, 0
    s_cselect_b32 s54, s44, s45
    s_lshl_b32 s55, s54, 16
    s_and_b32 s54, s54, 0xffff0000
    s_and_b32 s56, s47, 1
    s_cmp_eq_u32 s56, 0
    s_cselect_b32 s54, s55, s54
    s_waitcnt lgkmcnt(0)
    v_lshlrev_b32 v59, 16, v48
    v_and_b32 v58, 0xffff0000, v48
    v_lshlrev_b32 v57, 16, v49
    v_and_b32 v56, 0xffff0000, v49
    v_mul_f32 v56, s54, v56
    v_mul_f32 v57, s54, v57
    v_mul_f32 v58, s54, v58
    v_mul_f32 v59, s54, v59
    v_cvt_pk_bf16_f32 v60, v56, v57
    v_lshlrev_b32 v56, 16, v60
    v_and_b32 v57, 0xffff0000, v60
    v_cvt_pk_bf16_f32 v60, v58, v59
    v_lshlrev_b32 v58, 16, v60
    v_and_b32 v59, 0xffff0000, v60
    v_cvt_pk_bf16_f32 v60, v96, v97
    v_lshlrev_b32 v96, 16, v60
    v_and_b32 v97, 0xffff0000, v60
    v_cvt_pk_bf16_f32 v60, v98, v99
    v_lshlrev_b32 v98, 16, v60
    v_and_b32 v99, 0xffff0000, v60
    v_add_f32 v96, v96, v56
    v_add_f32 v97, v97, v57
    v_add_f32 v98, v98, v58
    v_add_f32 v99, v99, v59
    v_cvt_pk_bf16_f32 v96, v96, v97
    v_cvt_pk_bf16_f32 v97, v98, v99
    v_lshlrev_b32 v59, 16, v50
    v_and_b32 v58, 0xffff0000, v50
    v_lshlrev_b32 v57, 16, v51
    v_and_b32 v56, 0xffff0000, v51
    v_mul_f32 v56, s54, v56
    v_mul_f32 v57, s54, v57
    v_mul_f32 v58, s54, v58
    v_mul_f32 v59, s54, v59
    v_cvt_pk_bf16_f32 v60, v56, v57
    v_lshlrev_b32 v56, 16, v60
    v_and_b32 v57, 0xffff0000, v60
    v_cvt_pk_bf16_f32 v60, v58, v59
    v_lshlrev_b32 v58, 16, v60
    v_and_b32 v59, 0xffff0000, v60
    v_cvt_pk_bf16_f32 v60, v100, v101
    v_lshlrev_b32 v100, 16, v60
    v_and_b32 v101, 0xffff0000, v60
    v_cvt_pk_bf16_f32 v60, v102, v103
    v_lshlrev_b32 v102, 16, v60
    v_and_b32 v103, 0xffff0000, v60
    v_add_f32 v100, v100, v56
    v_add_f32 v101, v101, v57
    v_add_f32 v102, v102, v58
    v_add_f32 v103, v103, v59
    v_cvt_pk_bf16_f32 v100, v100, v101
    v_cvt_pk_bf16_f32 v101, v102, v103
    v_lshlrev_b32 v59, 16, v52
    v_and_b32 v58, 0xffff0000, v52
    v_lshlrev_b32 v57, 16, v53
    v_and_b32 v56, 0xffff0000, v53
    v_mul_f32 v56, s54, v56
    v_mul_f32 v57, s54, v57
    v_mul_f32 v58, s54, v58
    v_mul_f32 v59, s54, v59
    v_cvt_pk_bf16_f32 v60, v56, v57
    v_lshlrev_b32 v56, 16, v60
    v_and_b32 v57, 0xffff0000, v60
    v_cvt_pk_bf16_f32 v60, v58, v59
    v_lshlrev_b32 v58, 16, v60
    v_and_b32 v59, 0xffff0000, v60
    v_cvt_pk_bf16_f32 v60, v104, v105
    v_lshlrev_b32 v104, 16, v60
    v_and_b32 v105, 0xffff0000, v60
    v_cvt_pk_bf16_f32 v60, v106, v107
    v_lshlrev_b32 v106, 16, v60
    v_and_b32 v107, 0xffff0000, v60
    v_add_f32 v104, v104, v56
    v_add_f32 v105, v105, v57
    v_add_f32 v106, v106, v58
    v_add_f32 v107, v107, v59
    v_cvt_pk_bf16_f32 v104, v104, v105
    v_cvt_pk_bf16_f32 v105, v106, v107
    v_lshlrev_b32 v59, 16, v54
    v_and_b32 v58, 0xffff0000, v54
    v_lshlrev_b32 v57, 16, v55
    v_and_b32 v56, 0xffff0000, v55
    v_mul_f32 v56, s54, v56
    v_mul_f32 v57, s54, v57
    v_mul_f32 v58, s54, v58
    v_mul_f32 v59, s54, v59
    v_cvt_pk_bf16_f32 v60, v56, v57
    v_lshlrev_b32 v56, 16, v60
    v_and_b32 v57, 0xffff0000, v60
    v_cvt_pk_bf16_f32 v60, v58, v59
    v_lshlrev_b32 v58, 16, v60
    v_and_b32 v59, 0xffff0000, v60
    v_cvt_pk_bf16_f32 v60, v108, v109
    v_lshlrev_b32 v108, 16, v60
    v_and_b32 v109, 0xffff0000, v60
    v_cvt_pk_bf16_f32 v60, v110, v111
    v_lshlrev_b32 v110, 16, v60
    v_and_b32 v111, 0xffff0000, v60
    v_add_f32 v108, v108, v56
    v_add_f32 v109, v109, v57
    v_add_f32 v110, v110, v58
    v_add_f32 v111, v111, v59
    v_cvt_pk_bf16_f32 v108, v108, v109
    v_cvt_pk_bf16_f32 v109, v110, v111
    s_barrier
    v_lshlrev_b32 v11, 5, v7
    v_lshl_add_u32 v11, v4, 2, v11
    v_lshlrev_b32 v11, 3, v11
    v_lshl_add_u32 v11, v7, 3, v11
    s_lshl_b32 s56, s47, 1
    v_add_u32 v11, s56, v11
    ds_write_b16 v11, v96 offset:0
    ds_write_b16_d16_hi v11, v96 offset:8
    ds_write_b16 v11, v97 offset:16
    ds_write_b16_d16_hi v11, v97 offset:24
    ds_write_b16 v11, v100 offset:64
    ds_write_b16_d16_hi v11, v100 offset:72
    ds_write_b16 v11, v101 offset:80
    ds_write_b16_d16_hi v11, v101 offset:88
    ds_write_b16 v11, v104 offset:128
    ds_write_b16_d16_hi v11, v104 offset:136
    ds_write_b16 v11, v105 offset:144
    ds_write_b16_d16_hi v11, v105 offset:152
    ds_write_b16 v11, v108 offset:192
    ds_write_b16_d16_hi v11, v108 offset:200
    ds_write_b16 v11, v109 offset:208
    ds_write_b16_d16_hi v11, v109 offset:216
    s_waitcnt lgkmcnt(0)
    s_barrier
    v_lshlrev_b32 v12, 3, v0
    v_lshrrev_b32 v14, 5, v0
    v_lshl_add_u32 v14, v14, 3, v12
    ds_read_b64 v[16:17], v14 offset:0
    ds_read_b64 v[18:19], v14 offset:4224
    ds_read_b64 v[20:21], v14 offset:8448
    ds_read_b64 v[22:23], v14 offset:12672
    s_lshl_b32 s3, s2, 14
    v_add_u32 v13, s3, v12
    s_waitcnt lgkmcnt(3)
    buffer_store_dwordx2 v[16:17], v13, s[28:31], 0 offen
    v_add_u32 v13, 0x1000, v13
    s_waitcnt lgkmcnt(2)
    buffer_store_dwordx2 v[18:19], v13, s[28:31], 0 offen
    v_add_u32 v13, 0x1000, v13
    s_waitcnt lgkmcnt(1)
    buffer_store_dwordx2 v[20:21], v13, s[28:31], 0 offen
    v_add_u32 v13, 0x1000, v13
    s_waitcnt lgkmcnt(0)
    buffer_store_dwordx2 v[22:23], v13, s[28:31], 0 offen
    v_add_u32 v13, 0x1000, v13
    s_branch Lend_3
Ltr_4:
    s_load_dwordx2 s[6:7], s[0:1], 56
    s_load_dwordx2 s[8:9], s[0:1], 80
    s_waitcnt lgkmcnt(0)
    s_mov_b32 s16, s6
    s_mov_b32 s17, s7
    s_mov_b32 s18, 0x21c000
    s_mov_b32 s19, 0x00020000
    s_add_u32 s20, s4, 0x281000
    s_addc_u32 s21, s5, 0
    s_mov_b32 s22, 0x21c000
    s_mov_b32 s23, 0x00020000
    s_mov_b32 s24, s8
    s_mov_b32 s25, s9
    s_mov_b32 s26, 0x10e000
    s_mov_b32 s27, 0x00020000
    s_add_u32 s28, s4, 0x49e000
    s_addc_u32 s29, s5, 0
    s_mov_b32 s30, 0x10e000
    s_mov_b32 s31, 0x00020000
    v_lshrrev_b32 v20, 8, v0
    v_and_b32 v21, 255, v0
    v_lshrrev_b32 v1, 3, v21
    v_and_b32 v2, 7, v21
    v_mul_u32_u24 v4, 640, v2
    v_lshl_add_u32 v4, v1, 1, v4
    v_mul_u32_u24 v22, 5120, v20
    v_add_u32 v4, v4, v22
    v_lshrrev_b32 v5, 2, v21
    v_and_b32 v6, 3, v21
    v_mul_u32_u24 v7, 80, v5
    v_lshl_add_u32 v7, v6, 4, v7
    v_add_u32 v7, v7, v22
    s_sub_u32 s3, s2, 160
    s_lshl_b32 s3, s3, 1
    v_add_u32 v23, s3, v20
    v_cmp_gt_u32 vcc, 540, v23
    s_mov_b64 s[80:81], vcc
    v_cmp_gt_u32 vcc, 810, v23
    s_mov_b64 s[82:83], vcc
    v_subrev_u32 v24, 540, v23
    v_cndmask_b32 v24, v24, v23, s[80:81]
    v_mul_u32_u24 v25, 0x97b5, v24
    v_lshrrev_b32 v25, 20, v25
    v_mul_u32_u24 v26, 0x1999a, v24
    v_lshrrev_b32 v26, 20, v26
    v_cndmask_b32 v25, v26, v25, s[80:81]
    v_mov_b32 v26, 10
    v_cndmask_b32 v26, v26, 27, s[80:81]
    v_mul_u32_u24 v26, v26, v25
    v_sub_u32 v26, v24, v26
    v_mov_b32 v27, 1280
    v_mov_b32 v28, 3456
    v_cndmask_b32 v27, v27, v28, s[80:81]
    v_mov_b32 v28, 1728
    v_mov_b32 v29, 1280
    v_cndmask_b32 v28, v28, v29, s[80:81]
    v_lshl_add_u32 v29, v25, 5, v1
    v_mul_lo_u32 v29, v29, v27
    v_lshl_add_u32 v29, v2, 4, v29
    v_lshl_add_u32 v29, v26, 7, v29
    v_lshl_add_u32 v32, v26, 6, v5
    v_mul_lo_u32 v32, v32, v28
    v_lshl_add_u32 v32, v6, 4, v32
    v_lshl_add_u32 v32, v25, 6, v32
    s_and_b64 s[40:41], s[80:81], s[82:83]
    s_andn2_b64 s[42:43], s[82:83], s[80:81]
    s_mov_b64 exec, s[40:41]
    buffer_load_dwordx4 v[40:43], v29, s[16:19], 0 offen
    s_mov_b64 exec, s[42:43]
    buffer_load_dwordx4 v[40:43], v29, s[24:27], 0 offen
    s_mov_b64 exec, -1
    v_add_u32 v23, 192, v23
    v_cmp_gt_u32 vcc, 540, v23
    s_mov_b64 s[80:81], vcc
    v_cmp_gt_u32 vcc, 810, v23
    s_mov_b64 s[82:83], vcc
    v_subrev_u32 v24, 540, v23
    v_cndmask_b32 v24, v24, v23, s[80:81]
    v_mul_u32_u24 v25, 0x97b5, v24
    v_lshrrev_b32 v25, 20, v25
    v_mul_u32_u24 v26, 0x1999a, v24
    v_lshrrev_b32 v26, 20, v26
    v_cndmask_b32 v25, v26, v25, s[80:81]
    v_mov_b32 v26, 10
    v_cndmask_b32 v26, v26, 27, s[80:81]
    v_mul_u32_u24 v26, v26, v25
    v_sub_u32 v26, v24, v26
    v_mov_b32 v27, 1280
    v_mov_b32 v28, 3456
    v_cndmask_b32 v27, v27, v28, s[80:81]
    v_mov_b32 v28, 1728
    v_mov_b32 v29, 1280
    v_cndmask_b32 v28, v28, v29, s[80:81]
    v_lshl_add_u32 v29, v25, 5, v1
    v_mul_lo_u32 v29, v29, v27
    v_lshl_add_u32 v29, v2, 4, v29
    v_lshl_add_u32 v29, v26, 7, v29
    v_lshl_add_u32 v33, v26, 6, v5
    v_mul_lo_u32 v33, v33, v28
    v_lshl_add_u32 v33, v6, 4, v33
    v_lshl_add_u32 v33, v25, 6, v33
    s_and_b64 s[44:45], s[80:81], s[82:83]
    s_andn2_b64 s[46:47], s[82:83], s[80:81]
    s_mov_b64 exec, s[44:45]
    buffer_load_dwordx4 v[44:47], v29, s[16:19], 0 offen
    s_mov_b64 exec, s[46:47]
    buffer_load_dwordx4 v[44:47], v29, s[24:27], 0 offen
    s_mov_b64 exec, -1
    v_add_u32 v23, 192, v23
    v_cmp_gt_u32 vcc, 540, v23
    s_mov_b64 s[80:81], vcc
    v_cmp_gt_u32 vcc, 810, v23
    s_mov_b64 s[82:83], vcc
    v_subrev_u32 v24, 540, v23
    v_cndmask_b32 v24, v24, v23, s[80:81]
    v_mul_u32_u24 v25, 0x97b5, v24
    v_lshrrev_b32 v25, 20, v25
    v_mul_u32_u24 v26, 0x1999a, v24
    v_lshrrev_b32 v26, 20, v26
    v_cndmask_b32 v25, v26, v25, s[80:81]
    v_mov_b32 v26, 10
    v_cndmask_b32 v26, v26, 27, s[80:81]
    v_mul_u32_u24 v26, v26, v25
    v_sub_u32 v26, v24, v26
    v_mov_b32 v27, 1280
    v_mov_b32 v28, 3456
    v_cndmask_b32 v27, v27, v28, s[80:81]
    v_mov_b32 v28, 1728
    v_mov_b32 v29, 1280
    v_cndmask_b32 v28, v28, v29, s[80:81]
    v_lshl_add_u32 v29, v25, 5, v1
    v_mul_lo_u32 v29, v29, v27
    v_lshl_add_u32 v29, v2, 4, v29
    v_lshl_add_u32 v29, v26, 7, v29
    v_lshl_add_u32 v34, v26, 6, v5
    v_mul_lo_u32 v34, v34, v28
    v_lshl_add_u32 v34, v6, 4, v34
    v_lshl_add_u32 v34, v25, 6, v34
    s_and_b64 s[48:49], s[80:81], s[82:83]
    s_andn2_b64 s[50:51], s[82:83], s[80:81]
    s_mov_b64 exec, s[48:49]
    buffer_load_dwordx4 v[48:51], v29, s[16:19], 0 offen
    s_mov_b64 exec, s[50:51]
    buffer_load_dwordx4 v[48:51], v29, s[24:27], 0 offen
    s_mov_b64 exec, -1
    v_add_u32 v23, 192, v23
    v_cmp_gt_u32 vcc, 540, v23
    s_mov_b64 s[80:81], vcc
    v_cmp_gt_u32 vcc, 810, v23
    s_mov_b64 s[82:83], vcc
    v_subrev_u32 v24, 540, v23
    v_cndmask_b32 v24, v24, v23, s[80:81]
    v_mul_u32_u24 v25, 0x97b5, v24
    v_lshrrev_b32 v25, 20, v25
    v_mul_u32_u24 v26, 0x1999a, v24
    v_lshrrev_b32 v26, 20, v26
    v_cndmask_b32 v25, v26, v25, s[80:81]
    v_mov_b32 v26, 10
    v_cndmask_b32 v26, v26, 27, s[80:81]
    v_mul_u32_u24 v26, v26, v25
    v_sub_u32 v26, v24, v26
    v_mov_b32 v27, 1280
    v_mov_b32 v28, 3456
    v_cndmask_b32 v27, v27, v28, s[80:81]
    v_mov_b32 v28, 1728
    v_mov_b32 v29, 1280
    v_cndmask_b32 v28, v28, v29, s[80:81]
    v_lshl_add_u32 v29, v25, 5, v1
    v_mul_lo_u32 v29, v29, v27
    v_lshl_add_u32 v29, v2, 4, v29
    v_lshl_add_u32 v29, v26, 7, v29
    v_lshl_add_u32 v35, v26, 6, v5
    v_mul_lo_u32 v35, v35, v28
    v_lshl_add_u32 v35, v6, 4, v35
    v_lshl_add_u32 v35, v25, 6, v35
    s_and_b64 s[52:53], s[80:81], s[82:83]
    s_andn2_b64 s[54:55], s[82:83], s[80:81]
    s_mov_b64 exec, s[52:53]
    buffer_load_dwordx4 v[52:55], v29, s[16:19], 0 offen
    s_mov_b64 exec, s[54:55]
    buffer_load_dwordx4 v[52:55], v29, s[24:27], 0 offen
    s_mov_b64 exec, -1
    v_add_u32 v23, 192, v23
    v_cmp_gt_u32 vcc, 540, v23
    s_mov_b64 s[80:81], vcc
    v_cmp_gt_u32 vcc, 810, v23
    s_mov_b64 s[82:83], vcc
    v_subrev_u32 v24, 540, v23
    v_cndmask_b32 v24, v24, v23, s[80:81]
    v_mul_u32_u24 v25, 0x97b5, v24
    v_lshrrev_b32 v25, 20, v25
    v_mul_u32_u24 v26, 0x1999a, v24
    v_lshrrev_b32 v26, 20, v26
    v_cndmask_b32 v25, v26, v25, s[80:81]
    v_mov_b32 v26, 10
    v_cndmask_b32 v26, v26, 27, s[80:81]
    v_mul_u32_u24 v26, v26, v25
    v_sub_u32 v26, v24, v26
    v_mov_b32 v27, 1280
    v_mov_b32 v28, 3456
    v_cndmask_b32 v27, v27, v28, s[80:81]
    v_mov_b32 v28, 1728
    v_mov_b32 v29, 1280
    v_cndmask_b32 v28, v28, v29, s[80:81]
    v_lshl_add_u32 v29, v25, 5, v1
    v_mul_lo_u32 v29, v29, v27
    v_lshl_add_u32 v29, v2, 4, v29
    v_lshl_add_u32 v29, v26, 7, v29
    v_lshl_add_u32 v36, v26, 6, v5
    v_mul_lo_u32 v36, v36, v28
    v_lshl_add_u32 v36, v6, 4, v36
    v_lshl_add_u32 v36, v25, 6, v36
    s_and_b64 s[56:57], s[80:81], s[82:83]
    s_andn2_b64 s[58:59], s[82:83], s[80:81]
    s_mov_b64 exec, s[56:57]
    buffer_load_dwordx4 v[56:59], v29, s[16:19], 0 offen
    s_mov_b64 exec, s[58:59]
    buffer_load_dwordx4 v[56:59], v29, s[24:27], 0 offen
    s_mov_b64 exec, -1
    v_add_u32 v23, 192, v23
    s_waitcnt vmcnt(0)
    ds_write_b16 v4, v40 offset:0
    ds_write_b16_d16_hi v4, v40 offset:80
    ds_write_b16 v4, v41 offset:160
    ds_write_b16_d16_hi v4, v41 offset:240
    ds_write_b16 v4, v42 offset:320
    ds_write_b16_d16_hi v4, v42 offset:400
    ds_write_b16 v4, v43 offset:480
    ds_write_b16_d16_hi v4, v43 offset:560
    ds_write_b16 v4, v44 offset:10240
    ds_write_b16_d16_hi v4, v44 offset:10320
    ds_write_b16 v4, v45 offset:10400
    ds_write_b16_d16_hi v4, v45 offset:10480
    ds_write_b16 v4, v46 offset:10560
    ds_write_b16_d16_hi v4, v46 offset:10640
    ds_write_b16 v4, v47 offset:10720
    ds_write_b16_d16_hi v4, v47 offset:10800
    ds_write_b16 v4, v48 offset:20480
    ds_write_b16_d16_hi v4, v48 offset:20560
    ds_write_b16 v4, v49 offset:20640
    ds_write_b16_d16_hi v4, v49 offset:20720
    ds_write_b16 v4, v50 offset:20800
    ds_write_b16_d16_hi v4, v50 offset:20880
    ds_write_b16 v4, v51 offset:20960
    ds_write_b16_d16_hi v4, v51 offset:21040
    ds_write_b16 v4, v52 offset:30720
    ds_write_b16_d16_hi v4, v52 offset:30800
    ds_write_b16 v4, v53 offset:30880
    ds_write_b16_d16_hi v4, v53 offset:30960
    ds_write_b16 v4, v54 offset:31040
    ds_write_b16_d16_hi v4, v54 offset:31120
    ds_write_b16 v4, v55 offset:31200
    ds_write_b16_d16_hi v4, v55 offset:31280
    ds_write_b16 v4, v56 offset:40960
    ds_write_b16_d16_hi v4, v56 offset:41040
    ds_write_b16 v4, v57 offset:41120
    ds_write_b16_d16_hi v4, v57 offset:41200
    ds_write_b16 v4, v58 offset:41280
    ds_write_b16_d16_hi v4, v58 offset:41360
    ds_write_b16 v4, v59 offset:41440
    ds_write_b16_d16_hi v4, v59 offset:41520
    s_waitcnt lgkmcnt(0)
    s_barrier
    ds_read_b128 v[40:43], v7 offset:0
    ds_read_b128 v[44:47], v7 offset:10240
    ds_read_b128 v[48:51], v7 offset:20480
    ds_read_b128 v[52:55], v7 offset:30720
    ds_read_b128 v[56:59], v7 offset:40960
    s_waitcnt lgkmcnt(4)
    s_mov_b64 exec, s[40:41]
    buffer_store_dwordx4 v[40:43], v32, s[20:23], 0 offen
    s_mov_b64 exec, s[42:43]
    buffer_store_dwordx4 v[40:43], v32, s[28:31], 0 offen
    s_mov_b64 exec, -1
    s_waitcnt lgkmcnt(3)
    s_mov_b64 exec, s[44:45]
    buffer_store_dwordx4 v[44:47], v33, s[20:23], 0 offen
    s_mov_b64 exec, s[46:47]
    buffer_store_dwordx4 v[44:47], v33, s[28:31], 0 offen
    s_mov_b64 exec, -1
    s_waitcnt lgkmcnt(2)
    s_mov_b64 exec, s[48:49]
    buffer_store_dwordx4 v[48:51], v34, s[20:23], 0 offen
    s_mov_b64 exec, s[50:51]
    buffer_store_dwordx4 v[48:51], v34, s[28:31], 0 offen
    s_mov_b64 exec, -1
    s_waitcnt lgkmcnt(1)
    s_mov_b64 exec, s[52:53]
    buffer_store_dwordx4 v[52:55], v35, s[20:23], 0 offen
    s_mov_b64 exec, s[54:55]
    buffer_store_dwordx4 v[52:55], v35, s[28:31], 0 offen
    s_mov_b64 exec, -1
    s_waitcnt lgkmcnt(0)
    s_mov_b64 exec, s[56:57]
    buffer_store_dwordx4 v[56:59], v36, s[20:23], 0 offen
    s_mov_b64 exec, s[58:59]
    buffer_store_dwordx4 v[56:59], v36, s[28:31], 0 offen
    s_mov_b64 exec, -1
    s_load_dwordx2 s[6:7], s[0:1], 64
    s_waitcnt lgkmcnt(0)
    s_mov_b32 s16, s6
    s_mov_b32 s17, s7
    s_mov_b32 s18, 0x800000
    s_mov_b32 s19, 0x00020000
    s_sub_u32 s3, s2, 160
    s_mul_i32 s3, s3, 90112
    v_lshlrev_b32 v1, 4, v0
    buffer_load_dwordx4 v[8:11], v1, s[16:19], s3 offen
    s_add_u32 s3, s3, 8192
    buffer_load_dwordx4 v[8:11], v1, s[16:19], s3 offen
    s_add_u32 s3, s3, 8192
    buffer_load_dwordx4 v[8:11], v1, s[16:19], s3 offen
    s_add_u32 s3, s3, 8192
    buffer_load_dwordx4 v[8:11], v1, s[16:19], s3 offen
    s_add_u32 s3, s3, 8192
    buffer_load_dwordx4 v[8:11], v1, s[16:19], s3 offen
    s_add_u32 s3, s3, 8192
    buffer_load_dwordx4 v[8:11], v1, s[16:19], s3 offen
    s_add_u32 s3, s3, 8192
    buffer_load_dwordx4 v[8:11], v1, s[16:19], s3 offen
    s_add_u32 s3, s3, 8192
    buffer_load_dwordx4 v[8:11], v1, s[16:19], s3 offen
    s_add_u32 s3, s3, 8192
    buffer_load_dwordx4 v[8:11], v1, s[16:19], s3 offen
    s_add_u32 s3, s3, 8192
    buffer_load_dwordx4 v[8:11], v1, s[16:19], s3 offen
    s_add_u32 s3, s3, 8192
    buffer_load_dwordx4 v[8:11], v1, s[16:19], s3 offen
    s_add_u32 s3, s3, 8192
Lend_3:
    s_endpgm
.p2align 8
.type e1_kernel,@function
e1_kernel:
    s_cmp_ge_u32 s2, 128
    s_cbranch_scc1 Lend_10
    s_load_dwordx2 s[4:5], s[0:1], 104
    s_load_dwordx2 s[6:7], s[0:1], 0
    s_waitcnt lgkmcnt(0)
    s_mov_b32 s8, s6
    s_mov_b32 s9, s7
    s_mov_b32 s10, 0x280000
    s_mov_b32 s11, 0x00020000
    s_mov_b32 s12, s4
    s_mov_b32 s13, s5
    s_mov_b32 s14, 0x280000
    s_mov_b32 s15, 0x00020000
    s_add_u32 s16, s4, 0x5ad000
    s_addc_u32 s17, s5, 0
    s_mov_b32 s18, 0x280000
    s_mov_b32 s19, 0x00020000
    s_add_u32 s20, s4, 0x82e000
    s_addc_u32 s21, s5, 0
    s_mov_b32 s22, 0x280000
    s_mov_b32 s23, 0x00020000
    v_lshrrev_b32 v1, 6, v0
    s_lshl_b32 s3, s2, 4
    v_add_u32 v1, s3, v1
    v_and_b32 v2, 63, v0
    v_mul_u32_u24 v1, 1280, v1
    v_lshl_add_u32 v1, v2, 3, v1
    v_cmp_gt_u32 vcc, 32, v2
    s_nop 1
    v_cndmask_b32 v58, 0, 1.0, vcc
    s_mov_b64 s[30:31], vcc
    v_mov_b32 v8, 0
    v_mov_b32 v9, 0
    v_mov_b32 v14, 0
    v_mov_b32 v15, 0
    v_lshrrev_b32 v3, 3, v0
    v_and_b32 v59, 7, v0
    v_lshlrev_b32 v60, 14, v3
    v_lshl_add_u32 v60, v59, 4, v60
    s_lshl_b32 s3, s2, 7
    buffer_load_dwordx4 v[16:19], v60, s[12:15], s3 offen
    v_cmp_gt_u32 vcc, 256, v0
    s_and_saveexec_b64 s[28:29], vcc
    v_add_u32 v60, 0x200000, v60
    buffer_load_dwordx4 v[44:47], v60, s[12:15], s3 offen
    s_mov_b64 exec, -1
    buffer_load_dwordx2 v[4:5], v1, s[8:11], 0 offen
    buffer_load_dwordx2 v[6:7], v1, s[8:11], 0 offen offset:512
    s_mov_b64 exec, s[30:31]
    buffer_load_dwordx2 v[8:9], v1, s[8:11], 0 offen offset:1024
    s_mov_b64 exec, -1
    v_mul_u32_u24 v3, 144, v3
    v_lshl_add_u32 v3, v59, 4, v3
    s_waitcnt vmcnt(3)
    ds_write_b128 v3, v[16:19]
    s_mov_b64 exec, s[28:29]
    v_cmp_gt_u32 vcc, 256, v0
    s_and_saveexec_b64 s[28:29], vcc
    ds_write_b128 v3, v[44:47] offset:18432
    s_mov_b64 exec, -1
    s_waitcnt lgkmcnt(0)
    s_barrier
    v_lshrrev_b32 v3, 6, v0
    v_lshlrev_b32 v3, 3, v3
    v_mul_u32_u24 v59, 144, v2
    v_add_u32 v3, v3, v59
    ds_read_b64 v[10:11], v3
    ds_read_b64 v[12:13], v3 offset:9216
    s_mov_b64 exec, s[30:31]
    ds_read_b64 v[14:15], v3 offset:18432
    s_mov_b64 exec, -1
    s_waitcnt vmcnt(0) lgkmcnt(0)
    v_lshlrev_b32 v20, 16, v4
    v_and_b32 v21, 0xffff0000, v4
    v_mov_b32 v32, v20
    v_mov_b32 v33, v21
    v_lshlrev_b32 v22, 16, v5
    v_and_b32 v23, 0xffff0000, v5
    v_mov_b32 v34, v22
    v_mov_b32 v35, v23
    v_lshlrev_b32 v24, 16, v6
    v_and_b32 v25, 0xffff0000, v6
    v_mov_b32 v36, v24
    v_mov_b32 v37, v25
    v_lshlrev_b32 v26, 16, v7
    v_and_b32 v27, 0xffff0000, v7
    v_mov_b32 v38, v26
    v_mov_b32 v39, v27
    v_lshlrev_b32 v28, 16, v8
    v_and_b32 v29, 0xffff0000, v8
    v_mov_b32 v40, v28
    v_mov_b32 v41, v29
    v_lshlrev_b32 v30, 16, v9
    v_and_b32 v31, 0xffff0000, v9
    v_mov_b32 v42, v30
    v_mov_b32 v43, v31
    v_add_f32 v62, v32, v33
    v_mul_f32 v63, v32, v32
    v_fmac_f32 v63, v33, v33
    v_add_f32 v62, v62, v34
    v_fmac_f32 v63, v34, v34
    v_add_f32 v62, v62, v35
    v_fmac_f32 v63, v35, v35
    v_add_f32 v62, v62, v36
    v_fmac_f32 v63, v36, v36
    v_add_f32 v62, v62, v37
    v_fmac_f32 v63, v37, v37
    v_add_f32 v62, v62, v38
    v_fmac_f32 v63, v38, v38
    v_add_f32 v62, v62, v39
    v_fmac_f32 v63, v39, v39
    v_add_f32 v62, v62, v40
    v_fmac_f32 v63, v40, v40
    v_add_f32 v62, v62, v41
    v_fmac_f32 v63, v41, v41
    v_add_f32 v62, v62, v42
    v_fmac_f32 v63, v42, v42
    v_add_f32 v62, v62, v43
    v_fmac_f32 v63, v43, v43
    s_nop 0
    s_nop 0
    v_add_f32_dpp v62, v62, v62 quad_perm:[1,0,3,2] row_mask:0xf bank_mask:0xf
    v_add_f32_dpp v63, v63, v63 quad_perm:[1,0,3,2] row_mask:0xf bank_mask:0xf
    s_nop 0
    v_add_f32_dpp v62, v62, v62 quad_perm:[2,3,0,1] row_mask:0xf bank_mask:0xf
    v_add_f32_dpp v63, v63, v63 quad_perm:[2,3,0,1] row_mask:0xf bank_mask:0xf
    s_nop 0
    v_add_f32_dpp v62, v62, v62 row_half_mirror row_mask:0xf bank_mask:0xf
    v_add_f32_dpp v63, v63, v63 row_half_mirror row_mask:0xf bank_mask:0xf
    s_nop 0
    v_add_f32_dpp v62, v62, v62 row_mirror row_mask:0xf bank_mask:0xf
    v_add_f32_dpp v63, v63, v63 row_mirror row_mask:0xf bank_mask:0xf
    s_nop 0
    v_readlane_b32 s32, v62, 0
    v_readlane_b32 s33, v62, 16
    v_readlane_b32 s34, v62, 32
    v_readlane_b32 s35, v62, 48
    v_readlane_b32 s36, v63, 0
    v_readlane_b32 s37, v63, 16
    v_readlane_b32 s38, v63, 32
    v_readlane_b32 s39, v63, 48
    v_mov_b32 v62, s32
    v_mov_b32 v63, s36
    v_add_f32 v62, s33, v62
    v_add_f32 v63, s37, v63
    v_add_f32 v62, s34, v62
    v_add_f32 v63, s38, v63
    v_add_f32 v62, s35, v62
    v_add_f32 v63, s39, v63
    v_mul_f32 v62, 0x3acccccd, v62
    v_mul_f32 v63, 0x3acccccd, v63
    v_fma_f32 v63, -v62, v62, v63
    v_max_f32 v63, 0, v63
    v_cvt_pk_bf16_f32 v57, v62, v63
    v_lshlrev_b32 v62, 16, v57
    v_and_b32 v63, 0xffff0000, v57
    v_add_f32 v63, 0x3727c5ac, v63
    v_cvt_pk_bf16_f32 v57, v63, v63
    v_lshlrev_b32 v63, 16, v57
    v_sqrt_f32 v63, v63
    s_nop 0
    v_cvt_pk_bf16_f32 v57, v63, v63
    v_lshlrev_b32 v63, 16, v57
    v_rcp_f32 v63, v63
    s_nop 0
    v_sub_f32 v32, v32, v62
    v_sub_f32 v33, v33, v62
    v_cvt_pk_bf16_f32 v57, v32, v33
    v_lshlrev_b32 v32, 16, v57
    v_and_b32 v33, 0xffff0000, v57
    v_mul_f32 v32, v32, v63
    v_mul_f32 v33, v33, v63
    v_cvt_pk_bf16_f32 v57, v32, v33
    v_lshlrev_b32 v32, 16, v57
    v_and_b32 v33, 0xffff0000, v57
    v_sub_f32 v34, v34, v62
    v_sub_f32 v35, v35, v62
    v_cvt_pk_bf16_f32 v57, v34, v35
    v_lshlrev_b32 v34, 16, v57
    v_and_b32 v35, 0xffff0000, v57
    v_mul_f32 v34, v34, v63
    v_mul_f32 v35, v35, v63
    v_cvt_pk_bf16_f32 v57, v34, v35
    v_lshlrev_b32 v34, 16, v57
    v_and_b32 v35, 0xffff0000, v57
    v_sub_f32 v36, v36, v62
    v_sub_f32 v37, v37, v62
    v_cvt_pk_bf16_f32 v57, v36, v37
    v_lshlrev_b32 v36, 16, v57
    v_and_b32 v37, 0xffff0000, v57
    v_mul_f32 v36, v36, v63
    v_mul_f32 v37, v37, v63
    v_cvt_pk_bf16_f32 v57, v36, v37
    v_lshlrev_b32 v36, 16, v57
    v_and_b32 v37, 0xffff0000, v57
    v_sub_f32 v38, v38, v62
    v_sub_f32 v39, v39, v62
    v_cvt_pk_bf16_f32 v57, v38, v39
    v_lshlrev_b32 v38, 16, v57
    v_and_b32 v39, 0xffff0000, v57
    v_mul_f32 v38, v38, v63
    v_mul_f32 v39, v39, v63
    v_cvt_pk_bf16_f32 v57, v38, v39
    v_lshlrev_b32 v38, 16, v57
    v_and_b32 v39, 0xffff0000, v57
    v_sub_f32 v40, v40, v62
    v_sub_f32 v41, v41, v62
    v_cvt_pk_bf16_f32 v57, v40, v41
    v_lshlrev_b32 v40, 16, v57
    v_and_b32 v41, 0xffff0000, v57
    v_mul_f32 v40, v40, v63
    v_mul_f32 v41, v41, v63
    v_cvt_pk_bf16_f32 v57, v40, v41
    v_lshlrev_b32 v40, 16, v57
    v_and_b32 v41, 0xffff0000, v57
    v_sub_f32 v42, v42, v62
    v_sub_f32 v43, v43, v62
    v_cvt_pk_bf16_f32 v57, v42, v43
    v_lshlrev_b32 v42, 16, v57
    v_and_b32 v43, 0xffff0000, v57
    v_mul_f32 v42, v42, v63
    v_mul_f32 v43, v43, v63
    v_cvt_pk_bf16_f32 v57, v42, v43
    v_lshlrev_b32 v42, 16, v57
    v_and_b32 v43, 0xffff0000, v57
    v_lshlrev_b32 v44, 16, v10
    v_and_b32 v45, 0xffff0000, v10
    v_lshlrev_b32 v46, 16, v11
    v_and_b32 v47, 0xffff0000, v11
    v_lshlrev_b32 v48, 16, v12
    v_and_b32 v49, 0xffff0000, v12
    v_lshlrev_b32 v50, 16, v13
    v_and_b32 v51, 0xffff0000, v13
    v_lshlrev_b32 v52, 16, v14
    v_and_b32 v53, 0xffff0000, v14
    v_lshlrev_b32 v54, 16, v15
    v_and_b32 v55, 0xffff0000, v15
    v_mul_f32 v32, v32, v44
    v_mul_f32 v33, v33, v45
    v_cvt_pk_bf16_f32 v57, v32, v33
    v_lshlrev_b32 v32, 16, v57
    v_and_b32 v33, 0xffff0000, v57
    v_add_f32 v20, v20, v32
    v_add_f32 v21, v21, v33
    v_cvt_pk_bf16_f32 v4, v20, v21
    v_lshlrev_b32 v20, 16, v4
    v_and_b32 v21, 0xffff0000, v4
    v_mul_f32 v34, v34, v46
    v_mul_f32 v35, v35, v47
    v_cvt_pk_bf16_f32 v57, v34, v35
    v_lshlrev_b32 v34, 16, v57
    v_and_b32 v35, 0xffff0000, v57
    v_add_f32 v22, v22, v34
    v_add_f32 v23, v23, v35
    v_cvt_pk_bf16_f32 v5, v22, v23
    v_lshlrev_b32 v22, 16, v5
    v_and_b32 v23, 0xffff0000, v5
    v_mul_f32 v36, v36, v48
    v_mul_f32 v37, v37, v49
    v_cvt_pk_bf16_f32 v57, v36, v37
    v_lshlrev_b32 v36, 16, v57
    v_and_b32 v37, 0xffff0000, v57
    v_add_f32 v24, v24, v36
    v_add_f32 v25, v25, v37
    v_cvt_pk_bf16_f32 v6, v24, v25
    v_lshlrev_b32 v24, 16, v6
    v_and_b32 v25, 0xffff0000, v6
    v_mul_f32 v38, v38, v50
    v_mul_f32 v39, v39, v51
    v_cvt_pk_bf16_f32 v57, v38, v39
    v_lshlrev_b32 v38, 16, v57
    v_and_b32 v39, 0xffff0000, v57
    v_add_f32 v26, v26, v38
    v_add_f32 v27, v27, v39
    v_cvt_pk_bf16_f32 v7, v26, v27
    v_lshlrev_b32 v26, 16, v7
    v_and_b32 v27, 0xffff0000, v7
    v_mul_f32 v40, v40, v52
    v_mul_f32 v41, v41, v53
    v_cvt_pk_bf16_f32 v57, v40, v41
    v_lshlrev_b32 v40, 16, v57
    v_and_b32 v41, 0xffff0000, v57
    v_add_f32 v28, v28, v40
    v_add_f32 v29, v29, v41
    v_cvt_pk_bf16_f32 v8, v28, v29
    v_lshlrev_b32 v28, 16, v8
    v_and_b32 v29, 0xffff0000, v8
    v_mul_f32 v42, v42, v54
    v_mul_f32 v43, v43, v55
    v_cvt_pk_bf16_f32 v57, v42, v43
    v_lshlrev_b32 v42, 16, v57
    v_and_b32 v43, 0xffff0000, v57
    v_add_f32 v30, v30, v42
    v_add_f32 v31, v31, v43
    v_cvt_pk_bf16_f32 v9, v30, v31
    v_lshlrev_b32 v30, 16, v9
    v_and_b32 v31, 0xffff0000, v9
    buffer_store_dwordx2 v[4:5], v1, s[16:19], 0 offen
    buffer_store_dwordx2 v[6:7], v1, s[16:19], 0 offen offset:512
    s_mov_b64 exec, s[30:31]
    buffer_store_dwordx2 v[8:9], v1, s[16:19], 0 offen offset:1024
    s_mov_b64 exec, -1
    v_add_f32 v62, v20, v21
    v_mul_f32 v63, v20, v20
    v_fmac_f32 v63, v21, v21
    v_add_f32 v62, v62, v22
    v_fmac_f32 v63, v22, v22
    v_add_f32 v62, v62, v23
    v_fmac_f32 v63, v23, v23
    v_add_f32 v62, v62, v24
    v_fmac_f32 v63, v24, v24
    v_add_f32 v62, v62, v25
    v_fmac_f32 v63, v25, v25
    v_add_f32 v62, v62, v26
    v_fmac_f32 v63, v26, v26
    v_add_f32 v62, v62, v27
    v_fmac_f32 v63, v27, v27
    v_add_f32 v62, v62, v28
    v_fmac_f32 v63, v28, v28
    v_add_f32 v62, v62, v29
    v_fmac_f32 v63, v29, v29
    v_add_f32 v62, v62, v30
    v_fmac_f32 v63, v30, v30
    v_add_f32 v62, v62, v31
    v_fmac_f32 v63, v31, v31
    s_nop 0
    s_nop 0
    v_add_f32_dpp v62, v62, v62 quad_perm:[1,0,3,2] row_mask:0xf bank_mask:0xf
    v_add_f32_dpp v63, v63, v63 quad_perm:[1,0,3,2] row_mask:0xf bank_mask:0xf
    s_nop 0
    v_add_f32_dpp v62, v62, v62 quad_perm:[2,3,0,1] row_mask:0xf bank_mask:0xf
    v_add_f32_dpp v63, v63, v63 quad_perm:[2,3,0,1] row_mask:0xf bank_mask:0xf
    s_nop 0
    v_add_f32_dpp v62, v62, v62 row_half_mirror row_mask:0xf bank_mask:0xf
    v_add_f32_dpp v63, v63, v63 row_half_mirror row_mask:0xf bank_mask:0xf
    s_nop 0
    v_add_f32_dpp v62, v62, v62 row_mirror row_mask:0xf bank_mask:0xf
    v_add_f32_dpp v63, v63, v63 row_mirror row_mask:0xf bank_mask:0xf
    s_nop 0
    v_readlane_b32 s32, v62, 0
    v_readlane_b32 s33, v62, 16
    v_readlane_b32 s34, v62, 32
    v_readlane_b32 s35, v62, 48
    v_readlane_b32 s36, v63, 0
    v_readlane_b32 s37, v63, 16
    v_readlane_b32 s38, v63, 32
    v_readlane_b32 s39, v63, 48
    v_mov_b32 v62, s32
    v_mov_b32 v63, s36
    v_add_f32 v62, s33, v62
    v_add_f32 v63, s37, v63
    v_add_f32 v62, s34, v62
    v_add_f32 v63, s38, v63
    v_add_f32 v62, s35, v62
    v_add_f32 v63, s39, v63
    v_mul_f32 v62, 0x3acccccd, v62
    v_mul_f32 v63, 0x3acccccd, v63
    v_fma_f32 v63, -v62, v62, v63
    v_max_f32 v63, 0, v63
    v_cvt_pk_bf16_f32 v57, v62, v63
    v_lshlrev_b32 v62, 16, v57
    v_and_b32 v63, 0xffff0000, v57
    v_add_f32 v63, 0x3727c5ac, v63
    v_cvt_pk_bf16_f32 v57, v63, v63
    v_lshlrev_b32 v63, 16, v57
    v_sqrt_f32 v63, v63
    s_nop 0
    v_cvt_pk_bf16_f32 v57, v63, v63
    v_lshlrev_b32 v63, 16, v57
    v_rcp_f32 v63, v63
    s_nop 0
    v_sub_f32 v20, v20, v62
    v_sub_f32 v21, v21, v62
    v_cvt_pk_bf16_f32 v57, v20, v21
    v_lshlrev_b32 v20, 16, v57
    v_and_b32 v21, 0xffff0000, v57
    v_mul_f32 v20, v20, v63
    v_mul_f32 v21, v21, v63
    v_cvt_pk_bf16_f32 v57, v20, v21
    v_lshlrev_b32 v20, 16, v57
    v_and_b32 v21, 0xffff0000, v57
    v_sub_f32 v22, v22, v62
    v_sub_f32 v23, v23, v62
    v_cvt_pk_bf16_f32 v57, v22, v23
    v_lshlrev_b32 v22, 16, v57
    v_and_b32 v23, 0xffff0000, v57
    v_mul_f32 v22, v22, v63
    v_mul_f32 v23, v23, v63
    v_cvt_pk_bf16_f32 v57, v22, v23
    v_lshlrev_b32 v22, 16, v57
    v_and_b32 v23, 0xffff0000, v57
    v_sub_f32 v24, v24, v62
    v_sub_f32 v25, v25, v62
    v_cvt_pk_bf16_f32 v57, v24, v25
    v_lshlrev_b32 v24, 16, v57
    v_and_b32 v25, 0xffff0000, v57
    v_mul_f32 v24, v24, v63
    v_mul_f32 v25, v25, v63
    v_cvt_pk_bf16_f32 v57, v24, v25
    v_lshlrev_b32 v24, 16, v57
    v_and_b32 v25, 0xffff0000, v57
    v_sub_f32 v26, v26, v62
    v_sub_f32 v27, v27, v62
    v_cvt_pk_bf16_f32 v57, v26, v27
    v_lshlrev_b32 v26, 16, v57
    v_and_b32 v27, 0xffff0000, v57
    v_mul_f32 v26, v26, v63
    v_mul_f32 v27, v27, v63
    v_cvt_pk_bf16_f32 v57, v26, v27
    v_lshlrev_b32 v26, 16, v57
    v_and_b32 v27, 0xffff0000, v57
    v_sub_f32 v28, v28, v62
    v_sub_f32 v29, v29, v62
    v_cvt_pk_bf16_f32 v57, v28, v29
    v_lshlrev_b32 v28, 16, v57
    v_and_b32 v29, 0xffff0000, v57
    v_mul_f32 v28, v28, v63
    v_mul_f32 v29, v29, v63
    v_cvt_pk_bf16_f32 v57, v28, v29
    v_lshlrev_b32 v28, 16, v57
    v_and_b32 v29, 0xffff0000, v57
    v_sub_f32 v30, v30, v62
    v_sub_f32 v31, v31, v62
    v_cvt_pk_bf16_f32 v57, v30, v31
    v_lshlrev_b32 v30, 16, v57
    v_and_b32 v31, 0xffff0000, v57
    v_mul_f32 v30, v30, v63
    v_mul_f32 v31, v31, v63
    v_cvt_pk_bf16_f32 v57, v30, v31
    v_lshlrev_b32 v30, 16, v57
    v_and_b32 v31, 0xffff0000, v57
    v_cvt_pk_bf16_f32 v10, v20, v21
    v_cvt_pk_bf16_f32 v11, v22, v23
    v_cvt_pk_bf16_f32 v12, v24, v25
    v_cvt_pk_bf16_f32 v13, v26, v27
    v_cvt_pk_bf16_f32 v14, v28, v29
    v_cvt_pk_bf16_f32 v15, v30, v31
    buffer_store_dwordx2 v[10:11], v1, s[20:23], 0 offen
    buffer_store_dwordx2 v[12:13], v1, s[20:23], 0 offen offset:512
    s_mov_b64 exec, s[30:31]
    buffer_store_dwordx2 v[14:15], v1, s[20:23], 0 offen offset:1024
Lend_10:
    s_endpgm
.p2align 8
.type e2_kernel,@function
e2_kernel:
    s_cmp_ge_u32 s2, 128
    s_cbranch_scc1 Lend_11
    s_load_dwordx2 s[4:5], s[0:1], 104
    s_waitcnt lgkmcnt(0)
    s_add_u32 s8, s4, 0x1832000
    s_addc_u32 s9, s5, 0
    s_mov_b32 s10, 0x280000
    s_mov_b32 s11, 0x00020000
    s_mov_b32 s12, s4
    s_mov_b32 s13, s5
    s_mov_b32 s14, 0x280000
    s_mov_b32 s15, 0x00020000
    s_add_u32 s16, s4, 0x1ab3000
    s_addc_u32 s17, s5, 0
    s_mov_b32 s18, 0x280000
    s_mov_b32 s19, 0x00020000
    s_add_u32 s20, s4, 0x82e000
    s_addc_u32 s21, s5, 0
    s_mov_b32 s22, 0x280000
    s_mov_b32 s23, 0x00020000
    v_lshrrev_b32 v1, 6, v0
    s_lshl_b32 s3, s2, 4
    v_add_u32 v1, s3, v1
    v_and_b32 v2, 63, v0
    v_mul_u32_u24 v1, 1280, v1
    v_lshl_add_u32 v1, v2, 3, v1
    v_cmp_gt_u32 vcc, 32, v2
    s_nop 1
    v_cndmask_b32 v58, 0, 1.0, vcc
    s_mov_b64 s[30:31], vcc
    v_mov_b32 v8, 0
    v_mov_b32 v9, 0
    v_mov_b32 v14, 0
    v_mov_b32 v15, 0
    v_lshrrev_b32 v3, 3, v0
    v_and_b32 v59, 7, v0
    v_lshlrev_b32 v60, 14, v3
    v_lshl_add_u32 v60, v59, 4, v60
    s_lshl_b32 s3, s2, 7
    buffer_load_dwordx4 v[16:19], v60, s[12:15], s3 offen
    v_cmp_gt_u32 vcc, 256, v0
    s_and_saveexec_b64 s[28:29], vcc
    v_add_u32 v60, 0x200000, v60
    buffer_load_dwordx4 v[44:47], v60, s[12:15], s3 offen
    s_mov_b64 exec, -1
    buffer_load_dwordx2 v[4:5], v1, s[8:11], 0 offen
    buffer_load_dwordx2 v[6:7], v1, s[8:11], 0 offen offset:512
    s_mov_b64 exec, s[30:31]
    buffer_load_dwordx2 v[8:9], v1, s[8:11], 0 offen offset:1024
    s_mov_b64 exec, -1
    v_mul_u32_u24 v3, 144, v3
    v_lshl_add_u32 v3, v59, 4, v3
    s_waitcnt vmcnt(3)
    ds_write_b128 v3, v[16:19]
    s_mov_b64 exec, s[28:29]
    v_cmp_gt_u32 vcc, 256, v0
    s_and_saveexec_b64 s[28:29], vcc
    ds_write_b128 v3, v[44:47] offset:18432
    s_mov_b64 exec, -1
    s_waitcnt lgkmcnt(0)
    s_barrier
    v_lshrrev_b32 v3, 6, v0
    v_lshlrev_b32 v3, 3, v3
    v_mul_u32_u24 v59, 144, v2
    v_add_u32 v3, v3, v59
    ds_read_b64 v[10:11], v3
    ds_read_b64 v[12:13], v3 offset:9216
    s_mov_b64 exec, s[30:31]
    ds_read_b64 v[14:15], v3 offset:18432
    s_mov_b64 exec, -1
    s_waitcnt vmcnt(0) lgkmcnt(0)
    v_lshlrev_b32 v20, 16, v4
    v_and_b32 v21, 0xffff0000, v4
    v_mov_b32 v32, v20
    v_mov_b32 v33, v21
    v_lshlrev_b32 v22, 16, v5
    v_and_b32 v23, 0xffff0000, v5
    v_mov_b32 v34, v22
    v_mov_b32 v35, v23
    v_lshlrev_b32 v24, 16, v6
    v_and_b32 v25, 0xffff0000, v6
    v_mov_b32 v36, v24
    v_mov_b32 v37, v25
    v_lshlrev_b32 v26, 16, v7
    v_and_b32 v27, 0xffff0000, v7
    v_mov_b32 v38, v26
    v_mov_b32 v39, v27
    v_lshlrev_b32 v28, 16, v8
    v_and_b32 v29, 0xffff0000, v8
    v_mov_b32 v40, v28
    v_mov_b32 v41, v29
    v_lshlrev_b32 v30, 16, v9
    v_and_b32 v31, 0xffff0000, v9
    v_mov_b32 v42, v30
    v_mov_b32 v43, v31
    v_add_f32 v62, v32, v33
    v_mul_f32 v63, v32, v32
    v_fmac_f32 v63, v33, v33
    v_add_f32 v62, v62, v34
    v_fmac_f32 v63, v34, v34
    v_add_f32 v62, v62, v35
    v_fmac_f32 v63, v35, v35
    v_add_f32 v62, v62, v36
    v_fmac_f32 v63, v36, v36
    v_add_f32 v62, v62, v37
    v_fmac_f32 v63, v37, v37
    v_add_f32 v62, v62, v38
    v_fmac_f32 v63, v38, v38
    v_add_f32 v62, v62, v39
    v_fmac_f32 v63, v39, v39
    v_add_f32 v62, v62, v40
    v_fmac_f32 v63, v40, v40
    v_add_f32 v62, v62, v41
    v_fmac_f32 v63, v41, v41
    v_add_f32 v62, v62, v42
    v_fmac_f32 v63, v42, v42
    v_add_f32 v62, v62, v43
    v_fmac_f32 v63, v43, v43
    s_nop 0
    s_nop 0
    v_add_f32_dpp v62, v62, v62 quad_perm:[1,0,3,2] row_mask:0xf bank_mask:0xf
    v_add_f32_dpp v63, v63, v63 quad_perm:[1,0,3,2] row_mask:0xf bank_mask:0xf
    s_nop 0
    v_add_f32_dpp v62, v62, v62 quad_perm:[2,3,0,1] row_mask:0xf bank_mask:0xf
    v_add_f32_dpp v63, v63, v63 quad_perm:[2,3,0,1] row_mask:0xf bank_mask:0xf
    s_nop 0
    v_add_f32_dpp v62, v62, v62 row_half_mirror row_mask:0xf bank_mask:0xf
    v_add_f32_dpp v63, v63, v63 row_half_mirror row_mask:0xf bank_mask:0xf
    s_nop 0
    v_add_f32_dpp v62, v62, v62 row_mirror row_mask:0xf bank_mask:0xf
    v_add_f32_dpp v63, v63, v63 row_mirror row_mask:0xf bank_mask:0xf
    s_nop 0
    v_readlane_b32 s32, v62, 0
    v_readlane_b32 s33, v62, 16
    v_readlane_b32 s34, v62, 32
    v_readlane_b32 s35, v62, 48
    v_readlane_b32 s36, v63, 0
    v_readlane_b32 s37, v63, 16
    v_readlane_b32 s38, v63, 32
    v_readlane_b32 s39, v63, 48
    v_mov_b32 v62, s32
    v_mov_b32 v63, s36
    v_add_f32 v62, s33, v62
    v_add_f32 v63, s37, v63
    v_add_f32 v62, s34, v62
    v_add_f32 v63, s38, v63
    v_add_f32 v62, s35, v62
    v_add_f32 v63, s39, v63
    v_mul_f32 v62, 0x3acccccd, v62
    v_mul_f32 v63, 0x3acccccd, v63
    v_fma_f32 v63, -v62, v62, v63
    v_max_f32 v63, 0, v63
    v_cvt_pk_bf16_f32 v57, v62, v63
    v_lshlrev_b32 v62, 16, v57
    v_and_b32 v63, 0xffff0000, v57
    v_add_f32 v63, 0x3727c5ac, v63
    v_cvt_pk_bf16_f32 v57, v63, v63
    v_lshlrev_b32 v63, 16, v57
    v_sqrt_f32 v63, v63
    s_nop 0
    v_cvt_pk_bf16_f32 v57, v63, v63
    v_lshlrev_b32 v63, 16, v57
    v_rcp_f32 v63, v63
    s_nop 0
    v_sub_f32 v32, v32, v62
    v_sub_f32 v33, v33, v62
    v_cvt_pk_bf16_f32 v57, v32, v33
    v_lshlrev_b32 v32, 16, v57
    v_and_b32 v33, 0xffff0000, v57
    v_mul_f32 v32, v32, v63
    v_mul_f32 v33, v33, v63
    v_cvt_pk_bf16_f32 v57, v32, v33
    v_lshlrev_b32 v32, 16, v57
    v_and_b32 v33, 0xffff0000, v57
    v_sub_f32 v34, v34, v62
    v_sub_f32 v35, v35, v62
    v_cvt_pk_bf16_f32 v57, v34, v35
    v_lshlrev_b32 v34, 16, v57
    v_and_b32 v35, 0xffff0000, v57
    v_mul_f32 v34, v34, v63
    v_mul_f32 v35, v35, v63
    v_cvt_pk_bf16_f32 v57, v34, v35
    v_lshlrev_b32 v34, 16, v57
    v_and_b32 v35, 0xffff0000, v57
    v_sub_f32 v36, v36, v62
    v_sub_f32 v37, v37, v62
    v_cvt_pk_bf16_f32 v57, v36, v37
    v_lshlrev_b32 v36, 16, v57
    v_and_b32 v37, 0xffff0000, v57
    v_mul_f32 v36, v36, v63
    v_mul_f32 v37, v37, v63
    v_cvt_pk_bf16_f32 v57, v36, v37
    v_lshlrev_b32 v36, 16, v57
    v_and_b32 v37, 0xffff0000, v57
    v_sub_f32 v38, v38, v62
    v_sub_f32 v39, v39, v62
    v_cvt_pk_bf16_f32 v57, v38, v39
    v_lshlrev_b32 v38, 16, v57
    v_and_b32 v39, 0xffff0000, v57
    v_mul_f32 v38, v38, v63
    v_mul_f32 v39, v39, v63
    v_cvt_pk_bf16_f32 v57, v38, v39
    v_lshlrev_b32 v38, 16, v57
    v_and_b32 v39, 0xffff0000, v57
    v_sub_f32 v40, v40, v62
    v_sub_f32 v41, v41, v62
    v_cvt_pk_bf16_f32 v57, v40, v41
    v_lshlrev_b32 v40, 16, v57
    v_and_b32 v41, 0xffff0000, v57
    v_mul_f32 v40, v40, v63
    v_mul_f32 v41, v41, v63
    v_cvt_pk_bf16_f32 v57, v40, v41
    v_lshlrev_b32 v40, 16, v57
    v_and_b32 v41, 0xffff0000, v57
    v_sub_f32 v42, v42, v62
    v_sub_f32 v43, v43, v62
    v_cvt_pk_bf16_f32 v57, v42, v43
    v_lshlrev_b32 v42, 16, v57
    v_and_b32 v43, 0xffff0000, v57
    v_mul_f32 v42, v42, v63
    v_mul_f32 v43, v43, v63
    v_cvt_pk_bf16_f32 v57, v42, v43
    v_lshlrev_b32 v42, 16, v57
    v_and_b32 v43, 0xffff0000, v57
    v_lshlrev_b32 v44, 16, v10
    v_and_b32 v45, 0xffff0000, v10
    v_lshlrev_b32 v46, 16, v11
    v_and_b32 v47, 0xffff0000, v11
    v_lshlrev_b32 v48, 16, v12
    v_and_b32 v49, 0xffff0000, v12
    v_lshlrev_b32 v50, 16, v13
    v_and_b32 v51, 0xffff0000, v13
    v_lshlrev_b32 v52, 16, v14
    v_and_b32 v53, 0xffff0000, v14
    v_lshlrev_b32 v54, 16, v15
    v_and_b32 v55, 0xffff0000, v15
    v_mul_f32 v32, v32, v44
    v_mul_f32 v33, v33, v45
    v_cvt_pk_bf16_f32 v57, v32, v33
    v_lshlrev_b32 v32, 16, v57
    v_and_b32 v33, 0xffff0000, v57
    v_add_f32 v20, v20, v32
    v_add_f32 v21, v21, v33
    v_cvt_pk_bf16_f32 v4, v20, v21
    v_lshlrev_b32 v20, 16, v4
    v_and_b32 v21, 0xffff0000, v4
    v_mul_f32 v34, v34, v46
    v_mul_f32 v35, v35, v47
    v_cvt_pk_bf16_f32 v57, v34, v35
    v_lshlrev_b32 v34, 16, v57
    v_and_b32 v35, 0xffff0000, v57
    v_add_f32 v22, v22, v34
    v_add_f32 v23, v23, v35
    v_cvt_pk_bf16_f32 v5, v22, v23
    v_lshlrev_b32 v22, 16, v5
    v_and_b32 v23, 0xffff0000, v5
    v_mul_f32 v36, v36, v48
    v_mul_f32 v37, v37, v49
    v_cvt_pk_bf16_f32 v57, v36, v37
    v_lshlrev_b32 v36, 16, v57
    v_and_b32 v37, 0xffff0000, v57
    v_add_f32 v24, v24, v36
    v_add_f32 v25, v25, v37
    v_cvt_pk_bf16_f32 v6, v24, v25
    v_lshlrev_b32 v24, 16, v6
    v_and_b32 v25, 0xffff0000, v6
    v_mul_f32 v38, v38, v50
    v_mul_f32 v39, v39, v51
    v_cvt_pk_bf16_f32 v57, v38, v39
    v_lshlrev_b32 v38, 16, v57
    v_and_b32 v39, 0xffff0000, v57
    v_add_f32 v26, v26, v38
    v_add_f32 v27, v27, v39
    v_cvt_pk_bf16_f32 v7, v26, v27
    v_lshlrev_b32 v26, 16, v7
    v_and_b32 v27, 0xffff0000, v7
    v_mul_f32 v40, v40, v52
    v_mul_f32 v41, v41, v53
    v_cvt_pk_bf16_f32 v57, v40, v41
    v_lshlrev_b32 v40, 16, v57
    v_and_b32 v41, 0xffff0000, v57
    v_add_f32 v28, v28, v40
    v_add_f32 v29, v29, v41
    v_cvt_pk_bf16_f32 v8, v28, v29
    v_lshlrev_b32 v28, 16, v8
    v_and_b32 v29, 0xffff0000, v8
    v_mul_f32 v42, v42, v54
    v_mul_f32 v43, v43, v55
    v_cvt_pk_bf16_f32 v57, v42, v43
    v_lshlrev_b32 v42, 16, v57
    v_and_b32 v43, 0xffff0000, v57
    v_add_f32 v30, v30, v42
    v_add_f32 v31, v31, v43
    v_cvt_pk_bf16_f32 v9, v30, v31
    v_lshlrev_b32 v30, 16, v9
    v_and_b32 v31, 0xffff0000, v9
    buffer_store_dwordx2 v[4:5], v1, s[16:19], 0 offen
    buffer_store_dwordx2 v[6:7], v1, s[16:19], 0 offen offset:512
    s_mov_b64 exec, s[30:31]
    buffer_store_dwordx2 v[8:9], v1, s[16:19], 0 offen offset:1024
    s_mov_b64 exec, -1
    v_add_f32 v62, v20, v21
    v_mul_f32 v63, v20, v20
    v_fmac_f32 v63, v21, v21
    v_add_f32 v62, v62, v22
    v_fmac_f32 v63, v22, v22
    v_add_f32 v62, v62, v23
    v_fmac_f32 v63, v23, v23
    v_add_f32 v62, v62, v24
    v_fmac_f32 v63, v24, v24
    v_add_f32 v62, v62, v25
    v_fmac_f32 v63, v25, v25
    v_add_f32 v62, v62, v26
    v_fmac_f32 v63, v26, v26
    v_add_f32 v62, v62, v27
    v_fmac_f32 v63, v27, v27
    v_add_f32 v62, v62, v28
    v_fmac_f32 v63, v28, v28
    v_add_f32 v62, v62, v29
    v_fmac_f32 v63, v29, v29
    v_add_f32 v62, v62, v30
    v_fmac_f32 v63, v30, v30
    v_add_f32 v62, v62, v31
    v_fmac_f32 v63, v31, v31
    s_nop 0
    s_nop 0
    v_add_f32_dpp v62, v62, v62 quad_perm:[1,0,3,2] row_mask:0xf bank_mask:0xf
    v_add_f32_dpp v63, v63, v63 quad_perm:[1,0,3,2] row_mask:0xf bank_mask:0xf
    s_nop 0
    v_add_f32_dpp v62, v62, v62 quad_perm:[2,3,0,1] row_mask:0xf bank_mask:0xf
    v_add_f32_dpp v63, v63, v63 quad_perm:[2,3,0,1] row_mask:0xf bank_mask:0xf
    s_nop 0
    v_add_f32_dpp v62, v62, v62 row_half_mirror row_mask:0xf bank_mask:0xf
    v_add_f32_dpp v63, v63, v63 row_half_mirror row_mask:0xf bank_mask:0xf
    s_nop 0
    v_add_f32_dpp v62, v62, v62 row_mirror row_mask:0xf bank_mask:0xf
    v_add_f32_dpp v63, v63, v63 row_mirror row_mask:0xf bank_mask:0xf
    s_nop 0
    v_readlane_b32 s32, v62, 0
    v_readlane_b32 s33, v62, 16
    v_readlane_b32 s34, v62, 32
    v_readlane_b32 s35, v62, 48
    v_readlane_b32 s36, v63, 0
    v_readlane_b32 s37, v63, 16
    v_readlane_b32 s38, v63, 32
    v_readlane_b32 s39, v63, 48
    v_mov_b32 v62, s32
    v_mov_b32 v63, s36
    v_add_f32 v62, s33, v62
    v_add_f32 v63, s37, v63
    v_add_f32 v62, s34, v62
    v_add_f32 v63, s38, v63
    v_add_f32 v62, s35, v62
    v_add_f32 v63, s39, v63
    v_mul_f32 v62, 0x3acccccd, v62
    v_mul_f32 v63, 0x3acccccd, v63
    v_fma_f32 v63, -v62, v62, v63
    v_max_f32 v63, 0, v63
    v_cvt_pk_bf16_f32 v57, v62, v63
    v_lshlrev_b32 v62, 16, v57
    v_and_b32 v63, 0xffff0000, v57
    v_add_f32 v63, 0x3727c5ac, v63
    v_cvt_pk_bf16_f32 v57, v63, v63
    v_lshlrev_b32 v63, 16, v57
    v_sqrt_f32 v63, v63
    s_nop 0
    v_cvt_pk_bf16_f32 v57, v63, v63
    v_lshlrev_b32 v63, 16, v57
    v_rcp_f32 v63, v63
    s_nop 0
    v_sub_f32 v20, v20, v62
    v_sub_f32 v21, v21, v62
    v_cvt_pk_bf16_f32 v57, v20, v21
    v_lshlrev_b32 v20, 16, v57
    v_and_b32 v21, 0xffff0000, v57
    v_mul_f32 v20, v20, v63
    v_mul_f32 v21, v21, v63
    v_cvt_pk_bf16_f32 v57, v20, v21
    v_lshlrev_b32 v20, 16, v57
    v_and_b32 v21, 0xffff0000, v57
    v_sub_f32 v22, v22, v62
    v_sub_f32 v23, v23, v62
    v_cvt_pk_bf16_f32 v57, v22, v23
    v_lshlrev_b32 v22, 16, v57
    v_and_b32 v23, 0xffff0000, v57
    v_mul_f32 v22, v22, v63
    v_mul_f32 v23, v23, v63
    v_cvt_pk_bf16_f32 v57, v22, v23
    v_lshlrev_b32 v22, 16, v57
    v_and_b32 v23, 0xffff0000, v57
    v_sub_f32 v24, v24, v62
    v_sub_f32 v25, v25, v62
    v_cvt_pk_bf16_f32 v57, v24, v25
    v_lshlrev_b32 v24, 16, v57
    v_and_b32 v25, 0xffff0000, v57
    v_mul_f32 v24, v24, v63
    v_mul_f32 v25, v25, v63
    v_cvt_pk_bf16_f32 v57, v24, v25
    v_lshlrev_b32 v24, 16, v57
    v_and_b32 v25, 0xffff0000, v57
    v_sub_f32 v26, v26, v62
    v_sub_f32 v27, v27, v62
    v_cvt_pk_bf16_f32 v57, v26, v27
    v_lshlrev_b32 v26, 16, v57
    v_and_b32 v27, 0xffff0000, v57
    v_mul_f32 v26, v26, v63
    v_mul_f32 v27, v27, v63
    v_cvt_pk_bf16_f32 v57, v26, v27
    v_lshlrev_b32 v26, 16, v57
    v_and_b32 v27, 0xffff0000, v57
    v_sub_f32 v28, v28, v62
    v_sub_f32 v29, v29, v62
    v_cvt_pk_bf16_f32 v57, v28, v29
    v_lshlrev_b32 v28, 16, v57
    v_and_b32 v29, 0xffff0000, v57
    v_mul_f32 v28, v28, v63
    v_mul_f32 v29, v29, v63
    v_cvt_pk_bf16_f32 v57, v28, v29
    v_lshlrev_b32 v28, 16, v57
    v_and_b32 v29, 0xffff0000, v57
    v_sub_f32 v30, v30, v62
    v_sub_f32 v31, v31, v62
    v_cvt_pk_bf16_f32 v57, v30, v31
    v_lshlrev_b32 v30, 16, v57
    v_and_b32 v31, 0xffff0000, v57
    v_mul_f32 v30, v30, v63
    v_mul_f32 v31, v31, v63
    v_cvt_pk_bf16_f32 v57, v30, v31
    v_lshlrev_b32 v30, 16, v57
    v_and_b32 v31, 0xffff0000, v57
    v_cvt_pk_bf16_f32 v10, v20, v21
    v_cvt_pk_bf16_f32 v11, v22, v23
    v_cvt_pk_bf16_f32 v12, v24, v25
    v_cvt_pk_bf16_f32 v13, v26, v27
    v_cvt_pk_bf16_f32 v14, v28, v29
    v_cvt_pk_bf16_f32 v15, v30, v31
    buffer_store_dwordx2 v[10:11], v1, s[20:23], 0 offen
    buffer_store_dwordx2 v[12:13], v1, s[20:23], 0 offen offset:512
    s_mov_b64 exec, s[30:31]
    buffer_store_dwordx2 v[14:15], v1, s[20:23], 0 offen offset:1024
Lend_11:
    s_endpgm
.p2align 8
.type g1_kernel,@function
g1_kernel:
    s_cmp_ge_u32 s2, 256
    s_cbranch_scc1 Lend_12
    s_load_dwordx2 s[4:5], s[0:1], 104
    s_and_b32 s40, s2, 7
    s_lshr_b32 s41, s2, 3
    s_and_b32 s42, s40, 3
    s_lshr_b32 s43, s40, 2
    s_mov_b32 s45, 0x40000001
    s_mul_hi_u32 s46, s41, s45
    s_mul_i32 s45, s46, 4
    s_sub_u32 s45, s41, s45
    s_mul_i32 s42, s42, 4
    s_add_u32 s42, s42, s45
    s_mul_i32 s43, s43, 8
    s_add_u32 s43, s43, s46
    s_cmp_ge_u32 s42, 16
    s_cbranch_scc1 Lend_12
    s_mov_b32 s39, s42
    s_mul_i32 s42, s42, 112
    s_lshr_b32 s37, s39, 3
    s_and_b32 s39, s39, 7
    s_mul_i32 s42, s39, 112
    s_mul_i32 s37, s37, 864
    s_add_u32 s42, s42, s37
    s_sub_u32 s38, s39, 6
    s_max_i32 s38, s38, 0
    s_lshl_b32 s38, s38, 4
    s_sub_u32 s42, s42, s38
    s_mul_i32 s43, s43, 128
    v_lshrrev_b32 v1, 6, v0
    s_nop 0
    v_readfirstlane_b32 s44, v1
    v_and_b32 v2, 63, v0
    v_lshrrev_b32 v5, 4, v2
    s_waitcnt lgkmcnt(0)
    s_cmp_ge_u32 s44, 8
    s_cbranch_scc1 Lpf_15
    s_cmp_ge_u32 s44, 4
    s_cbranch_scc1 Lload_13
    v_and_b32 v3, 15, v2
    v_lshrrev_b32 v4, 1, v3
    v_and_b32 v4, 7, v4
    v_xor_b32 v4, v4, v5
    v_lshlrev_b32 v4, 4, v4
    v_lshl_add_u32 v4, v3, 7, v4
    s_and_b32 s45, s44, 0
    s_lshr_b32 s46, s44, 0
    s_mul_i32 s47, s45, 14336
    s_mul_i32 s48, s46, 4096
    s_add_u32 s48, s48, 14336
    v_add_u32 v8, s47, v4
    v_add_u32 v9, s47, v4
    v_add_u32 v9, 61440, v9
    v_add_u32 v10, s47, v4
    v_add_u32 v10, 122880, v10
    v_add_u32 v11, s47, v4
    v_xor_b32 v11, 64, v11
    v_add_u32 v12, s47, v4
    v_xor_b32 v12, 64, v12
    v_add_u32 v12, 61440, v12
    v_add_u32 v13, s47, v4
    v_xor_b32 v13, 64, v13
    v_add_u32 v13, 122880, v13
    v_add_u32 v14, s48, v4
    v_add_u32 v15, s48, v4
    v_add_u32 v15, 61440, v15
    v_add_u32 v16, s48, v4
    v_add_u32 v16, 122880, v16
    v_add_u32 v17, s48, v4
    v_xor_b32 v17, 64, v17
    v_add_u32 v18, s48, v4
    v_xor_b32 v18, 64, v18
    v_add_u32 v18, 61440, v18
    v_add_u32 v19, s48, v4
    v_xor_b32 v19, 64, v19
    v_add_u32 v19, 122880, v19
    v_mov_b32 v92, 0
    v_mov_b32 v93, 0
    v_mov_b32 v94, 0
    v_mov_b32 v95, 0
    v_mov_b32 v96, 0
    v_mov_b32 v97, 0
    v_mov_b32 v98, 0
    v_mov_b32 v99, 0
    v_mov_b32 v100, 0
    v_mov_b32 v101, 0
    v_mov_b32 v102, 0
    v_mov_b32 v103, 0
    v_mov_b32 v104, 0
    v_mov_b32 v105, 0
    v_mov_b32 v106, 0
    v_mov_b32 v107, 0
    v_mov_b32 v108, 0
    v_mov_b32 v109, 0
    v_mov_b32 v110, 0
    v_mov_b32 v111, 0
    v_mov_b32 v112, 0
    v_mov_b32 v113, 0
    v_mov_b32 v114, 0
    v_mov_b32 v115, 0
    v_mov_b32 v116, 0
    v_mov_b32 v117, 0
    v_mov_b32 v118, 0
    v_mov_b32 v119, 0
    v_mov_b32 v120, 0
    v_mov_b32 v121, 0
    v_mov_b32 v122, 0
    v_mov_b32 v123, 0
    v_mov_b32 v124, 0
    v_mov_b32 v125, 0
    v_mov_b32 v126, 0
    v_mov_b32 v127, 0
    v_mov_b32 v128, 0
    v_mov_b32 v129, 0
    v_mov_b32 v130, 0
    v_mov_b32 v131, 0
    v_mov_b32 v132, 0
    v_mov_b32 v133, 0
    v_mov_b32 v134, 0
    v_mov_b32 v135, 0
    v_mov_b32 v136, 0
    v_mov_b32 v137, 0
    v_mov_b32 v138, 0
    v_mov_b32 v139, 0
    v_mov_b32 v140, 0
    v_mov_b32 v141, 0
    v_mov_b32 v142, 0
    v_mov_b32 v143, 0
    v_mov_b32 v144, 0
    v_mov_b32 v145, 0
    v_mov_b32 v146, 0
    v_mov_b32 v147, 0
    v_and_b32 v3, 15, v2
    s_mul_i32 s47, s46, 32
    s_add_u32 s47, s47, s43
    v_add_u32 v3, s47, v3
    v_lshrrev_b32 v4, 4, v2
    v_lshlrev_b32 v4, 2, v4
    s_mul_i32 s47, s45, 112
    s_add_u32 s47, s47, s42
    v_add_u32 v4, s47, v4
    s_barrier
    ds_read_b128 v[20:23], v8 offset:0
    ds_read_b128 v[76:79], v14 offset:0
    ds_read_b128 v[80:83], v14 offset:2048
    ds_read_b128 v[24:27], v8 offset:2048
    ds_read_b128 v[28:31], v8 offset:4096
    ds_read_b128 v[32:35], v8 offset:6144
    ds_read_b128 v[36:39], v8 offset:8192
    ds_read_b128 v[40:43], v8 offset:10240
    ds_read_b128 v[44:47], v8 offset:12288
    ds_read_b128 v[48:51], v11 offset:0
    ds_read_b128 v[84:87], v17 offset:0
    ds_read_b128 v[88:91], v17 offset:2048
    ds_read_b128 v[52:55], v11 offset:2048
    ds_read_b128 v[56:59], v11 offset:4096
    ds_read_b128 v[60:63], v11 offset:6144
    ds_read_b128 v[64:67], v11 offset:8192
    ds_read_b128 v[68:71], v11 offset:10240
    ds_read_b128 v[72:75], v11 offset:12288
    s_waitcnt lgkmcnt(9)
    v_mfma_f32_16x16x32_bf16 v[92:95], v[20:23], v[76:79], v[92:95]
    v_mfma_f32_16x16x32_bf16 v[96:99], v[20:23], v[80:83], v[96:99]
    v_mfma_f32_16x16x32_bf16 v[100:103], v[24:27], v[76:79], v[100:103]
    v_mfma_f32_16x16x32_bf16 v[104:107], v[24:27], v[80:83], v[104:107]
    v_mfma_f32_16x16x32_bf16 v[108:111], v[28:31], v[76:79], v[108:111]
    v_mfma_f32_16x16x32_bf16 v[112:115], v[28:31], v[80:83], v[112:115]
    v_mfma_f32_16x16x32_bf16 v[116:119], v[32:35], v[76:79], v[116:119]
    v_mfma_f32_16x16x32_bf16 v[120:123], v[32:35], v[80:83], v[120:123]
    v_mfma_f32_16x16x32_bf16 v[124:127], v[36:39], v[76:79], v[124:127]
    v_mfma_f32_16x16x32_bf16 v[128:131], v[36:39], v[80:83], v[128:131]
    v_mfma_f32_16x16x32_bf16 v[132:135], v[40:43], v[76:79], v[132:135]
    v_mfma_f32_16x16x32_bf16 v[136:139], v[40:43], v[80:83], v[136:139]
    v_mfma_f32_16x16x32_bf16 v[140:143], v[44:47], v[76:79], v[140:143]
    v_mfma_f32_16x16x32_bf16 v[144:147], v[44:47], v[80:83], v[144:147]
    s_waitcnt lgkmcnt(0)
    s_barrier
    ds_read_b128 v[20:23], v8 offset:30720
    ds_read_b128 v[76:79], v14 offset:30720
    ds_read_b128 v[80:83], v14 offset:32768
    ds_read_b128 v[24:27], v8 offset:32768
    ds_read_b128 v[28:31], v8 offset:34816
    ds_read_b128 v[32:35], v8 offset:36864
    ds_read_b128 v[36:39], v8 offset:38912
    ds_read_b128 v[40:43], v8 offset:40960
    ds_read_b128 v[44:47], v8 offset:43008
    v_mfma_f32_16x16x32_bf16 v[92:95], v[48:51], v[84:87], v[92:95]
    v_mfma_f32_16x16x32_bf16 v[96:99], v[48:51], v[88:91], v[96:99]
    v_mfma_f32_16x16x32_bf16 v[100:103], v[52:55], v[84:87], v[100:103]
    v_mfma_f32_16x16x32_bf16 v[104:107], v[52:55], v[88:91], v[104:107]
    v_mfma_f32_16x16x32_bf16 v[108:111], v[56:59], v[84:87], v[108:111]
    v_mfma_f32_16x16x32_bf16 v[112:115], v[56:59], v[88:91], v[112:115]
    v_mfma_f32_16x16x32_bf16 v[116:119], v[60:63], v[84:87], v[116:119]
    v_mfma_f32_16x16x32_bf16 v[120:123], v[60:63], v[88:91], v[120:123]
    v_mfma_f32_16x16x32_bf16 v[124:127], v[64:67], v[84:87], v[124:127]
    v_mfma_f32_16x16x32_bf16 v[128:131], v[64:67], v[88:91], v[128:131]
    v_mfma_f32_16x16x32_bf16 v[132:135], v[68:71], v[84:87], v[132:135]
    v_mfma_f32_16x16x32_bf16 v[136:139], v[68:71], v[88:91], v[136:139]
    v_mfma_f32_16x16x32_bf16 v[140:143], v[72:75], v[84:87], v[140:143]
    v_mfma_f32_16x16x32_bf16 v[144:147], v[72:75], v[88:91], v[144:147]
    ds_read_b128 v[48:51], v11 offset:30720
    ds_read_b128 v[84:87], v17 offset:30720
    ds_read_b128 v[88:91], v17 offset:32768
    ds_read_b128 v[52:55], v11 offset:32768
    ds_read_b128 v[56:59], v11 offset:34816
    ds_read_b128 v[60:63], v11 offset:36864
    ds_read_b128 v[64:67], v11 offset:38912
    ds_read_b128 v[68:71], v11 offset:40960
    ds_read_b128 v[72:75], v11 offset:43008
    s_waitcnt lgkmcnt(9)
    v_mfma_f32_16x16x32_bf16 v[92:95], v[20:23], v[76:79], v[92:95]
    v_mfma_f32_16x16x32_bf16 v[96:99], v[20:23], v[80:83], v[96:99]
    v_mfma_f32_16x16x32_bf16 v[100:103], v[24:27], v[76:79], v[100:103]
    v_mfma_f32_16x16x32_bf16 v[104:107], v[24:27], v[80:83], v[104:107]
    v_mfma_f32_16x16x32_bf16 v[108:111], v[28:31], v[76:79], v[108:111]
    v_mfma_f32_16x16x32_bf16 v[112:115], v[28:31], v[80:83], v[112:115]
    v_mfma_f32_16x16x32_bf16 v[116:119], v[32:35], v[76:79], v[116:119]
    v_mfma_f32_16x16x32_bf16 v[120:123], v[32:35], v[80:83], v[120:123]
    v_mfma_f32_16x16x32_bf16 v[124:127], v[36:39], v[76:79], v[124:127]
    v_mfma_f32_16x16x32_bf16 v[128:131], v[36:39], v[80:83], v[128:131]
    v_mfma_f32_16x16x32_bf16 v[132:135], v[40:43], v[76:79], v[132:135]
    v_mfma_f32_16x16x32_bf16 v[136:139], v[40:43], v[80:83], v[136:139]
    v_mfma_f32_16x16x32_bf16 v[140:143], v[44:47], v[76:79], v[140:143]
    v_mfma_f32_16x16x32_bf16 v[144:147], v[44:47], v[80:83], v[144:147]
    s_waitcnt lgkmcnt(0)
    s_barrier
    ds_read_b128 v[20:23], v9 offset:0
    ds_read_b128 v[76:79], v15 offset:0
    ds_read_b128 v[80:83], v15 offset:2048
    ds_read_b128 v[24:27], v9 offset:2048
    ds_read_b128 v[28:31], v9 offset:4096
    ds_read_b128 v[32:35], v9 offset:6144
    ds_read_b128 v[36:39], v9 offset:8192
    ds_read_b128 v[40:43], v9 offset:10240
    ds_read_b128 v[44:47], v9 offset:12288
    v_mfma_f32_16x16x32_bf16 v[92:95], v[48:51], v[84:87], v[92:95]
    v_mfma_f32_16x16x32_bf16 v[96:99], v[48:51], v[88:91], v[96:99]
    v_mfma_f32_16x16x32_bf16 v[100:103], v[52:55], v[84:87], v[100:103]
    v_mfma_f32_16x16x32_bf16 v[104:107], v[52:55], v[88:91], v[104:107]
    v_mfma_f32_16x16x32_bf16 v[108:111], v[56:59], v[84:87], v[108:111]
    v_mfma_f32_16x16x32_bf16 v[112:115], v[56:59], v[88:91], v[112:115]
    v_mfma_f32_16x16x32_bf16 v[116:119], v[60:63], v[84:87], v[116:119]
    v_mfma_f32_16x16x32_bf16 v[120:123], v[60:63], v[88:91], v[120:123]
    v_mfma_f32_16x16x32_bf16 v[124:127], v[64:67], v[84:87], v[124:127]
    v_mfma_f32_16x16x32_bf16 v[128:131], v[64:67], v[88:91], v[128:131]
    v_mfma_f32_16x16x32_bf16 v[132:135], v[68:71], v[84:87], v[132:135]
    v_mfma_f32_16x16x32_bf16 v[136:139], v[68:71], v[88:91], v[136:139]
    v_mfma_f32_16x16x32_bf16 v[140:143], v[72:75], v[84:87], v[140:143]
    v_mfma_f32_16x16x32_bf16 v[144:147], v[72:75], v[88:91], v[144:147]
    ds_read_b128 v[48:51], v12 offset:0
    ds_read_b128 v[84:87], v18 offset:0
    ds_read_b128 v[88:91], v18 offset:2048
    ds_read_b128 v[52:55], v12 offset:2048
    ds_read_b128 v[56:59], v12 offset:4096
    ds_read_b128 v[60:63], v12 offset:6144
    ds_read_b128 v[64:67], v12 offset:8192
    ds_read_b128 v[68:71], v12 offset:10240
    ds_read_b128 v[72:75], v12 offset:12288
    s_waitcnt lgkmcnt(9)
    v_mfma_f32_16x16x32_bf16 v[92:95], v[20:23], v[76:79], v[92:95]
    v_mfma_f32_16x16x32_bf16 v[96:99], v[20:23], v[80:83], v[96:99]
    v_mfma_f32_16x16x32_bf16 v[100:103], v[24:27], v[76:79], v[100:103]
    v_mfma_f32_16x16x32_bf16 v[104:107], v[24:27], v[80:83], v[104:107]
    v_mfma_f32_16x16x32_bf16 v[108:111], v[28:31], v[76:79], v[108:111]
    v_mfma_f32_16x16x32_bf16 v[112:115], v[28:31], v[80:83], v[112:115]
    v_mfma_f32_16x16x32_bf16 v[116:119], v[32:35], v[76:79], v[116:119]
    v_mfma_f32_16x16x32_bf16 v[120:123], v[32:35], v[80:83], v[120:123]
    v_mfma_f32_16x16x32_bf16 v[124:127], v[36:39], v[76:79], v[124:127]
    v_mfma_f32_16x16x32_bf16 v[128:131], v[36:39], v[80:83], v[128:131]
    v_mfma_f32_16x16x32_bf16 v[132:135], v[40:43], v[76:79], v[132:135]
    v_mfma_f32_16x16x32_bf16 v[136:139], v[40:43], v[80:83], v[136:139]
    v_mfma_f32_16x16x32_bf16 v[140:143], v[44:47], v[76:79], v[140:143]
    v_mfma_f32_16x16x32_bf16 v[144:147], v[44:47], v[80:83], v[144:147]
    s_waitcnt lgkmcnt(0)
    s_barrier
    ds_read_b128 v[20:23], v9 offset:30720
    ds_read_b128 v[76:79], v15 offset:30720
    ds_read_b128 v[80:83], v15 offset:32768
    ds_read_b128 v[24:27], v9 offset:32768
    ds_read_b128 v[28:31], v9 offset:34816
    ds_read_b128 v[32:35], v9 offset:36864
    ds_read_b128 v[36:39], v9 offset:38912
    ds_read_b128 v[40:43], v9 offset:40960
    ds_read_b128 v[44:47], v9 offset:43008
    s_add_u32 s24, s4, 0xaaf000
    s_addc_u32 s25, s5, 0
    s_mov_b32 s26, 0x6c0000
    s_mov_b32 s27, 0x00020000
    v_mul_u32_u24 v5, 3456, v3
    v_lshl_add_u32 v5, v4, 1, v5
    v_mfma_f32_16x16x32_bf16 v[92:95], v[48:51], v[84:87], v[92:95]
    v_mfma_f32_16x16x32_bf16 v[96:99], v[48:51], v[88:91], v[96:99]
    v_mfma_f32_16x16x32_bf16 v[100:103], v[52:55], v[84:87], v[100:103]
    v_mfma_f32_16x16x32_bf16 v[104:107], v[52:55], v[88:91], v[104:107]
    v_mfma_f32_16x16x32_bf16 v[108:111], v[56:59], v[84:87], v[108:111]
    v_mfma_f32_16x16x32_bf16 v[112:115], v[56:59], v[88:91], v[112:115]
    v_mfma_f32_16x16x32_bf16 v[116:119], v[60:63], v[84:87], v[116:119]
    v_mfma_f32_16x16x32_bf16 v[120:123], v[60:63], v[88:91], v[120:123]
    v_mfma_f32_16x16x32_bf16 v[124:127], v[64:67], v[84:87], v[124:127]
    v_mfma_f32_16x16x32_bf16 v[128:131], v[64:67], v[88:91], v[128:131]
    v_mfma_f32_16x16x32_bf16 v[132:135], v[68:71], v[84:87], v[132:135]
    v_mfma_f32_16x16x32_bf16 v[136:139], v[68:71], v[88:91], v[136:139]
    v_mfma_f32_16x16x32_bf16 v[140:143], v[72:75], v[84:87], v[140:143]
    v_mfma_f32_16x16x32_bf16 v[144:147], v[72:75], v[88:91], v[144:147]
    ds_read_b128 v[48:51], v12 offset:30720
    ds_read_b128 v[84:87], v18 offset:30720
    ds_read_b128 v[88:91], v18 offset:32768
    ds_read_b128 v[52:55], v12 offset:32768
    ds_read_b128 v[56:59], v12 offset:34816
    ds_read_b128 v[60:63], v12 offset:36864
    ds_read_b128 v[64:67], v12 offset:38912
    ds_read_b128 v[68:71], v12 offset:40960
    ds_read_b128 v[72:75], v12 offset:43008
    s_waitcnt lgkmcnt(9)
    v_mfma_f32_16x16x32_bf16 v[92:95], v[20:23], v[76:79], v[92:95]
    v_mfma_f32_16x16x32_bf16 v[96:99], v[20:23], v[80:83], v[96:99]
    v_mfma_f32_16x16x32_bf16 v[100:103], v[24:27], v[76:79], v[100:103]
    v_mfma_f32_16x16x32_bf16 v[104:107], v[24:27], v[80:83], v[104:107]
    v_mfma_f32_16x16x32_bf16 v[108:111], v[28:31], v[76:79], v[108:111]
    v_mfma_f32_16x16x32_bf16 v[112:115], v[28:31], v[80:83], v[112:115]
    v_mfma_f32_16x16x32_bf16 v[116:119], v[32:35], v[76:79], v[116:119]
    v_mfma_f32_16x16x32_bf16 v[120:123], v[32:35], v[80:83], v[120:123]
    v_mfma_f32_16x16x32_bf16 v[124:127], v[36:39], v[76:79], v[124:127]
    v_mfma_f32_16x16x32_bf16 v[128:131], v[36:39], v[80:83], v[128:131]
    v_mfma_f32_16x16x32_bf16 v[132:135], v[40:43], v[76:79], v[132:135]
    v_mfma_f32_16x16x32_bf16 v[136:139], v[40:43], v[80:83], v[136:139]
    v_mfma_f32_16x16x32_bf16 v[140:143], v[44:47], v[76:79], v[140:143]
    v_mfma_f32_16x16x32_bf16 v[144:147], v[44:47], v[80:83], v[144:147]
    s_waitcnt lgkmcnt(0)
    s_barrier
    ds_read_b128 v[20:23], v10 offset:0
    ds_read_b128 v[76:79], v16 offset:0
    ds_read_b128 v[80:83], v16 offset:2048
    ds_read_b128 v[24:27], v10 offset:2048
    ds_read_b128 v[28:31], v10 offset:4096
    ds_read_b128 v[32:35], v10 offset:6144
    ds_read_b128 v[36:39], v10 offset:8192
    ds_read_b128 v[40:43], v10 offset:10240
    ds_read_b128 v[44:47], v10 offset:12288
    v_mfma_f32_16x16x32_bf16 v[92:95], v[48:51], v[84:87], v[92:95]
    v_mfma_f32_16x16x32_bf16 v[96:99], v[48:51], v[88:91], v[96:99]
    v_mfma_f32_16x16x32_bf16 v[100:103], v[52:55], v[84:87], v[100:103]
    v_mfma_f32_16x16x32_bf16 v[104:107], v[52:55], v[88:91], v[104:107]
    v_mfma_f32_16x16x32_bf16 v[108:111], v[56:59], v[84:87], v[108:111]
    v_mfma_f32_16x16x32_bf16 v[112:115], v[56:59], v[88:91], v[112:115]
    v_mfma_f32_16x16x32_bf16 v[116:119], v[60:63], v[84:87], v[116:119]
    v_mfma_f32_16x16x32_bf16 v[120:123], v[60:63], v[88:91], v[120:123]
    v_mfma_f32_16x16x32_bf16 v[124:127], v[64:67], v[84:87], v[124:127]
    v_mfma_f32_16x16x32_bf16 v[128:131], v[64:67], v[88:91], v[128:131]
    v_mfma_f32_16x16x32_bf16 v[132:135], v[68:71], v[84:87], v[132:135]
    v_mfma_f32_16x16x32_bf16 v[136:139], v[68:71], v[88:91], v[136:139]
    v_mfma_f32_16x16x32_bf16 v[140:143], v[72:75], v[84:87], v[140:143]
    v_mfma_f32_16x16x32_bf16 v[144:147], v[72:75], v[88:91], v[144:147]
    ds_read_b128 v[48:51], v13 offset:0
    ds_read_b128 v[84:87], v19 offset:0
    ds_read_b128 v[88:91], v19 offset:2048
    ds_read_b128 v[52:55], v13 offset:2048
    ds_read_b128 v[56:59], v13 offset:4096
    ds_read_b128 v[60:63], v13 offset:6144
    ds_read_b128 v[64:67], v13 offset:8192
    ds_read_b128 v[68:71], v13 offset:10240
    ds_read_b128 v[72:75], v13 offset:12288
    s_waitcnt lgkmcnt(9)
    v_mfma_f32_16x16x32_bf16 v[92:95], v[20:23], v[76:79], v[92:95]
    v_mfma_f32_16x16x32_bf16 v[96:99], v[20:23], v[80:83], v[96:99]
    v_mfma_f32_16x16x32_bf16 v[100:103], v[24:27], v[76:79], v[100:103]
    v_mfma_f32_16x16x32_bf16 v[104:107], v[24:27], v[80:83], v[104:107]
    v_mfma_f32_16x16x32_bf16 v[108:111], v[28:31], v[76:79], v[108:111]
    v_mfma_f32_16x16x32_bf16 v[112:115], v[28:31], v[80:83], v[112:115]
    v_mfma_f32_16x16x32_bf16 v[116:119], v[32:35], v[76:79], v[116:119]
    v_mfma_f32_16x16x32_bf16 v[120:123], v[32:35], v[80:83], v[120:123]
    v_mfma_f32_16x16x32_bf16 v[124:127], v[36:39], v[76:79], v[124:127]
    v_mfma_f32_16x16x32_bf16 v[128:131], v[36:39], v[80:83], v[128:131]
    v_mfma_f32_16x16x32_bf16 v[132:135], v[40:43], v[76:79], v[132:135]
    v_mfma_f32_16x16x32_bf16 v[136:139], v[40:43], v[80:83], v[136:139]
    v_mfma_f32_16x16x32_bf16 v[140:143], v[44:47], v[76:79], v[140:143]
    v_mfma_f32_16x16x32_bf16 v[144:147], v[44:47], v[80:83], v[144:147]
    s_waitcnt lgkmcnt(0)
    s_barrier
    ds_read_b128 v[20:23], v8 offset:0
    ds_read_b128 v[76:79], v14 offset:0
    ds_read_b128 v[80:83], v14 offset:2048
    ds_read_b128 v[24:27], v8 offset:2048
    ds_read_b128 v[28:31], v8 offset:4096
    ds_read_b128 v[32:35], v8 offset:6144
    ds_read_b128 v[36:39], v8 offset:8192
    ds_read_b128 v[40:43], v8 offset:10240
    ds_read_b128 v[44:47], v8 offset:12288
    v_mfma_f32_16x16x32_bf16 v[92:95], v[48:51], v[84:87], v[92:95]
    v_mfma_f32_16x16x32_bf16 v[96:99], v[48:51], v[88:91], v[96:99]
    v_mfma_f32_16x16x32_bf16 v[100:103], v[52:55], v[84:87], v[100:103]
    v_mfma_f32_16x16x32_bf16 v[104:107], v[52:55], v[88:91], v[104:107]
    v_mfma_f32_16x16x32_bf16 v[108:111], v[56:59], v[84:87], v[108:111]
    v_mfma_f32_16x16x32_bf16 v[112:115], v[56:59], v[88:91], v[112:115]
    v_mfma_f32_16x16x32_bf16 v[116:119], v[60:63], v[84:87], v[116:119]
    v_mfma_f32_16x16x32_bf16 v[120:123], v[60:63], v[88:91], v[120:123]
    v_mfma_f32_16x16x32_bf16 v[124:127], v[64:67], v[84:87], v[124:127]
    v_mfma_f32_16x16x32_bf16 v[128:131], v[64:67], v[88:91], v[128:131]
    v_mfma_f32_16x16x32_bf16 v[132:135], v[68:71], v[84:87], v[132:135]
    v_mfma_f32_16x16x32_bf16 v[136:139], v[68:71], v[88:91], v[136:139]
    v_mfma_f32_16x16x32_bf16 v[140:143], v[72:75], v[84:87], v[140:143]
    v_mfma_f32_16x16x32_bf16 v[144:147], v[72:75], v[88:91], v[144:147]
    ds_read_b128 v[48:51], v11 offset:0
    ds_read_b128 v[84:87], v17 offset:0
    ds_read_b128 v[88:91], v17 offset:2048
    ds_read_b128 v[52:55], v11 offset:2048
    ds_read_b128 v[56:59], v11 offset:4096
    ds_read_b128 v[60:63], v11 offset:6144
    ds_read_b128 v[64:67], v11 offset:8192
    ds_read_b128 v[68:71], v11 offset:10240
    ds_read_b128 v[72:75], v11 offset:12288
    s_waitcnt lgkmcnt(9)
    v_mfma_f32_16x16x32_bf16 v[92:95], v[20:23], v[76:79], v[92:95]
    v_mfma_f32_16x16x32_bf16 v[96:99], v[20:23], v[80:83], v[96:99]
    v_mfma_f32_16x16x32_bf16 v[100:103], v[24:27], v[76:79], v[100:103]
    v_mfma_f32_16x16x32_bf16 v[104:107], v[24:27], v[80:83], v[104:107]
    v_mfma_f32_16x16x32_bf16 v[108:111], v[28:31], v[76:79], v[108:111]
    v_mfma_f32_16x16x32_bf16 v[112:115], v[28:31], v[80:83], v[112:115]
    v_mfma_f32_16x16x32_bf16 v[116:119], v[32:35], v[76:79], v[116:119]
    v_mfma_f32_16x16x32_bf16 v[120:123], v[32:35], v[80:83], v[120:123]
    v_mfma_f32_16x16x32_bf16 v[124:127], v[36:39], v[76:79], v[124:127]
    v_mfma_f32_16x16x32_bf16 v[128:131], v[36:39], v[80:83], v[128:131]
    v_mfma_f32_16x16x32_bf16 v[132:135], v[40:43], v[76:79], v[132:135]
    v_mfma_f32_16x16x32_bf16 v[136:139], v[40:43], v[80:83], v[136:139]
    v_mfma_f32_16x16x32_bf16 v[140:143], v[44:47], v[76:79], v[140:143]
    v_mfma_f32_16x16x32_bf16 v[144:147], v[44:47], v[80:83], v[144:147]
    s_waitcnt lgkmcnt(0)
    s_barrier
    ds_read_b128 v[20:23], v8 offset:30720
    ds_read_b128 v[76:79], v14 offset:30720
    ds_read_b128 v[80:83], v14 offset:32768
    ds_read_b128 v[24:27], v8 offset:32768
    ds_read_b128 v[28:31], v8 offset:34816
    ds_read_b128 v[32:35], v8 offset:36864
    ds_read_b128 v[36:39], v8 offset:38912
    ds_read_b128 v[40:43], v8 offset:40960
    ds_read_b128 v[44:47], v8 offset:43008
    v_mfma_f32_16x16x32_bf16 v[92:95], v[48:51], v[84:87], v[92:95]
    v_mfma_f32_16x16x32_bf16 v[96:99], v[48:51], v[88:91], v[96:99]
    v_mfma_f32_16x16x32_bf16 v[100:103], v[52:55], v[84:87], v[100:103]
    v_mfma_f32_16x16x32_bf16 v[104:107], v[52:55], v[88:91], v[104:107]
    v_mfma_f32_16x16x32_bf16 v[108:111], v[56:59], v[84:87], v[108:111]
    v_mfma_f32_16x16x32_bf16 v[112:115], v[56:59], v[88:91], v[112:115]
    v_mfma_f32_16x16x32_bf16 v[116:119], v[60:63], v[84:87], v[116:119]
    v_mfma_f32_16x16x32_bf16 v[120:123], v[60:63], v[88:91], v[120:123]
    v_mfma_f32_16x16x32_bf16 v[124:127], v[64:67], v[84:87], v[124:127]
    v_mfma_f32_16x16x32_bf16 v[128:131], v[64:67], v[88:91], v[128:131]
    v_mfma_f32_16x16x32_bf16 v[132:135], v[68:71], v[84:87], v[132:135]
    v_mfma_f32_16x16x32_bf16 v[136:139], v[68:71], v[88:91], v[136:139]
    v_mfma_f32_16x16x32_bf16 v[140:143], v[72:75], v[84:87], v[140:143]
    v_mfma_f32_16x16x32_bf16 v[144:147], v[72:75], v[88:91], v[144:147]
    ds_read_b128 v[48:51], v11 offset:30720
    ds_read_b128 v[84:87], v17 offset:30720
    ds_read_b128 v[88:91], v17 offset:32768
    ds_read_b128 v[52:55], v11 offset:32768
    ds_read_b128 v[56:59], v11 offset:34816
    ds_read_b128 v[60:63], v11 offset:36864
    ds_read_b128 v[64:67], v11 offset:38912
    ds_read_b128 v[68:71], v11 offset:40960
    ds_read_b128 v[72:75], v11 offset:43008
    s_waitcnt lgkmcnt(9)
    v_mfma_f32_16x16x32_bf16 v[92:95], v[20:23], v[76:79], v[92:95]
    v_mfma_f32_16x16x32_bf16 v[96:99], v[20:23], v[80:83], v[96:99]
    v_mfma_f32_16x16x32_bf16 v[100:103], v[24:27], v[76:79], v[100:103]
    v_mfma_f32_16x16x32_bf16 v[104:107], v[24:27], v[80:83], v[104:107]
    v_mfma_f32_16x16x32_bf16 v[108:111], v[28:31], v[76:79], v[108:111]
    v_mfma_f32_16x16x32_bf16 v[112:115], v[28:31], v[80:83], v[112:115]
    v_mfma_f32_16x16x32_bf16 v[116:119], v[32:35], v[76:79], v[116:119]
    v_mfma_f32_16x16x32_bf16 v[120:123], v[32:35], v[80:83], v[120:123]
    v_mfma_f32_16x16x32_bf16 v[124:127], v[36:39], v[76:79], v[124:127]
    v_mfma_f32_16x16x32_bf16 v[128:131], v[36:39], v[80:83], v[128:131]
    v_mfma_f32_16x16x32_bf16 v[132:135], v[40:43], v[76:79], v[132:135]
    v_mfma_f32_16x16x32_bf16 v[136:139], v[40:43], v[80:83], v[136:139]
    v_mfma_f32_16x16x32_bf16 v[140:143], v[44:47], v[76:79], v[140:143]
    v_mfma_f32_16x16x32_bf16 v[144:147], v[44:47], v[80:83], v[144:147]
    s_waitcnt lgkmcnt(0)
    s_barrier
    ds_read_b128 v[20:23], v9 offset:0
    ds_read_b128 v[76:79], v15 offset:0
    ds_read_b128 v[80:83], v15 offset:2048
    ds_read_b128 v[24:27], v9 offset:2048
    ds_read_b128 v[28:31], v9 offset:4096
    ds_read_b128 v[32:35], v9 offset:6144
    ds_read_b128 v[36:39], v9 offset:8192
    ds_read_b128 v[40:43], v9 offset:10240
    ds_read_b128 v[44:47], v9 offset:12288
    v_mfma_f32_16x16x32_bf16 v[92:95], v[48:51], v[84:87], v[92:95]
    v_mfma_f32_16x16x32_bf16 v[96:99], v[48:51], v[88:91], v[96:99]
    v_mfma_f32_16x16x32_bf16 v[100:103], v[52:55], v[84:87], v[100:103]
    v_mfma_f32_16x16x32_bf16 v[104:107], v[52:55], v[88:91], v[104:107]
    v_mfma_f32_16x16x32_bf16 v[108:111], v[56:59], v[84:87], v[108:111]
    v_mfma_f32_16x16x32_bf16 v[112:115], v[56:59], v[88:91], v[112:115]
    v_mfma_f32_16x16x32_bf16 v[116:119], v[60:63], v[84:87], v[116:119]
    v_mfma_f32_16x16x32_bf16 v[120:123], v[60:63], v[88:91], v[120:123]
    v_mfma_f32_16x16x32_bf16 v[124:127], v[64:67], v[84:87], v[124:127]
    v_mfma_f32_16x16x32_bf16 v[128:131], v[64:67], v[88:91], v[128:131]
    v_mfma_f32_16x16x32_bf16 v[132:135], v[68:71], v[84:87], v[132:135]
    v_mfma_f32_16x16x32_bf16 v[136:139], v[68:71], v[88:91], v[136:139]
    v_mfma_f32_16x16x32_bf16 v[140:143], v[72:75], v[84:87], v[140:143]
    v_mfma_f32_16x16x32_bf16 v[144:147], v[72:75], v[88:91], v[144:147]
    ds_read_b128 v[48:51], v12 offset:0
    ds_read_b128 v[84:87], v18 offset:0
    ds_read_b128 v[88:91], v18 offset:2048
    ds_read_b128 v[52:55], v12 offset:2048
    ds_read_b128 v[56:59], v12 offset:4096
    ds_read_b128 v[60:63], v12 offset:6144
    ds_read_b128 v[64:67], v12 offset:8192
    ds_read_b128 v[68:71], v12 offset:10240
    ds_read_b128 v[72:75], v12 offset:12288
    s_waitcnt lgkmcnt(9)
    v_mfma_f32_16x16x32_bf16 v[92:95], v[20:23], v[76:79], v[92:95]
    v_mfma_f32_16x16x32_bf16 v[96:99], v[20:23], v[80:83], v[96:99]
    v_mfma_f32_16x16x32_bf16 v[100:103], v[24:27], v[76:79], v[100:103]
    v_mfma_f32_16x16x32_bf16 v[104:107], v[24:27], v[80:83], v[104:107]
    v_mfma_f32_16x16x32_bf16 v[108:111], v[28:31], v[76:79], v[108:111]
    v_mfma_f32_16x16x32_bf16 v[112:115], v[28:31], v[80:83], v[112:115]
    v_mfma_f32_16x16x32_bf16 v[116:119], v[32:35], v[76:79], v[116:119]
    v_mfma_f32_16x16x32_bf16 v[120:123], v[32:35], v[80:83], v[120:123]
    v_mfma_f32_16x16x32_bf16 v[124:127], v[36:39], v[76:79], v[124:127]
    v_mfma_f32_16x16x32_bf16 v[128:131], v[36:39], v[80:83], v[128:131]
    v_mfma_f32_16x16x32_bf16 v[132:135], v[40:43], v[76:79], v[132:135]
    v_mfma_f32_16x16x32_bf16 v[136:139], v[40:43], v[80:83], v[136:139]
    v_mfma_f32_16x16x32_bf16 v[140:143], v[44:47], v[76:79], v[140:143]
    v_mfma_f32_16x16x32_bf16 v[144:147], v[44:47], v[80:83], v[144:147]
    s_waitcnt lgkmcnt(0)
    s_barrier
    ds_read_b128 v[20:23], v9 offset:30720
    ds_read_b128 v[76:79], v15 offset:30720
    ds_read_b128 v[80:83], v15 offset:32768
    ds_read_b128 v[24:27], v9 offset:32768
    ds_read_b128 v[28:31], v9 offset:34816
    ds_read_b128 v[32:35], v9 offset:36864
    ds_read_b128 v[36:39], v9 offset:38912
    ds_read_b128 v[40:43], v9 offset:40960
    ds_read_b128 v[44:47], v9 offset:43008
    v_mfma_f32_16x16x32_bf16 v[92:95], v[48:51], v[84:87], v[92:95]
    v_mfma_f32_16x16x32_bf16 v[96:99], v[48:51], v[88:91], v[96:99]
    v_mfma_f32_16x16x32_bf16 v[100:103], v[52:55], v[84:87], v[100:103]
    v_mfma_f32_16x16x32_bf16 v[104:107], v[52:55], v[88:91], v[104:107]
    v_mfma_f32_16x16x32_bf16 v[108:111], v[56:59], v[84:87], v[108:111]
    v_mfma_f32_16x16x32_bf16 v[112:115], v[56:59], v[88:91], v[112:115]
    v_mfma_f32_16x16x32_bf16 v[116:119], v[60:63], v[84:87], v[116:119]
    v_mfma_f32_16x16x32_bf16 v[120:123], v[60:63], v[88:91], v[120:123]
    v_mfma_f32_16x16x32_bf16 v[124:127], v[64:67], v[84:87], v[124:127]
    v_mfma_f32_16x16x32_bf16 v[128:131], v[64:67], v[88:91], v[128:131]
    v_mfma_f32_16x16x32_bf16 v[132:135], v[68:71], v[84:87], v[132:135]
    v_mfma_f32_16x16x32_bf16 v[136:139], v[68:71], v[88:91], v[136:139]
    v_mfma_f32_16x16x32_bf16 v[140:143], v[72:75], v[84:87], v[140:143]
    v_mfma_f32_16x16x32_bf16 v[144:147], v[72:75], v[88:91], v[144:147]
    ds_read_b128 v[48:51], v12 offset:30720
    ds_read_b128 v[84:87], v18 offset:30720
    ds_read_b128 v[88:91], v18 offset:32768
    ds_read_b128 v[52:55], v12 offset:32768
    ds_read_b128 v[56:59], v12 offset:34816
    ds_read_b128 v[60:63], v12 offset:36864
    ds_read_b128 v[64:67], v12 offset:38912
    ds_read_b128 v[68:71], v12 offset:40960
    ds_read_b128 v[72:75], v12 offset:43008
    s_waitcnt lgkmcnt(9)
    v_mfma_f32_16x16x32_bf16 v[92:95], v[20:23], v[76:79], v[92:95]
    v_mfma_f32_16x16x32_bf16 v[96:99], v[20:23], v[80:83], v[96:99]
    v_mfma_f32_16x16x32_bf16 v[100:103], v[24:27], v[76:79], v[100:103]
    v_mfma_f32_16x16x32_bf16 v[104:107], v[24:27], v[80:83], v[104:107]
    v_mfma_f32_16x16x32_bf16 v[108:111], v[28:31], v[76:79], v[108:111]
    v_mfma_f32_16x16x32_bf16 v[112:115], v[28:31], v[80:83], v[112:115]
    v_mfma_f32_16x16x32_bf16 v[116:119], v[32:35], v[76:79], v[116:119]
    v_mfma_f32_16x16x32_bf16 v[120:123], v[32:35], v[80:83], v[120:123]
    v_mfma_f32_16x16x32_bf16 v[124:127], v[36:39], v[76:79], v[124:127]
    v_mfma_f32_16x16x32_bf16 v[128:131], v[36:39], v[80:83], v[128:131]
    v_mfma_f32_16x16x32_bf16 v[132:135], v[40:43], v[76:79], v[132:135]
    v_mfma_f32_16x16x32_bf16 v[136:139], v[40:43], v[80:83], v[136:139]
    v_mfma_f32_16x16x32_bf16 v[140:143], v[44:47], v[76:79], v[140:143]
    v_mfma_f32_16x16x32_bf16 v[144:147], v[44:47], v[80:83], v[144:147]
    s_waitcnt lgkmcnt(0)
    s_barrier
    ds_read_b128 v[20:23], v10 offset:0
    ds_read_b128 v[76:79], v16 offset:0
    ds_read_b128 v[80:83], v16 offset:2048
    ds_read_b128 v[24:27], v10 offset:2048
    ds_read_b128 v[28:31], v10 offset:4096
    ds_read_b128 v[32:35], v10 offset:6144
    ds_read_b128 v[36:39], v10 offset:8192
    ds_read_b128 v[40:43], v10 offset:10240
    ds_read_b128 v[44:47], v10 offset:12288
    v_mfma_f32_16x16x32_bf16 v[92:95], v[48:51], v[84:87], v[92:95]
    v_mfma_f32_16x16x32_bf16 v[96:99], v[48:51], v[88:91], v[96:99]
    v_mfma_f32_16x16x32_bf16 v[100:103], v[52:55], v[84:87], v[100:103]
    v_mfma_f32_16x16x32_bf16 v[104:107], v[52:55], v[88:91], v[104:107]
    v_mfma_f32_16x16x32_bf16 v[108:111], v[56:59], v[84:87], v[108:111]
    v_mfma_f32_16x16x32_bf16 v[112:115], v[56:59], v[88:91], v[112:115]
    v_mfma_f32_16x16x32_bf16 v[116:119], v[60:63], v[84:87], v[116:119]
    v_mfma_f32_16x16x32_bf16 v[120:123], v[60:63], v[88:91], v[120:123]
    v_mfma_f32_16x16x32_bf16 v[124:127], v[64:67], v[84:87], v[124:127]
    v_mfma_f32_16x16x32_bf16 v[128:131], v[64:67], v[88:91], v[128:131]
    v_mfma_f32_16x16x32_bf16 v[132:135], v[68:71], v[84:87], v[132:135]
    v_mfma_f32_16x16x32_bf16 v[136:139], v[68:71], v[88:91], v[136:139]
    v_mfma_f32_16x16x32_bf16 v[140:143], v[72:75], v[84:87], v[140:143]
    v_mfma_f32_16x16x32_bf16 v[144:147], v[72:75], v[88:91], v[144:147]
    ds_read_b128 v[48:51], v13 offset:0
    ds_read_b128 v[84:87], v19 offset:0
    ds_read_b128 v[88:91], v19 offset:2048
    ds_read_b128 v[52:55], v13 offset:2048
    ds_read_b128 v[56:59], v13 offset:4096
    ds_read_b128 v[60:63], v13 offset:6144
    ds_read_b128 v[64:67], v13 offset:8192
    ds_read_b128 v[68:71], v13 offset:10240
    ds_read_b128 v[72:75], v13 offset:12288
    s_waitcnt lgkmcnt(9)
    v_mfma_f32_16x16x32_bf16 v[92:95], v[20:23], v[76:79], v[92:95]
    v_mfma_f32_16x16x32_bf16 v[96:99], v[20:23], v[80:83], v[96:99]
    v_mfma_f32_16x16x32_bf16 v[100:103], v[24:27], v[76:79], v[100:103]
    v_mfma_f32_16x16x32_bf16 v[104:107], v[24:27], v[80:83], v[104:107]
    v_mfma_f32_16x16x32_bf16 v[108:111], v[28:31], v[76:79], v[108:111]
    v_mfma_f32_16x16x32_bf16 v[112:115], v[28:31], v[80:83], v[112:115]
    v_mfma_f32_16x16x32_bf16 v[116:119], v[32:35], v[76:79], v[116:119]
    v_mfma_f32_16x16x32_bf16 v[120:123], v[32:35], v[80:83], v[120:123]
    v_mfma_f32_16x16x32_bf16 v[124:127], v[36:39], v[76:79], v[124:127]
    v_mfma_f32_16x16x32_bf16 v[128:131], v[36:39], v[80:83], v[128:131]
    v_mfma_f32_16x16x32_bf16 v[132:135], v[40:43], v[76:79], v[132:135]
    v_mfma_f32_16x16x32_bf16 v[136:139], v[40:43], v[80:83], v[136:139]
    v_mfma_f32_16x16x32_bf16 v[140:143], v[44:47], v[76:79], v[140:143]
    v_mfma_f32_16x16x32_bf16 v[144:147], v[44:47], v[80:83], v[144:147]
    s_waitcnt lgkmcnt(0)
    v_mfma_f32_16x16x32_bf16 v[92:95], v[48:51], v[84:87], v[92:95]
    v_mfma_f32_16x16x32_bf16 v[96:99], v[48:51], v[88:91], v[96:99]
    v_mfma_f32_16x16x32_bf16 v[100:103], v[52:55], v[84:87], v[100:103]
    v_mfma_f32_16x16x32_bf16 v[104:107], v[52:55], v[88:91], v[104:107]
    v_mfma_f32_16x16x32_bf16 v[108:111], v[56:59], v[84:87], v[108:111]
    v_mfma_f32_16x16x32_bf16 v[112:115], v[56:59], v[88:91], v[112:115]
    v_mfma_f32_16x16x32_bf16 v[116:119], v[60:63], v[84:87], v[116:119]
    v_mfma_f32_16x16x32_bf16 v[120:123], v[60:63], v[88:91], v[120:123]
    v_mfma_f32_16x16x32_bf16 v[124:127], v[64:67], v[84:87], v[124:127]
    v_mfma_f32_16x16x32_bf16 v[128:131], v[64:67], v[88:91], v[128:131]
    v_mfma_f32_16x16x32_bf16 v[132:135], v[68:71], v[84:87], v[132:135]
    v_mfma_f32_16x16x32_bf16 v[136:139], v[68:71], v[88:91], v[136:139]
    v_mfma_f32_16x16x32_bf16 v[140:143], v[72:75], v[84:87], v[140:143]
    v_mfma_f32_16x16x32_bf16 v[144:147], v[72:75], v[88:91], v[144:147]
    s_nop 15
    v_mov_b32 v20, 0xc0135761
    v_mov_b32 v21, 0xc0135761
    v_mov_b32 v22, 0xbdd2d3e8
    v_mov_b32 v23, 0xbdd2d3e8
    v_mov_b32 v24, 1.0
    v_mov_b32 v25, 1.0
    v_cvt_pk_bf16_f32 v32, v92, v93
    v_lshlrev_b32 v92, 16, v32
    v_and_b32 v93, 0xffff0000, v32
    v_cvt_pk_bf16_f32 v32, v94, v95
    v_lshlrev_b32 v94, 16, v32
    v_and_b32 v95, 0xffff0000, v32
    v_pk_mul_f32 v[28:29], v[92:93], v[92:93]
    v_pk_fma_f32 v[28:29], v[28:29], v[22:23], v[20:21]
    v_pk_mul_f32 v[28:29], v[28:29], v[92:93]
    v_pk_mul_f32 v[30:31], v[94:95], v[94:95]
    v_pk_fma_f32 v[30:31], v[30:31], v[22:23], v[20:21]
    v_pk_mul_f32 v[30:31], v[30:31], v[94:95]
    v_exp_f32 v28, v28
    v_exp_f32 v29, v29
    v_exp_f32 v30, v30
    v_exp_f32 v31, v31
    s_nop 0
    v_pk_add_f32 v[28:29], v[28:29], v[24:25]
    v_pk_add_f32 v[30:31], v[30:31], v[24:25]
    v_rcp_f32 v28, v28
    v_rcp_f32 v29, v29
    v_rcp_f32 v30, v30
    v_rcp_f32 v31, v31
    s_nop 0
    v_pk_mul_f32 v[92:93], v[92:93], v[28:29]
    v_pk_mul_f32 v[94:95], v[94:95], v[30:31]
    v_cvt_pk_bf16_f32 v92, v92, v93
    v_cvt_pk_bf16_f32 v93, v94, v95
    buffer_store_dwordx2 v[92:93], v5, s[24:27], 0 offen offset:0
    v_cvt_pk_bf16_f32 v32, v100, v101
    v_lshlrev_b32 v100, 16, v32
    v_and_b32 v101, 0xffff0000, v32
    v_cvt_pk_bf16_f32 v32, v102, v103
    v_lshlrev_b32 v102, 16, v32
    v_and_b32 v103, 0xffff0000, v32
    v_pk_mul_f32 v[28:29], v[100:101], v[100:101]
    v_pk_fma_f32 v[28:29], v[28:29], v[22:23], v[20:21]
    v_pk_mul_f32 v[28:29], v[28:29], v[100:101]
    v_pk_mul_f32 v[30:31], v[102:103], v[102:103]
    v_pk_fma_f32 v[30:31], v[30:31], v[22:23], v[20:21]
    v_pk_mul_f32 v[30:31], v[30:31], v[102:103]
    v_exp_f32 v28, v28
    v_exp_f32 v29, v29
    v_exp_f32 v30, v30
    v_exp_f32 v31, v31
    s_nop 0
    v_pk_add_f32 v[28:29], v[28:29], v[24:25]
    v_pk_add_f32 v[30:31], v[30:31], v[24:25]
    v_rcp_f32 v28, v28
    v_rcp_f32 v29, v29
    v_rcp_f32 v30, v30
    v_rcp_f32 v31, v31
    s_nop 0
    v_pk_mul_f32 v[100:101], v[100:101], v[28:29]
    v_pk_mul_f32 v[102:103], v[102:103], v[30:31]
    v_cvt_pk_bf16_f32 v100, v100, v101
    v_cvt_pk_bf16_f32 v101, v102, v103
    buffer_store_dwordx2 v[100:101], v5, s[24:27], 0 offen offset:32
    v_cvt_pk_bf16_f32 v32, v108, v109
    v_lshlrev_b32 v108, 16, v32
    v_and_b32 v109, 0xffff0000, v32
    v_cvt_pk_bf16_f32 v32, v110, v111
    v_lshlrev_b32 v110, 16, v32
    v_and_b32 v111, 0xffff0000, v32
    v_pk_mul_f32 v[28:29], v[108:109], v[108:109]
    v_pk_fma_f32 v[28:29], v[28:29], v[22:23], v[20:21]
    v_pk_mul_f32 v[28:29], v[28:29], v[108:109]
    v_pk_mul_f32 v[30:31], v[110:111], v[110:111]
    v_pk_fma_f32 v[30:31], v[30:31], v[22:23], v[20:21]
    v_pk_mul_f32 v[30:31], v[30:31], v[110:111]
    v_exp_f32 v28, v28
    v_exp_f32 v29, v29
    v_exp_f32 v30, v30
    v_exp_f32 v31, v31
    s_nop 0
    v_pk_add_f32 v[28:29], v[28:29], v[24:25]
    v_pk_add_f32 v[30:31], v[30:31], v[24:25]
    v_rcp_f32 v28, v28
    v_rcp_f32 v29, v29
    v_rcp_f32 v30, v30
    v_rcp_f32 v31, v31
    s_nop 0
    v_pk_mul_f32 v[108:109], v[108:109], v[28:29]
    v_pk_mul_f32 v[110:111], v[110:111], v[30:31]
    v_cvt_pk_bf16_f32 v108, v108, v109
    v_cvt_pk_bf16_f32 v109, v110, v111
    buffer_store_dwordx2 v[108:109], v5, s[24:27], 0 offen offset:64
    v_cvt_pk_bf16_f32 v32, v116, v117
    v_lshlrev_b32 v116, 16, v32
    v_and_b32 v117, 0xffff0000, v32
    v_cvt_pk_bf16_f32 v32, v118, v119
    v_lshlrev_b32 v118, 16, v32
    v_and_b32 v119, 0xffff0000, v32
    v_pk_mul_f32 v[28:29], v[116:117], v[116:117]
    v_pk_fma_f32 v[28:29], v[28:29], v[22:23], v[20:21]
    v_pk_mul_f32 v[28:29], v[28:29], v[116:117]
    v_pk_mul_f32 v[30:31], v[118:119], v[118:119]
    v_pk_fma_f32 v[30:31], v[30:31], v[22:23], v[20:21]
    v_pk_mul_f32 v[30:31], v[30:31], v[118:119]
    v_exp_f32 v28, v28
    v_exp_f32 v29, v29
    v_exp_f32 v30, v30
    v_exp_f32 v31, v31
    s_nop 0
    v_pk_add_f32 v[28:29], v[28:29], v[24:25]
    v_pk_add_f32 v[30:31], v[30:31], v[24:25]
    v_rcp_f32 v28, v28
    v_rcp_f32 v29, v29
    v_rcp_f32 v30, v30
    v_rcp_f32 v31, v31
    s_nop 0
    v_pk_mul_f32 v[116:117], v[116:117], v[28:29]
    v_pk_mul_f32 v[118:119], v[118:119], v[30:31]
    v_cvt_pk_bf16_f32 v116, v116, v117
    v_cvt_pk_bf16_f32 v117, v118, v119
    buffer_store_dwordx2 v[116:117], v5, s[24:27], 0 offen offset:96
    v_cvt_pk_bf16_f32 v32, v124, v125
    v_lshlrev_b32 v124, 16, v32
    v_and_b32 v125, 0xffff0000, v32
    v_cvt_pk_bf16_f32 v32, v126, v127
    v_lshlrev_b32 v126, 16, v32
    v_and_b32 v127, 0xffff0000, v32
    v_pk_mul_f32 v[28:29], v[124:125], v[124:125]
    v_pk_fma_f32 v[28:29], v[28:29], v[22:23], v[20:21]
    v_pk_mul_f32 v[28:29], v[28:29], v[124:125]
    v_pk_mul_f32 v[30:31], v[126:127], v[126:127]
    v_pk_fma_f32 v[30:31], v[30:31], v[22:23], v[20:21]
    v_pk_mul_f32 v[30:31], v[30:31], v[126:127]
    v_exp_f32 v28, v28
    v_exp_f32 v29, v29
    v_exp_f32 v30, v30
    v_exp_f32 v31, v31
    s_nop 0
    v_pk_add_f32 v[28:29], v[28:29], v[24:25]
    v_pk_add_f32 v[30:31], v[30:31], v[24:25]
    v_rcp_f32 v28, v28
    v_rcp_f32 v29, v29
    v_rcp_f32 v30, v30
    v_rcp_f32 v31, v31
    s_nop 0
    v_pk_mul_f32 v[124:125], v[124:125], v[28:29]
    v_pk_mul_f32 v[126:127], v[126:127], v[30:31]
    v_cvt_pk_bf16_f32 v124, v124, v125
    v_cvt_pk_bf16_f32 v125, v126, v127
    buffer_store_dwordx2 v[124:125], v5, s[24:27], 0 offen offset:128
    v_cvt_pk_bf16_f32 v32, v132, v133
    v_lshlrev_b32 v132, 16, v32
    v_and_b32 v133, 0xffff0000, v32
    v_cvt_pk_bf16_f32 v32, v134, v135
    v_lshlrev_b32 v134, 16, v32
    v_and_b32 v135, 0xffff0000, v32
    v_pk_mul_f32 v[28:29], v[132:133], v[132:133]
    v_pk_fma_f32 v[28:29], v[28:29], v[22:23], v[20:21]
    v_pk_mul_f32 v[28:29], v[28:29], v[132:133]
    v_pk_mul_f32 v[30:31], v[134:135], v[134:135]
    v_pk_fma_f32 v[30:31], v[30:31], v[22:23], v[20:21]
    v_pk_mul_f32 v[30:31], v[30:31], v[134:135]
    v_exp_f32 v28, v28
    v_exp_f32 v29, v29
    v_exp_f32 v30, v30
    v_exp_f32 v31, v31
    s_nop 0
    v_pk_add_f32 v[28:29], v[28:29], v[24:25]
    v_pk_add_f32 v[30:31], v[30:31], v[24:25]
    v_rcp_f32 v28, v28
    v_rcp_f32 v29, v29
    v_rcp_f32 v30, v30
    v_rcp_f32 v31, v31
    s_nop 0
    v_pk_mul_f32 v[132:133], v[132:133], v[28:29]
    v_pk_mul_f32 v[134:135], v[134:135], v[30:31]
    v_cvt_pk_bf16_f32 v132, v132, v133
    v_cvt_pk_bf16_f32 v133, v134, v135
    buffer_store_dwordx2 v[132:133], v5, s[24:27], 0 offen offset:160
    v_cvt_pk_bf16_f32 v32, v140, v141
    v_lshlrev_b32 v140, 16, v32
    v_and_b32 v141, 0xffff0000, v32
    v_cvt_pk_bf16_f32 v32, v142, v143
    v_lshlrev_b32 v142, 16, v32
    v_and_b32 v143, 0xffff0000, v32
    v_pk_mul_f32 v[28:29], v[140:141], v[140:141]
    v_pk_fma_f32 v[28:29], v[28:29], v[22:23], v[20:21]
    v_pk_mul_f32 v[28:29], v[28:29], v[140:141]
    v_pk_mul_f32 v[30:31], v[142:143], v[142:143]
    v_pk_fma_f32 v[30:31], v[30:31], v[22:23], v[20:21]
    v_pk_mul_f32 v[30:31], v[30:31], v[142:143]
    v_exp_f32 v28, v28
    v_exp_f32 v29, v29
    v_exp_f32 v30, v30
    v_exp_f32 v31, v31
    s_nop 0
    v_pk_add_f32 v[28:29], v[28:29], v[24:25]
    v_pk_add_f32 v[30:31], v[30:31], v[24:25]
    v_rcp_f32 v28, v28
    v_rcp_f32 v29, v29
    v_rcp_f32 v30, v30
    v_rcp_f32 v31, v31
    s_nop 0
    v_pk_mul_f32 v[140:141], v[140:141], v[28:29]
    v_pk_mul_f32 v[142:143], v[142:143], v[30:31]
    v_cvt_pk_bf16_f32 v140, v140, v141
    v_cvt_pk_bf16_f32 v141, v142, v143
    s_cmp_ge_u32 s39, 6
    s_cbranch_scc1 Lsk_16
    buffer_store_dwordx2 v[140:141], v5, s[24:27], 0 offen offset:192
Lsk_16:
    v_add_u32 v5, 55296, v5
    v_cvt_pk_bf16_f32 v32, v96, v97
    v_lshlrev_b32 v96, 16, v32
    v_and_b32 v97, 0xffff0000, v32
    v_cvt_pk_bf16_f32 v32, v98, v99
    v_lshlrev_b32 v98, 16, v32
    v_and_b32 v99, 0xffff0000, v32
    v_pk_mul_f32 v[28:29], v[96:97], v[96:97]
    v_pk_fma_f32 v[28:29], v[28:29], v[22:23], v[20:21]
    v_pk_mul_f32 v[28:29], v[28:29], v[96:97]
    v_pk_mul_f32 v[30:31], v[98:99], v[98:99]
    v_pk_fma_f32 v[30:31], v[30:31], v[22:23], v[20:21]
    v_pk_mul_f32 v[30:31], v[30:31], v[98:99]
    v_exp_f32 v28, v28
    v_exp_f32 v29, v29
    v_exp_f32 v30, v30
    v_exp_f32 v31, v31
    s_nop 0
    v_pk_add_f32 v[28:29], v[28:29], v[24:25]
    v_pk_add_f32 v[30:31], v[30:31], v[24:25]
    v_rcp_f32 v28, v28
    v_rcp_f32 v29, v29
    v_rcp_f32 v30, v30
    v_rcp_f32 v31, v31
    s_nop 0
    v_pk_mul_f32 v[96:97], v[96:97], v[28:29]
    v_pk_mul_f32 v[98:99], v[98:99], v[30:31]
    v_cvt_pk_bf16_f32 v96, v96, v97
    v_cvt_pk_bf16_f32 v97, v98, v99
    buffer_store_dwordx2 v[96:97], v5, s[24:27], 0 offen offset:0
    v_cvt_pk_bf16_f32 v32, v104, v105
    v_lshlrev_b32 v104, 16, v32
    v_and_b32 v105, 0xffff0000, v32
    v_cvt_pk_bf16_f32 v32, v106, v107
    v_lshlrev_b32 v106, 16, v32
    v_and_b32 v107, 0xffff0000, v32
    v_pk_mul_f32 v[28:29], v[104:105], v[104:105]
    v_pk_fma_f32 v[28:29], v[28:29], v[22:23], v[20:21]
    v_pk_mul_f32 v[28:29], v[28:29], v[104:105]
    v_pk_mul_f32 v[30:31], v[106:107], v[106:107]
    v_pk_fma_f32 v[30:31], v[30:31], v[22:23], v[20:21]
    v_pk_mul_f32 v[30:31], v[30:31], v[106:107]
    v_exp_f32 v28, v28
    v_exp_f32 v29, v29
    v_exp_f32 v30, v30
    v_exp_f32 v31, v31
    s_nop 0
    v_pk_add_f32 v[28:29], v[28:29], v[24:25]
    v_pk_add_f32 v[30:31], v[30:31], v[24:25]
    v_rcp_f32 v28, v28
    v_rcp_f32 v29, v29
    v_rcp_f32 v30, v30
    v_rcp_f32 v31, v31
    s_nop 0
    v_pk_mul_f32 v[104:105], v[104:105], v[28:29]
    v_pk_mul_f32 v[106:107], v[106:107], v[30:31]
    v_cvt_pk_bf16_f32 v104, v104, v105
    v_cvt_pk_bf16_f32 v105, v106, v107
    buffer_store_dwordx2 v[104:105], v5, s[24:27], 0 offen offset:32
    v_cvt_pk_bf16_f32 v32, v112, v113
    v_lshlrev_b32 v112, 16, v32
    v_and_b32 v113, 0xffff0000, v32
    v_cvt_pk_bf16_f32 v32, v114, v115
    v_lshlrev_b32 v114, 16, v32
    v_and_b32 v115, 0xffff0000, v32
    v_pk_mul_f32 v[28:29], v[112:113], v[112:113]
    v_pk_fma_f32 v[28:29], v[28:29], v[22:23], v[20:21]
    v_pk_mul_f32 v[28:29], v[28:29], v[112:113]
    v_pk_mul_f32 v[30:31], v[114:115], v[114:115]
    v_pk_fma_f32 v[30:31], v[30:31], v[22:23], v[20:21]
    v_pk_mul_f32 v[30:31], v[30:31], v[114:115]
    v_exp_f32 v28, v28
    v_exp_f32 v29, v29
    v_exp_f32 v30, v30
    v_exp_f32 v31, v31
    s_nop 0
    v_pk_add_f32 v[28:29], v[28:29], v[24:25]
    v_pk_add_f32 v[30:31], v[30:31], v[24:25]
    v_rcp_f32 v28, v28
    v_rcp_f32 v29, v29
    v_rcp_f32 v30, v30
    v_rcp_f32 v31, v31
    s_nop 0
    v_pk_mul_f32 v[112:113], v[112:113], v[28:29]
    v_pk_mul_f32 v[114:115], v[114:115], v[30:31]
    v_cvt_pk_bf16_f32 v112, v112, v113
    v_cvt_pk_bf16_f32 v113, v114, v115
    buffer_store_dwordx2 v[112:113], v5, s[24:27], 0 offen offset:64
    v_cvt_pk_bf16_f32 v32, v120, v121
    v_lshlrev_b32 v120, 16, v32
    v_and_b32 v121, 0xffff0000, v32
    v_cvt_pk_bf16_f32 v32, v122, v123
    v_lshlrev_b32 v122, 16, v32
    v_and_b32 v123, 0xffff0000, v32
    v_pk_mul_f32 v[28:29], v[120:121], v[120:121]
    v_pk_fma_f32 v[28:29], v[28:29], v[22:23], v[20:21]
    v_pk_mul_f32 v[28:29], v[28:29], v[120:121]
    v_pk_mul_f32 v[30:31], v[122:123], v[122:123]
    v_pk_fma_f32 v[30:31], v[30:31], v[22:23], v[20:21]
    v_pk_mul_f32 v[30:31], v[30:31], v[122:123]
    v_exp_f32 v28, v28
    v_exp_f32 v29, v29
    v_exp_f32 v30, v30
    v_exp_f32 v31, v31
    s_nop 0
    v_pk_add_f32 v[28:29], v[28:29], v[24:25]
    v_pk_add_f32 v[30:31], v[30:31], v[24:25]
    v_rcp_f32 v28, v28
    v_rcp_f32 v29, v29
    v_rcp_f32 v30, v30
    v_rcp_f32 v31, v31
    s_nop 0
    v_pk_mul_f32 v[120:121], v[120:121], v[28:29]
    v_pk_mul_f32 v[122:123], v[122:123], v[30:31]
    v_cvt_pk_bf16_f32 v120, v120, v121
    v_cvt_pk_bf16_f32 v121, v122, v123
    buffer_store_dwordx2 v[120:121], v5, s[24:27], 0 offen offset:96
    v_cvt_pk_bf16_f32 v32, v128, v129
    v_lshlrev_b32 v128, 16, v32
    v_and_b32 v129, 0xffff0000, v32
    v_cvt_pk_bf16_f32 v32, v130, v131
    v_lshlrev_b32 v130, 16, v32
    v_and_b32 v131, 0xffff0000, v32
    v_pk_mul_f32 v[28:29], v[128:129], v[128:129]
    v_pk_fma_f32 v[28:29], v[28:29], v[22:23], v[20:21]
    v_pk_mul_f32 v[28:29], v[28:29], v[128:129]
    v_pk_mul_f32 v[30:31], v[130:131], v[130:131]
    v_pk_fma_f32 v[30:31], v[30:31], v[22:23], v[20:21]
    v_pk_mul_f32 v[30:31], v[30:31], v[130:131]
    v_exp_f32 v28, v28
    v_exp_f32 v29, v29
    v_exp_f32 v30, v30
    v_exp_f32 v31, v31
    s_nop 0
    v_pk_add_f32 v[28:29], v[28:29], v[24:25]
    v_pk_add_f32 v[30:31], v[30:31], v[24:25]
    v_rcp_f32 v28, v28
    v_rcp_f32 v29, v29
    v_rcp_f32 v30, v30
    v_rcp_f32 v31, v31
    s_nop 0
    v_pk_mul_f32 v[128:129], v[128:129], v[28:29]
    v_pk_mul_f32 v[130:131], v[130:131], v[30:31]
    v_cvt_pk_bf16_f32 v128, v128, v129
    v_cvt_pk_bf16_f32 v129, v130, v131
    buffer_store_dwordx2 v[128:129], v5, s[24:27], 0 offen offset:128
    v_cvt_pk_bf16_f32 v32, v136, v137
    v_lshlrev_b32 v136, 16, v32
    v_and_b32 v137, 0xffff0000, v32
    v_cvt_pk_bf16_f32 v32, v138, v139
    v_lshlrev_b32 v138, 16, v32
    v_and_b32 v139, 0xffff0000, v32
    v_pk_mul_f32 v[28:29], v[136:137], v[136:137]
    v_pk_fma_f32 v[28:29], v[28:29], v[22:23], v[20:21]
    v_pk_mul_f32 v[28:29], v[28:29], v[136:137]
    v_pk_mul_f32 v[30:31], v[138:139], v[138:139]
    v_pk_fma_f32 v[30:31], v[30:31], v[22:23], v[20:21]
    v_pk_mul_f32 v[30:31], v[30:31], v[138:139]
    v_exp_f32 v28, v28
    v_exp_f32 v29, v29
    v_exp_f32 v30, v30
    v_exp_f32 v31, v31
    s_nop 0
    v_pk_add_f32 v[28:29], v[28:29], v[24:25]
    v_pk_add_f32 v[30:31], v[30:31], v[24:25]
    v_rcp_f32 v28, v28
    v_rcp_f32 v29, v29
    v_rcp_f32 v30, v30
    v_rcp_f32 v31, v31
    s_nop 0
    v_pk_mul_f32 v[136:137], v[136:137], v[28:29]
    v_pk_mul_f32 v[138:139], v[138:139], v[30:31]
    v_cvt_pk_bf16_f32 v136, v136, v137
    v_cvt_pk_bf16_f32 v137, v138, v139
    buffer_store_dwordx2 v[136:137], v5, s[24:27], 0 offen offset:160
    v_cvt_pk_bf16_f32 v32, v144, v145
    v_lshlrev_b32 v144, 16, v32
    v_and_b32 v145, 0xffff0000, v32
    v_cvt_pk_bf16_f32 v32, v146, v147
    v_lshlrev_b32 v146, 16, v32
    v_and_b32 v147, 0xffff0000, v32
    v_pk_mul_f32 v[28:29], v[144:145], v[144:145]
    v_pk_fma_f32 v[28:29], v[28:29], v[22:23], v[20:21]
    v_pk_mul_f32 v[28:29], v[28:29], v[144:145]
    v_pk_mul_f32 v[30:31], v[146:147], v[146:147]
    v_pk_fma_f32 v[30:31], v[30:31], v[22:23], v[20:21]
    v_pk_mul_f32 v[30:31], v[30:31], v[146:147]
    v_exp_f32 v28, v28
    v_exp_f32 v29, v29
    v_exp_f32 v30, v30
    v_exp_f32 v31, v31
    s_nop 0
    v_pk_add_f32 v[28:29], v[28:29], v[24:25]
    v_pk_add_f32 v[30:31], v[30:31], v[24:25]
    v_rcp_f32 v28, v28
    v_rcp_f32 v29, v29
    v_rcp_f32 v30, v30
    v_rcp_f32 v31, v31
    s_nop 0
    v_pk_mul_f32 v[144:145], v[144:145], v[28:29]
    v_pk_mul_f32 v[146:147], v[146:147], v[30:31]
    v_cvt_pk_bf16_f32 v144, v144, v145
    v_cvt_pk_bf16_f32 v145, v146, v147
    s_cmp_ge_u32 s39, 6
    s_cbranch_scc1 Lsk_17
    buffer_store_dwordx2 v[144:145], v5, s[24:27], 0 offen offset:192
Lsk_17:
    v_add_u32 v5, 55296, v5
    s_branch Lend_12
Lload_13:
    s_add_u32 s16, s4, 0x281000
    s_addc_u32 s17, s5, 0
    s_mov_b32 s18, 0x224000
    s_mov_b32 s19, 0x00020000
    s_add_u32 s20, s4, 0x82e000
    s_addc_u32 s21, s5, 0
    s_mov_b32 s22, 0x280000
    s_mov_b32 s23, 0x00020000
    v_lshrrev_b32 v3, 3, v2
    v_and_b32 v4, 7, v2
    s_cmp_eq_u32 s44, 5
    s_cbranch_scc1 Lld_19
    s_cmp_eq_u32 s44, 6
    s_cbranch_scc1 Lld_20
    s_cmp_eq_u32 s44, 7
    s_cbranch_scc1 Lld_21
Lld_18:
    v_add_u32 v6, 0, v5
    v_and_b32 v6, 7, v6
    v_xor_b32 v6, v6, v4
    v_add_u32 v7, s42, v3
    s_mov_b32 s47, 1280
    v_mul_lo_u32 v7, v7, s47
    v_lshl_add_u32 v8, v6, 4, v7
    v_add_u32 v6, 0, v5
    v_and_b32 v6, 7, v6
    v_xor_b32 v6, v6, v4
    v_add_u32 v7, s42, v3
    v_add_u32 v7, 32, v7
    s_mov_b32 s47, 1280
    v_mul_lo_u32 v7, v7, s47
    v_lshl_add_u32 v9, v6, 4, v7
    v_add_u32 v6, 0, v5
    v_and_b32 v6, 7, v6
    v_xor_b32 v6, v6, v4
    v_add_u32 v7, s42, v3
    v_add_u32 v7, 64, v7
    s_mov_b32 s47, 1280
    v_mul_lo_u32 v7, v7, s47
    v_lshl_add_u32 v10, v6, 4, v7
    v_add_u32 v6, 0, v5
    v_and_b32 v6, 7, v6
    v_xor_b32 v6, v6, v4
    v_add_u32 v7, s42, v3
    v_add_u32 v7, 96, v7
    s_mov_b32 s47, 1280
    v_mul_lo_u32 v7, v7, s47
    v_lshl_add_u32 v11, v6, 4, v7
    v_add_u32 v6, 0, v5
    v_and_b32 v6, 7, v6
    v_xor_b32 v6, v6, v4
    v_add_u32 v7, s43, v3
    v_add_u32 v7, 16, v7
    s_mov_b32 s47, 1280
    v_mul_lo_u32 v7, v7, s47
    v_lshl_add_u32 v12, v6, 4, v7
    v_add_u32 v6, 0, v5
    v_and_b32 v6, 7, v6
    v_xor_b32 v6, v6, v4
    v_add_u32 v7, s43, v3
    v_add_u32 v7, 48, v7
    s_mov_b32 s47, 1280
    v_mul_lo_u32 v7, v7, s47
    v_lshl_add_u32 v13, v6, 4, v7
    v_add_u32 v6, 0, v5
    v_and_b32 v6, 7, v6
    v_xor_b32 v6, v6, v4
    v_add_u32 v7, s43, v3
    v_add_u32 v7, 80, v7
    s_mov_b32 s47, 1280
    v_mul_lo_u32 v7, v7, s47
    v_lshl_add_u32 v14, v6, 4, v7
    v_add_u32 v6, 0, v5
    v_and_b32 v6, 7, v6
    v_xor_b32 v6, v6, v4
    v_add_u32 v7, s43, v3
    v_add_u32 v7, 112, v7
    s_mov_b32 s47, 1280
    v_mul_lo_u32 v7, v7, s47
    v_lshl_add_u32 v15, v6, 4, v7
    s_mov_b32 s50, 0
    s_mov_b32 s51, 0
    s_mov_b32 m0, 0
    s_nop 0
    buffer_load_dwordx4 v8, s[16:19], s50 offen lds
    s_mov_b32 m0, 4096
    s_nop 0
    buffer_load_dwordx4 v9, s[16:19], s50 offen lds
    s_mov_b32 m0, 8192
    s_nop 0
    buffer_load_dwordx4 v10, s[16:19], s50 offen lds
    s_mov_b32 m0, 12288
    s_nop 0
    buffer_load_dwordx4 v11, s[16:19], s50 offen lds
    s_mov_b32 m0, 16384
    s_nop 0
    buffer_load_dwordx4 v12, s[20:23], s50 offen lds
    s_mov_b32 m0, 20480
    s_nop 0
    buffer_load_dwordx4 v13, s[20:23], s50 offen lds
    s_mov_b32 m0, 24576
    s_nop 0
    buffer_load_dwordx4 v14, s[20:23], s50 offen lds
    s_mov_b32 m0, 28672
    s_nop 0
    buffer_load_dwordx4 v15, s[20:23], s50 offen lds
    s_mov_b32 s50, 128
    s_mov_b32 s51, 110592
    s_mov_b32 m0, 30720
    s_nop 0
    buffer_load_dwordx4 v8, s[16:19], s50 offen lds
    s_mov_b32 m0, 34816
    s_nop 0
    buffer_load_dwordx4 v9, s[16:19], s50 offen lds
    s_mov_b32 m0, 38912
    s_nop 0
    buffer_load_dwordx4 v10, s[16:19], s50 offen lds
    s_mov_b32 m0, 43008
    s_nop 0
    buffer_load_dwordx4 v11, s[16:19], s50 offen lds
    s_mov_b32 m0, 47104
    s_nop 0
    buffer_load_dwordx4 v12, s[20:23], s50 offen lds
    s_mov_b32 m0, 51200
    s_nop 0
    buffer_load_dwordx4 v13, s[20:23], s50 offen lds
    s_mov_b32 m0, 55296
    s_nop 0
    buffer_load_dwordx4 v14, s[20:23], s50 offen lds
    s_mov_b32 m0, 59392
    s_nop 0
    buffer_load_dwordx4 v15, s[20:23], s50 offen lds
    s_mov_b32 s50, 256
    s_mov_b32 s51, 221184
    s_mov_b32 m0, 61440
    s_nop 0
    buffer_load_dwordx4 v8, s[16:19], s50 offen lds
    s_mov_b32 m0, 65536
    s_nop 0
    buffer_load_dwordx4 v9, s[16:19], s50 offen lds
    s_mov_b32 m0, 69632
    s_nop 0
    buffer_load_dwordx4 v10, s[16:19], s50 offen lds
    s_mov_b32 m0, 73728
    s_nop 0
    buffer_load_dwordx4 v11, s[16:19], s50 offen lds
    s_mov_b32 m0, 77824
    s_nop 0
    buffer_load_dwordx4 v12, s[20:23], s50 offen lds
    s_mov_b32 m0, 81920
    s_nop 0
    buffer_load_dwordx4 v13, s[20:23], s50 offen lds
    s_mov_b32 m0, 86016
    s_nop 0
    buffer_load_dwordx4 v14, s[20:23], s50 offen lds
    s_mov_b32 m0, 90112
    s_nop 0
    buffer_load_dwordx4 v15, s[20:23], s50 offen lds
    s_mov_b32 s50, 384
    s_mov_b32 s51, 331776
    s_mov_b32 m0, 92160
    s_nop 0
    buffer_load_dwordx4 v8, s[16:19], s50 offen lds
    s_mov_b32 m0, 96256
    s_nop 0
    buffer_load_dwordx4 v9, s[16:19], s50 offen lds
    s_mov_b32 m0, 100352
    s_nop 0
    buffer_load_dwordx4 v10, s[16:19], s50 offen lds
    s_mov_b32 m0, 104448
    s_nop 0
    buffer_load_dwordx4 v11, s[16:19], s50 offen lds
    s_mov_b32 m0, 108544
    s_nop 0
    buffer_load_dwordx4 v12, s[20:23], s50 offen lds
    s_mov_b32 m0, 112640
    s_nop 0
    buffer_load_dwordx4 v13, s[20:23], s50 offen lds
    s_mov_b32 m0, 116736
    s_nop 0
    buffer_load_dwordx4 v14, s[20:23], s50 offen lds
    s_mov_b32 m0, 120832
    s_nop 0
    buffer_load_dwordx4 v15, s[20:23], s50 offen lds
    s_waitcnt vmcnt(24)
    s_barrier
    s_waitcnt vmcnt(16)
    s_barrier
    s_mov_b32 s50, 512
    s_mov_b32 s51, 442368
    s_mov_b32 m0, 122880
    s_nop 0
    buffer_load_dwordx4 v8, s[16:19], s50 offen lds
    s_mov_b32 m0, 126976
    s_nop 0
    buffer_load_dwordx4 v9, s[16:19], s50 offen lds
    s_mov_b32 m0, 131072
    s_nop 0
    buffer_load_dwordx4 v10, s[16:19], s50 offen lds
    s_mov_b32 m0, 135168
    s_nop 0
    buffer_load_dwordx4 v11, s[16:19], s50 offen lds
    s_mov_b32 m0, 139264
    s_nop 0
    buffer_load_dwordx4 v12, s[20:23], s50 offen lds
    s_mov_b32 m0, 143360
    s_nop 0
    buffer_load_dwordx4 v13, s[20:23], s50 offen lds
    s_mov_b32 m0, 147456
    s_nop 0
    buffer_load_dwordx4 v14, s[20:23], s50 offen lds
    s_mov_b32 m0, 151552
    s_nop 0
    buffer_load_dwordx4 v15, s[20:23], s50 offen lds
    s_waitcnt vmcnt(16)
    s_barrier
    s_mov_b32 s50, 640
    s_mov_b32 s51, 552960
    s_mov_b32 m0, 0
    s_nop 0
    buffer_load_dwordx4 v8, s[16:19], s50 offen lds
    s_mov_b32 m0, 4096
    s_nop 0
    buffer_load_dwordx4 v9, s[16:19], s50 offen lds
    s_mov_b32 m0, 8192
    s_nop 0
    buffer_load_dwordx4 v10, s[16:19], s50 offen lds
    s_mov_b32 m0, 12288
    s_nop 0
    buffer_load_dwordx4 v11, s[16:19], s50 offen lds
    s_mov_b32 m0, 16384
    s_nop 0
    buffer_load_dwordx4 v12, s[20:23], s50 offen lds
    s_mov_b32 m0, 20480
    s_nop 0
    buffer_load_dwordx4 v13, s[20:23], s50 offen lds
    s_mov_b32 m0, 24576
    s_nop 0
    buffer_load_dwordx4 v14, s[20:23], s50 offen lds
    s_mov_b32 m0, 28672
    s_nop 0
    buffer_load_dwordx4 v15, s[20:23], s50 offen lds
    s_waitcnt vmcnt(16)
    s_barrier
    s_mov_b32 s50, 768
    s_mov_b32 s51, 663552
    s_mov_b32 m0, 30720
    s_nop 0
    buffer_load_dwordx4 v8, s[16:19], s50 offen lds
    s_mov_b32 m0, 34816
    s_nop 0
    buffer_load_dwordx4 v9, s[16:19], s50 offen lds
    s_mov_b32 m0, 38912
    s_nop 0
    buffer_load_dwordx4 v10, s[16:19], s50 offen lds
    s_mov_b32 m0, 43008
    s_nop 0
    buffer_load_dwordx4 v11, s[16:19], s50 offen lds
    s_mov_b32 m0, 47104
    s_nop 0
    buffer_load_dwordx4 v12, s[20:23], s50 offen lds
    s_mov_b32 m0, 51200
    s_nop 0
    buffer_load_dwordx4 v13, s[20:23], s50 offen lds
    s_mov_b32 m0, 55296
    s_nop 0
    buffer_load_dwordx4 v14, s[20:23], s50 offen lds
    s_mov_b32 m0, 59392
    s_nop 0
    buffer_load_dwordx4 v15, s[20:23], s50 offen lds
    s_waitcnt vmcnt(16)
    s_barrier
    s_mov_b32 s50, 896
    s_mov_b32 s51, 774144
    s_mov_b32 m0, 61440
    s_nop 0
    buffer_load_dwordx4 v8, s[16:19], s50 offen lds
    s_mov_b32 m0, 65536
    s_nop 0
    buffer_load_dwordx4 v9, s[16:19], s50 offen lds
    s_mov_b32 m0, 69632
    s_nop 0
    buffer_load_dwordx4 v10, s[16:19], s50 offen lds
    s_mov_b32 m0, 73728
    s_nop 0
    buffer_load_dwordx4 v11, s[16:19], s50 offen lds
    s_mov_b32 m0, 77824
    s_nop 0
    buffer_load_dwordx4 v12, s[20:23], s50 offen lds
    s_mov_b32 m0, 81920
    s_nop 0
    buffer_load_dwordx4 v13, s[20:23], s50 offen lds
    s_mov_b32 m0, 86016
    s_nop 0
    buffer_load_dwordx4 v14, s[20:23], s50 offen lds
    s_mov_b32 m0, 90112
    s_nop 0
    buffer_load_dwordx4 v15, s[20:23], s50 offen lds
    s_waitcnt vmcnt(16)
    s_barrier
    s_mov_b32 s50, 1024
    s_mov_b32 s51, 884736
    s_mov_b32 m0, 92160
    s_nop 0
    buffer_load_dwordx4 v8, s[16:19], s50 offen lds
    s_mov_b32 m0, 96256
    s_nop 0
    buffer_load_dwordx4 v9, s[16:19], s50 offen lds
    s_mov_b32 m0, 100352
    s_nop 0
    buffer_load_dwordx4 v10, s[16:19], s50 offen lds
    s_mov_b32 m0, 104448
    s_nop 0
    buffer_load_dwordx4 v11, s[16:19], s50 offen lds
    s_mov_b32 m0, 108544
    s_nop 0
    buffer_load_dwordx4 v12, s[20:23], s50 offen lds
    s_mov_b32 m0, 112640
    s_nop 0
    buffer_load_dwordx4 v13, s[20:23], s50 offen lds
    s_mov_b32 m0, 116736
    s_nop 0
    buffer_load_dwordx4 v14, s[20:23], s50 offen lds
    s_mov_b32 m0, 120832
    s_nop 0
    buffer_load_dwordx4 v15, s[20:23], s50 offen lds
    s_waitcnt vmcnt(16)
    s_barrier
    s_mov_b32 s50, 1152
    s_mov_b32 s51, 995328
    s_mov_b32 m0, 122880
    s_nop 0
    buffer_load_dwordx4 v8, s[16:19], s50 offen lds
    s_mov_b32 m0, 126976
    s_nop 0
    buffer_load_dwordx4 v9, s[16:19], s50 offen lds
    s_mov_b32 m0, 131072
    s_nop 0
    buffer_load_dwordx4 v10, s[16:19], s50 offen lds
    s_mov_b32 m0, 135168
    s_nop 0
    buffer_load_dwordx4 v11, s[16:19], s50 offen lds
    s_mov_b32 m0, 139264
    s_nop 0
    buffer_load_dwordx4 v12, s[20:23], s50 offen lds
    s_mov_b32 m0, 143360
    s_nop 0
    buffer_load_dwordx4 v13, s[20:23], s50 offen lds
    s_mov_b32 m0, 147456
    s_nop 0
    buffer_load_dwordx4 v14, s[20:23], s50 offen lds
    s_mov_b32 m0, 151552
    s_nop 0
    buffer_load_dwordx4 v15, s[20:23], s50 offen lds
    s_waitcnt vmcnt(16)
    s_barrier
    s_waitcnt vmcnt(8)
    s_barrier
    s_waitcnt vmcnt(0)
    s_barrier
    s_branch Lend_12
Lld_19:
    v_add_u32 v6, 4, v5
    v_and_b32 v6, 7, v6
    v_xor_b32 v6, v6, v4
    v_add_u32 v7, s42, v3
    v_add_u32 v7, 8, v7
    s_mov_b32 s47, 1280
    v_mul_lo_u32 v7, v7, s47
    v_lshl_add_u32 v8, v6, 4, v7
    v_add_u32 v6, 4, v5
    v_and_b32 v6, 7, v6
    v_xor_b32 v6, v6, v4
    v_add_u32 v7, s42, v3
    v_add_u32 v7, 40, v7
    s_mov_b32 s47, 1280
    v_mul_lo_u32 v7, v7, s47
    v_lshl_add_u32 v9, v6, 4, v7
    v_add_u32 v6, 4, v5
    v_and_b32 v6, 7, v6
    v_xor_b32 v6, v6, v4
    v_add_u32 v7, s42, v3
    v_add_u32 v7, 72, v7
    s_mov_b32 s47, 1280
    v_mul_lo_u32 v7, v7, s47
    v_lshl_add_u32 v10, v6, 4, v7
    v_add_u32 v6, 4, v5
    v_and_b32 v6, 7, v6
    v_xor_b32 v6, v6, v4
    v_add_u32 v7, s42, v3
    v_add_u32 v7, 104, v7
    s_mov_b32 s47, 1280
    v_mul_lo_u32 v7, v7, s47
    v_lshl_add_u32 v11, v6, 4, v7
    v_add_u32 v6, 4, v5
    v_and_b32 v6, 7, v6
    v_xor_b32 v6, v6, v4
    v_add_u32 v7, s43, v3
    v_add_u32 v7, 24, v7
    s_mov_b32 s47, 1280
    v_mul_lo_u32 v7, v7, s47
    v_lshl_add_u32 v12, v6, 4, v7
    v_add_u32 v6, 4, v5
    v_and_b32 v6, 7, v6
    v_xor_b32 v6, v6, v4
    v_add_u32 v7, s43, v3
    v_add_u32 v7, 56, v7
    s_mov_b32 s47, 1280
    v_mul_lo_u32 v7, v7, s47
    v_lshl_add_u32 v13, v6, 4, v7
    v_add_u32 v6, 4, v5
    v_and_b32 v6, 7, v6
    v_xor_b32 v6, v6, v4
    v_add_u32 v7, s43, v3
    v_add_u32 v7, 88, v7
    s_mov_b32 s47, 1280
    v_mul_lo_u32 v7, v7, s47
    v_lshl_add_u32 v14, v6, 4, v7
    v_add_u32 v6, 4, v5
    v_and_b32 v6, 7, v6
    v_xor_b32 v6, v6, v4
    v_add_u32 v7, s43, v3
    v_add_u32 v7, 120, v7
    s_mov_b32 s47, 1280
    v_mul_lo_u32 v7, v7, s47
    v_lshl_add_u32 v15, v6, 4, v7
    s_mov_b32 s50, 0
    s_mov_b32 s51, 0
    s_mov_b32 m0, 1024
    s_nop 0
    buffer_load_dwordx4 v8, s[16:19], s50 offen lds
    s_mov_b32 m0, 5120
    s_nop 0
    buffer_load_dwordx4 v9, s[16:19], s50 offen lds
    s_mov_b32 m0, 9216
    s_nop 0
    buffer_load_dwordx4 v10, s[16:19], s50 offen lds
    s_mov_b32 m0, 13312
    s_nop 0
    buffer_load_dwordx4 v11, s[16:19], s50 offen lds
    s_mov_b32 m0, 17408
    s_nop 0
    buffer_load_dwordx4 v12, s[20:23], s50 offen lds
    s_mov_b32 m0, 21504
    s_nop 0
    buffer_load_dwordx4 v13, s[20:23], s50 offen lds
    s_mov_b32 m0, 25600
    s_nop 0
    buffer_load_dwordx4 v14, s[20:23], s50 offen lds
    s_mov_b32 m0, 29696
    s_nop 0
    buffer_load_dwordx4 v15, s[20:23], s50 offen lds
    s_mov_b32 s50, 128
    s_mov_b32 s51, 110592
    s_mov_b32 m0, 31744
    s_nop 0
    buffer_load_dwordx4 v8, s[16:19], s50 offen lds
    s_mov_b32 m0, 35840
    s_nop 0
    buffer_load_dwordx4 v9, s[16:19], s50 offen lds
    s_mov_b32 m0, 39936
    s_nop 0
    buffer_load_dwordx4 v10, s[16:19], s50 offen lds
    s_mov_b32 m0, 44032
    s_nop 0
    buffer_load_dwordx4 v11, s[16:19], s50 offen lds
    s_mov_b32 m0, 48128
    s_nop 0
    buffer_load_dwordx4 v12, s[20:23], s50 offen lds
    s_mov_b32 m0, 52224
    s_nop 0
    buffer_load_dwordx4 v13, s[20:23], s50 offen lds
    s_mov_b32 m0, 56320
    s_nop 0
    buffer_load_dwordx4 v14, s[20:23], s50 offen lds
    s_mov_b32 m0, 60416
    s_nop 0
    buffer_load_dwordx4 v15, s[20:23], s50 offen lds
    s_mov_b32 s50, 256
    s_mov_b32 s51, 221184
    s_mov_b32 m0, 62464
    s_nop 0
    buffer_load_dwordx4 v8, s[16:19], s50 offen lds
    s_mov_b32 m0, 66560
    s_nop 0
    buffer_load_dwordx4 v9, s[16:19], s50 offen lds
    s_mov_b32 m0, 70656
    s_nop 0
    buffer_load_dwordx4 v10, s[16:19], s50 offen lds
    s_mov_b32 m0, 74752
    s_nop 0
    buffer_load_dwordx4 v11, s[16:19], s50 offen lds
    s_mov_b32 m0, 78848
    s_nop 0
    buffer_load_dwordx4 v12, s[20:23], s50 offen lds
    s_mov_b32 m0, 82944
    s_nop 0
    buffer_load_dwordx4 v13, s[20:23], s50 offen lds
    s_mov_b32 m0, 87040
    s_nop 0
    buffer_load_dwordx4 v14, s[20:23], s50 offen lds
    s_mov_b32 m0, 91136
    s_nop 0
    buffer_load_dwordx4 v15, s[20:23], s50 offen lds
    s_mov_b32 s50, 384
    s_mov_b32 s51, 331776
    s_mov_b32 m0, 93184
    s_nop 0
    buffer_load_dwordx4 v8, s[16:19], s50 offen lds
    s_mov_b32 m0, 97280
    s_nop 0
    buffer_load_dwordx4 v9, s[16:19], s50 offen lds
    s_mov_b32 m0, 101376
    s_nop 0
    buffer_load_dwordx4 v10, s[16:19], s50 offen lds
    s_mov_b32 m0, 105472
    s_nop 0
    buffer_load_dwordx4 v11, s[16:19], s50 offen lds
    s_mov_b32 m0, 109568
    s_nop 0
    buffer_load_dwordx4 v12, s[20:23], s50 offen lds
    s_mov_b32 m0, 113664
    s_nop 0
    buffer_load_dwordx4 v13, s[20:23], s50 offen lds
    s_mov_b32 m0, 117760
    s_nop 0
    buffer_load_dwordx4 v14, s[20:23], s50 offen lds
    s_mov_b32 m0, 121856
    s_nop 0
    buffer_load_dwordx4 v15, s[20:23], s50 offen lds
    s_waitcnt vmcnt(24)
    s_barrier
    s_waitcnt vmcnt(16)
    s_barrier
    s_mov_b32 s50, 512
    s_mov_b32 s51, 442368
    s_mov_b32 m0, 123904
    s_nop 0
    buffer_load_dwordx4 v8, s[16:19], s50 offen lds
    s_mov_b32 m0, 128000
    s_nop 0
    buffer_load_dwordx4 v9, s[16:19], s50 offen lds
    s_mov_b32 m0, 132096
    s_nop 0
    buffer_load_dwordx4 v10, s[16:19], s50 offen lds
    s_mov_b32 m0, 136192
    s_nop 0
    buffer_load_dwordx4 v11, s[16:19], s50 offen lds
    s_mov_b32 m0, 140288
    s_nop 0
    buffer_load_dwordx4 v12, s[20:23], s50 offen lds
    s_mov_b32 m0, 144384
    s_nop 0
    buffer_load_dwordx4 v13, s[20:23], s50 offen lds
    s_mov_b32 m0, 148480
    s_nop 0
    buffer_load_dwordx4 v14, s[20:23], s50 offen lds
    s_mov_b32 m0, 152576
    s_nop 0
    buffer_load_dwordx4 v15, s[20:23], s50 offen lds
    s_waitcnt vmcnt(16)
    s_barrier
    s_mov_b32 s50, 640
    s_mov_b32 s51, 552960
    s_mov_b32 m0, 1024
    s_nop 0
    buffer_load_dwordx4 v8, s[16:19], s50 offen lds
    s_mov_b32 m0, 5120
    s_nop 0
    buffer_load_dwordx4 v9, s[16:19], s50 offen lds
    s_mov_b32 m0, 9216
    s_nop 0
    buffer_load_dwordx4 v10, s[16:19], s50 offen lds
    s_mov_b32 m0, 13312
    s_nop 0
    buffer_load_dwordx4 v11, s[16:19], s50 offen lds
    s_mov_b32 m0, 17408
    s_nop 0
    buffer_load_dwordx4 v12, s[20:23], s50 offen lds
    s_mov_b32 m0, 21504
    s_nop 0
    buffer_load_dwordx4 v13, s[20:23], s50 offen lds
    s_mov_b32 m0, 25600
    s_nop 0
    buffer_load_dwordx4 v14, s[20:23], s50 offen lds
    s_mov_b32 m0, 29696
    s_nop 0
    buffer_load_dwordx4 v15, s[20:23], s50 offen lds
    s_waitcnt vmcnt(16)
    s_barrier
    s_mov_b32 s50, 768
    s_mov_b32 s51, 663552
    s_mov_b32 m0, 31744
    s_nop 0
    buffer_load_dwordx4 v8, s[16:19], s50 offen lds
    s_mov_b32 m0, 35840
    s_nop 0
    buffer_load_dwordx4 v9, s[16:19], s50 offen lds
    s_mov_b32 m0, 39936
    s_nop 0
    buffer_load_dwordx4 v10, s[16:19], s50 offen lds
    s_mov_b32 m0, 44032
    s_nop 0
    buffer_load_dwordx4 v11, s[16:19], s50 offen lds
    s_mov_b32 m0, 48128
    s_nop 0
    buffer_load_dwordx4 v12, s[20:23], s50 offen lds
    s_mov_b32 m0, 52224
    s_nop 0
    buffer_load_dwordx4 v13, s[20:23], s50 offen lds
    s_mov_b32 m0, 56320
    s_nop 0
    buffer_load_dwordx4 v14, s[20:23], s50 offen lds
    s_mov_b32 m0, 60416
    s_nop 0
    buffer_load_dwordx4 v15, s[20:23], s50 offen lds
    s_waitcnt vmcnt(16)
    s_barrier
    s_mov_b32 s50, 896
    s_mov_b32 s51, 774144
    s_mov_b32 m0, 62464
    s_nop 0
    buffer_load_dwordx4 v8, s[16:19], s50 offen lds
    s_mov_b32 m0, 66560
    s_nop 0
    buffer_load_dwordx4 v9, s[16:19], s50 offen lds
    s_mov_b32 m0, 70656
    s_nop 0
    buffer_load_dwordx4 v10, s[16:19], s50 offen lds
    s_mov_b32 m0, 74752
    s_nop 0
    buffer_load_dwordx4 v11, s[16:19], s50 offen lds
    s_mov_b32 m0, 78848
    s_nop 0
    buffer_load_dwordx4 v12, s[20:23], s50 offen lds
    s_mov_b32 m0, 82944
    s_nop 0
    buffer_load_dwordx4 v13, s[20:23], s50 offen lds
    s_mov_b32 m0, 87040
    s_nop 0
    buffer_load_dwordx4 v14, s[20:23], s50 offen lds
    s_mov_b32 m0, 91136
    s_nop 0
    buffer_load_dwordx4 v15, s[20:23], s50 offen lds
    s_waitcnt vmcnt(16)
    s_barrier
    s_mov_b32 s50, 1024
    s_mov_b32 s51, 884736
    s_mov_b32 m0, 93184
    s_nop 0
    buffer_load_dwordx4 v8, s[16:19], s50 offen lds
    s_mov_b32 m0, 97280
    s_nop 0
    buffer_load_dwordx4 v9, s[16:19], s50 offen lds
    s_mov_b32 m0, 101376
    s_nop 0
    buffer_load_dwordx4 v10, s[16:19], s50 offen lds
    s_mov_b32 m0, 105472
    s_nop 0
    buffer_load_dwordx4 v11, s[16:19], s50 offen lds
    s_mov_b32 m0, 109568
    s_nop 0
    buffer_load_dwordx4 v12, s[20:23], s50 offen lds
    s_mov_b32 m0, 113664
    s_nop 0
    buffer_load_dwordx4 v13, s[20:23], s50 offen lds
    s_mov_b32 m0, 117760
    s_nop 0
    buffer_load_dwordx4 v14, s[20:23], s50 offen lds
    s_mov_b32 m0, 121856
    s_nop 0
    buffer_load_dwordx4 v15, s[20:23], s50 offen lds
    s_waitcnt vmcnt(16)
    s_barrier
    s_mov_b32 s50, 1152
    s_mov_b32 s51, 995328
    s_mov_b32 m0, 123904
    s_nop 0
    buffer_load_dwordx4 v8, s[16:19], s50 offen lds
    s_mov_b32 m0, 128000
    s_nop 0
    buffer_load_dwordx4 v9, s[16:19], s50 offen lds
    s_mov_b32 m0, 132096
    s_nop 0
    buffer_load_dwordx4 v10, s[16:19], s50 offen lds
    s_mov_b32 m0, 136192
    s_nop 0
    buffer_load_dwordx4 v11, s[16:19], s50 offen lds
    s_mov_b32 m0, 140288
    s_nop 0
    buffer_load_dwordx4 v12, s[20:23], s50 offen lds
    s_mov_b32 m0, 144384
    s_nop 0
    buffer_load_dwordx4 v13, s[20:23], s50 offen lds
    s_mov_b32 m0, 148480
    s_nop 0
    buffer_load_dwordx4 v14, s[20:23], s50 offen lds
    s_mov_b32 m0, 152576
    s_nop 0
    buffer_load_dwordx4 v15, s[20:23], s50 offen lds
    s_waitcnt vmcnt(16)
    s_barrier
    s_waitcnt vmcnt(8)
    s_barrier
    s_waitcnt vmcnt(0)
    s_barrier
    s_branch Lend_12
Lld_20:
    v_add_u32 v6, 0, v5
    v_and_b32 v6, 7, v6
    v_xor_b32 v6, v6, v4
    v_add_u32 v7, s42, v3
    v_add_u32 v7, 16, v7
    s_mov_b32 s47, 1280
    v_mul_lo_u32 v7, v7, s47
    v_lshl_add_u32 v8, v6, 4, v7
    v_add_u32 v6, 0, v5
    v_and_b32 v6, 7, v6
    v_xor_b32 v6, v6, v4
    v_add_u32 v7, s42, v3
    v_add_u32 v7, 48, v7
    s_mov_b32 s47, 1280
    v_mul_lo_u32 v7, v7, s47
    v_lshl_add_u32 v9, v6, 4, v7
    v_add_u32 v6, 0, v5
    v_and_b32 v6, 7, v6
    v_xor_b32 v6, v6, v4
    v_add_u32 v7, s42, v3
    v_add_u32 v7, 80, v7
    s_mov_b32 s47, 1280
    v_mul_lo_u32 v7, v7, s47
    v_lshl_add_u32 v10, v6, 4, v7
    v_add_u32 v6, 0, v5
    v_and_b32 v6, 7, v6
    v_xor_b32 v6, v6, v4
    v_add_u32 v7, s43, v3
    s_mov_b32 s47, 1280
    v_mul_lo_u32 v7, v7, s47
    v_lshl_add_u32 v11, v6, 4, v7
    v_add_u32 v6, 0, v5
    v_and_b32 v6, 7, v6
    v_xor_b32 v6, v6, v4
    v_add_u32 v7, s43, v3
    v_add_u32 v7, 32, v7
    s_mov_b32 s47, 1280
    v_mul_lo_u32 v7, v7, s47
    v_lshl_add_u32 v12, v6, 4, v7
    v_add_u32 v6, 0, v5
    v_and_b32 v6, 7, v6
    v_xor_b32 v6, v6, v4
    v_add_u32 v7, s43, v3
    v_add_u32 v7, 64, v7
    s_mov_b32 s47, 1280
    v_mul_lo_u32 v7, v7, s47
    v_lshl_add_u32 v13, v6, 4, v7
    v_add_u32 v6, 0, v5
    v_and_b32 v6, 7, v6
    v_xor_b32 v6, v6, v4
    v_add_u32 v7, s43, v3
    v_add_u32 v7, 96, v7
    s_mov_b32 s47, 1280
    v_mul_lo_u32 v7, v7, s47
    v_lshl_add_u32 v14, v6, 4, v7
    s_mov_b32 s50, 0
    s_mov_b32 s51, 0
    s_mov_b32 m0, 2048
    s_nop 0
    buffer_load_dwordx4 v8, s[16:19], s50 offen lds
    s_mov_b32 m0, 6144
    s_nop 0
    buffer_load_dwordx4 v9, s[16:19], s50 offen lds
    s_mov_b32 m0, 10240
    s_nop 0
    buffer_load_dwordx4 v10, s[16:19], s50 offen lds
    s_mov_b32 m0, 14336
    s_nop 0
    buffer_load_dwordx4 v11, s[20:23], s50 offen lds
    s_mov_b32 m0, 18432
    s_nop 0
    buffer_load_dwordx4 v12, s[20:23], s50 offen lds
    s_mov_b32 m0, 22528
    s_nop 0
    buffer_load_dwordx4 v13, s[20:23], s50 offen lds
    s_mov_b32 m0, 26624
    s_nop 0
    buffer_load_dwordx4 v14, s[20:23], s50 offen lds
    s_mov_b32 s50, 128
    s_mov_b32 s51, 110592
    s_mov_b32 m0, 32768
    s_nop 0
    buffer_load_dwordx4 v8, s[16:19], s50 offen lds
    s_mov_b32 m0, 36864
    s_nop 0
    buffer_load_dwordx4 v9, s[16:19], s50 offen lds
    s_mov_b32 m0, 40960
    s_nop 0
    buffer_load_dwordx4 v10, s[16:19], s50 offen lds
    s_mov_b32 m0, 45056
    s_nop 0
    buffer_load_dwordx4 v11, s[20:23], s50 offen lds
    s_mov_b32 m0, 49152
    s_nop 0
    buffer_load_dwordx4 v12, s[20:23], s50 offen lds
    s_mov_b32 m0, 53248
    s_nop 0
    buffer_load_dwordx4 v13, s[20:23], s50 offen lds
    s_mov_b32 m0, 57344
    s_nop 0
    buffer_load_dwordx4 v14, s[20:23], s50 offen lds
    s_mov_b32 s50, 256
    s_mov_b32 s51, 221184
    s_mov_b32 m0, 63488
    s_nop 0
    buffer_load_dwordx4 v8, s[16:19], s50 offen lds
    s_mov_b32 m0, 67584
    s_nop 0
    buffer_load_dwordx4 v9, s[16:19], s50 offen lds
    s_mov_b32 m0, 71680
    s_nop 0
    buffer_load_dwordx4 v10, s[16:19], s50 offen lds
    s_mov_b32 m0, 75776
    s_nop 0
    buffer_load_dwordx4 v11, s[20:23], s50 offen lds
    s_mov_b32 m0, 79872
    s_nop 0
    buffer_load_dwordx4 v12, s[20:23], s50 offen lds
    s_mov_b32 m0, 83968
    s_nop 0
    buffer_load_dwordx4 v13, s[20:23], s50 offen lds
    s_mov_b32 m0, 88064
    s_nop 0
    buffer_load_dwordx4 v14, s[20:23], s50 offen lds
    s_mov_b32 s50, 384
    s_mov_b32 s51, 331776
    s_mov_b32 m0, 94208
    s_nop 0
    buffer_load_dwordx4 v8, s[16:19], s50 offen lds
    s_mov_b32 m0, 98304
    s_nop 0
    buffer_load_dwordx4 v9, s[16:19], s50 offen lds
    s_mov_b32 m0, 102400
    s_nop 0
    buffer_load_dwordx4 v10, s[16:19], s50 offen lds
    s_mov_b32 m0, 106496
    s_nop 0
    buffer_load_dwordx4 v11, s[20:23], s50 offen lds
    s_mov_b32 m0, 110592
    s_nop 0
    buffer_load_dwordx4 v12, s[20:23], s50 offen lds
    s_mov_b32 m0, 114688
    s_nop 0
    buffer_load_dwordx4 v13, s[20:23], s50 offen lds
    s_mov_b32 m0, 118784
    s_nop 0
    buffer_load_dwordx4 v14, s[20:23], s50 offen lds
    s_waitcnt vmcnt(21)
    s_barrier
    s_waitcnt vmcnt(14)
    s_barrier
    s_mov_b32 s50, 512
    s_mov_b32 s51, 442368
    s_mov_b32 m0, 124928
    s_nop 0
    buffer_load_dwordx4 v8, s[16:19], s50 offen lds
    s_mov_b32 m0, 129024
    s_nop 0
    buffer_load_dwordx4 v9, s[16:19], s50 offen lds
    s_mov_b32 m0, 133120
    s_nop 0
    buffer_load_dwordx4 v10, s[16:19], s50 offen lds
    s_mov_b32 m0, 137216
    s_nop 0
    buffer_load_dwordx4 v11, s[20:23], s50 offen lds
    s_mov_b32 m0, 141312
    s_nop 0
    buffer_load_dwordx4 v12, s[20:23], s50 offen lds
    s_mov_b32 m0, 145408
    s_nop 0
    buffer_load_dwordx4 v13, s[20:23], s50 offen lds
    s_mov_b32 m0, 149504
    s_nop 0
    buffer_load_dwordx4 v14, s[20:23], s50 offen lds
    s_waitcnt vmcnt(14)
    s_barrier
    s_mov_b32 s50, 640
    s_mov_b32 s51, 552960
    s_mov_b32 m0, 2048
    s_nop 0
    buffer_load_dwordx4 v8, s[16:19], s50 offen lds
    s_mov_b32 m0, 6144
    s_nop 0
    buffer_load_dwordx4 v9, s[16:19], s50 offen lds
    s_mov_b32 m0, 10240
    s_nop 0
    buffer_load_dwordx4 v10, s[16:19], s50 offen lds
    s_mov_b32 m0, 14336
    s_nop 0
    buffer_load_dwordx4 v11, s[20:23], s50 offen lds
    s_mov_b32 m0, 18432
    s_nop 0
    buffer_load_dwordx4 v12, s[20:23], s50 offen lds
    s_mov_b32 m0, 22528
    s_nop 0
    buffer_load_dwordx4 v13, s[20:23], s50 offen lds
    s_mov_b32 m0, 26624
    s_nop 0
    buffer_load_dwordx4 v14, s[20:23], s50 offen lds
    s_waitcnt vmcnt(14)
    s_barrier
    s_mov_b32 s50, 768
    s_mov_b32 s51, 663552
    s_mov_b32 m0, 32768
    s_nop 0
    buffer_load_dwordx4 v8, s[16:19], s50 offen lds
    s_mov_b32 m0, 36864
    s_nop 0
    buffer_load_dwordx4 v9, s[16:19], s50 offen lds
    s_mov_b32 m0, 40960
    s_nop 0
    buffer_load_dwordx4 v10, s[16:19], s50 offen lds
    s_mov_b32 m0, 45056
    s_nop 0
    buffer_load_dwordx4 v11, s[20:23], s50 offen lds
    s_mov_b32 m0, 49152
    s_nop 0
    buffer_load_dwordx4 v12, s[20:23], s50 offen lds
    s_mov_b32 m0, 53248
    s_nop 0
    buffer_load_dwordx4 v13, s[20:23], s50 offen lds
    s_mov_b32 m0, 57344
    s_nop 0
    buffer_load_dwordx4 v14, s[20:23], s50 offen lds
    s_waitcnt vmcnt(14)
    s_barrier
    s_mov_b32 s50, 896
    s_mov_b32 s51, 774144
    s_mov_b32 m0, 63488
    s_nop 0
    buffer_load_dwordx4 v8, s[16:19], s50 offen lds
    s_mov_b32 m0, 67584
    s_nop 0
    buffer_load_dwordx4 v9, s[16:19], s50 offen lds
    s_mov_b32 m0, 71680
    s_nop 0
    buffer_load_dwordx4 v10, s[16:19], s50 offen lds
    s_mov_b32 m0, 75776
    s_nop 0
    buffer_load_dwordx4 v11, s[20:23], s50 offen lds
    s_mov_b32 m0, 79872
    s_nop 0
    buffer_load_dwordx4 v12, s[20:23], s50 offen lds
    s_mov_b32 m0, 83968
    s_nop 0
    buffer_load_dwordx4 v13, s[20:23], s50 offen lds
    s_mov_b32 m0, 88064
    s_nop 0
    buffer_load_dwordx4 v14, s[20:23], s50 offen lds
    s_waitcnt vmcnt(14)
    s_barrier
    s_mov_b32 s50, 1024
    s_mov_b32 s51, 884736
    s_mov_b32 m0, 94208
    s_nop 0
    buffer_load_dwordx4 v8, s[16:19], s50 offen lds
    s_mov_b32 m0, 98304
    s_nop 0
    buffer_load_dwordx4 v9, s[16:19], s50 offen lds
    s_mov_b32 m0, 102400
    s_nop 0
    buffer_load_dwordx4 v10, s[16:19], s50 offen lds
    s_mov_b32 m0, 106496
    s_nop 0
    buffer_load_dwordx4 v11, s[20:23], s50 offen lds
    s_mov_b32 m0, 110592
    s_nop 0
    buffer_load_dwordx4 v12, s[20:23], s50 offen lds
    s_mov_b32 m0, 114688
    s_nop 0
    buffer_load_dwordx4 v13, s[20:23], s50 offen lds
    s_mov_b32 m0, 118784
    s_nop 0
    buffer_load_dwordx4 v14, s[20:23], s50 offen lds
    s_waitcnt vmcnt(14)
    s_barrier
    s_mov_b32 s50, 1152
    s_mov_b32 s51, 995328
    s_mov_b32 m0, 124928
    s_nop 0
    buffer_load_dwordx4 v8, s[16:19], s50 offen lds
    s_mov_b32 m0, 129024
    s_nop 0
    buffer_load_dwordx4 v9, s[16:19], s50 offen lds
    s_mov_b32 m0, 133120
    s_nop 0
    buffer_load_dwordx4 v10, s[16:19], s50 offen lds
    s_mov_b32 m0, 137216
    s_nop 0
    buffer_load_dwordx4 v11, s[20:23], s50 offen lds
    s_mov_b32 m0, 141312
    s_nop 0
    buffer_load_dwordx4 v12, s[20:23], s50 offen lds
    s_mov_b32 m0, 145408
    s_nop 0
    buffer_load_dwordx4 v13, s[20:23], s50 offen lds
    s_mov_b32 m0, 149504
    s_nop 0
    buffer_load_dwordx4 v14, s[20:23], s50 offen lds
    s_waitcnt vmcnt(14)
    s_barrier
    s_waitcnt vmcnt(7)
    s_barrier
    s_waitcnt vmcnt(0)
    s_barrier
    s_branch Lend_12
Lld_21:
    v_add_u32 v6, 4, v5
    v_and_b32 v6, 7, v6
    v_xor_b32 v6, v6, v4
    v_add_u32 v7, s42, v3
    v_add_u32 v7, 24, v7
    s_mov_b32 s47, 1280
    v_mul_lo_u32 v7, v7, s47
    v_lshl_add_u32 v8, v6, 4, v7
    v_add_u32 v6, 4, v5
    v_and_b32 v6, 7, v6
    v_xor_b32 v6, v6, v4
    v_add_u32 v7, s42, v3
    v_add_u32 v7, 56, v7
    s_mov_b32 s47, 1280
    v_mul_lo_u32 v7, v7, s47
    v_lshl_add_u32 v9, v6, 4, v7
    v_add_u32 v6, 4, v5
    v_and_b32 v6, 7, v6
    v_xor_b32 v6, v6, v4
    v_add_u32 v7, s42, v3
    v_add_u32 v7, 88, v7
    s_mov_b32 s47, 1280
    v_mul_lo_u32 v7, v7, s47
    v_lshl_add_u32 v10, v6, 4, v7
    v_add_u32 v6, 4, v5
    v_and_b32 v6, 7, v6
    v_xor_b32 v6, v6, v4
    v_add_u32 v7, s43, v3
    v_add_u32 v7, 8, v7
    s_mov_b32 s47, 1280
    v_mul_lo_u32 v7, v7, s47
    v_lshl_add_u32 v11, v6, 4, v7
    v_add_u32 v6, 4, v5
    v_and_b32 v6, 7, v6
    v_xor_b32 v6, v6, v4
    v_add_u32 v7, s43, v3
    v_add_u32 v7, 40, v7
    s_mov_b32 s47, 1280
    v_mul_lo_u32 v7, v7, s47
    v_lshl_add_u32 v12, v6, 4, v7
    v_add_u32 v6, 4, v5
    v_and_b32 v6, 7, v6
    v_xor_b32 v6, v6, v4
    v_add_u32 v7, s43, v3
    v_add_u32 v7, 72, v7
    s_mov_b32 s47, 1280
    v_mul_lo_u32 v7, v7, s47
    v_lshl_add_u32 v13, v6, 4, v7
    v_add_u32 v6, 4, v5
    v_and_b32 v6, 7, v6
    v_xor_b32 v6, v6, v4
    v_add_u32 v7, s43, v3
    v_add_u32 v7, 104, v7
    s_mov_b32 s47, 1280
    v_mul_lo_u32 v7, v7, s47
    v_lshl_add_u32 v14, v6, 4, v7
    s_mov_b32 s50, 0
    s_mov_b32 s51, 0
    s_mov_b32 m0, 3072
    s_nop 0
    buffer_load_dwordx4 v8, s[16:19], s50 offen lds
    s_mov_b32 m0, 7168
    s_nop 0
    buffer_load_dwordx4 v9, s[16:19], s50 offen lds
    s_mov_b32 m0, 11264
    s_nop 0
    buffer_load_dwordx4 v10, s[16:19], s50 offen lds
    s_mov_b32 m0, 15360
    s_nop 0
    buffer_load_dwordx4 v11, s[20:23], s50 offen lds
    s_mov_b32 m0, 19456
    s_nop 0
    buffer_load_dwordx4 v12, s[20:23], s50 offen lds
    s_mov_b32 m0, 23552
    s_nop 0
    buffer_load_dwordx4 v13, s[20:23], s50 offen lds
    s_mov_b32 m0, 27648
    s_nop 0
    buffer_load_dwordx4 v14, s[20:23], s50 offen lds
    s_mov_b32 s50, 128
    s_mov_b32 s51, 110592
    s_mov_b32 m0, 33792
    s_nop 0
    buffer_load_dwordx4 v8, s[16:19], s50 offen lds
    s_mov_b32 m0, 37888
    s_nop 0
    buffer_load_dwordx4 v9, s[16:19], s50 offen lds
    s_mov_b32 m0, 41984
    s_nop 0
    buffer_load_dwordx4 v10, s[16:19], s50 offen lds
    s_mov_b32 m0, 46080
    s_nop 0
    buffer_load_dwordx4 v11, s[20:23], s50 offen lds
    s_mov_b32 m0, 50176
    s_nop 0
    buffer_load_dwordx4 v12, s[20:23], s50 offen lds
    s_mov_b32 m0, 54272
    s_nop 0
    buffer_load_dwordx4 v13, s[20:23], s50 offen lds
    s_mov_b32 m0, 58368
    s_nop 0
    buffer_load_dwordx4 v14, s[20:23], s50 offen lds
    s_mov_b32 s50, 256
    s_mov_b32 s51, 221184
    s_mov_b32 m0, 64512
    s_nop 0
    buffer_load_dwordx4 v8, s[16:19], s50 offen lds
    s_mov_b32 m0, 68608
    s_nop 0
    buffer_load_dwordx4 v9, s[16:19], s50 offen lds
    s_mov_b32 m0, 72704
    s_nop 0
    buffer_load_dwordx4 v10, s[16:19], s50 offen lds
    s_mov_b32 m0, 76800
    s_nop 0
    buffer_load_dwordx4 v11, s[20:23], s50 offen lds
    s_mov_b32 m0, 80896
    s_nop 0
    buffer_load_dwordx4 v12, s[20:23], s50 offen lds
    s_mov_b32 m0, 84992
    s_nop 0
    buffer_load_dwordx4 v13, s[20:23], s50 offen lds
    s_mov_b32 m0, 89088
    s_nop 0
    buffer_load_dwordx4 v14, s[20:23], s50 offen lds
    s_mov_b32 s50, 384
    s_mov_b32 s51, 331776
    s_mov_b32 m0, 95232
    s_nop 0
    buffer_load_dwordx4 v8, s[16:19], s50 offen lds
    s_mov_b32 m0, 99328
    s_nop 0
    buffer_load_dwordx4 v9, s[16:19], s50 offen lds
    s_mov_b32 m0, 103424
    s_nop 0
    buffer_load_dwordx4 v10, s[16:19], s50 offen lds
    s_mov_b32 m0, 107520
    s_nop 0
    buffer_load_dwordx4 v11, s[20:23], s50 offen lds
    s_mov_b32 m0, 111616
    s_nop 0
    buffer_load_dwordx4 v12, s[20:23], s50 offen lds
    s_mov_b32 m0, 115712
    s_nop 0
    buffer_load_dwordx4 v13, s[20:23], s50 offen lds
    s_mov_b32 m0, 119808
    s_nop 0
    buffer_load_dwordx4 v14, s[20:23], s50 offen lds
    s_waitcnt vmcnt(21)
    s_barrier
    s_waitcnt vmcnt(14)
    s_barrier
    s_mov_b32 s50, 512
    s_mov_b32 s51, 442368
    s_mov_b32 m0, 125952
    s_nop 0
    buffer_load_dwordx4 v8, s[16:19], s50 offen lds
    s_mov_b32 m0, 130048
    s_nop 0
    buffer_load_dwordx4 v9, s[16:19], s50 offen lds
    s_mov_b32 m0, 134144
    s_nop 0
    buffer_load_dwordx4 v10, s[16:19], s50 offen lds
    s_mov_b32 m0, 138240
    s_nop 0
    buffer_load_dwordx4 v11, s[20:23], s50 offen lds
    s_mov_b32 m0, 142336
    s_nop 0
    buffer_load_dwordx4 v12, s[20:23], s50 offen lds
    s_mov_b32 m0, 146432
    s_nop 0
    buffer_load_dwordx4 v13, s[20:23], s50 offen lds
    s_mov_b32 m0, 150528
    s_nop 0
    buffer_load_dwordx4 v14, s[20:23], s50 offen lds
    s_waitcnt vmcnt(14)
    s_barrier
    s_mov_b32 s50, 640
    s_mov_b32 s51, 552960
    s_mov_b32 m0, 3072
    s_nop 0
    buffer_load_dwordx4 v8, s[16:19], s50 offen lds
    s_mov_b32 m0, 7168
    s_nop 0
    buffer_load_dwordx4 v9, s[16:19], s50 offen lds
    s_mov_b32 m0, 11264
    s_nop 0
    buffer_load_dwordx4 v10, s[16:19], s50 offen lds
    s_mov_b32 m0, 15360
    s_nop 0
    buffer_load_dwordx4 v11, s[20:23], s50 offen lds
    s_mov_b32 m0, 19456
    s_nop 0
    buffer_load_dwordx4 v12, s[20:23], s50 offen lds
    s_mov_b32 m0, 23552
    s_nop 0
    buffer_load_dwordx4 v13, s[20:23], s50 offen lds
    s_mov_b32 m0, 27648
    s_nop 0
    buffer_load_dwordx4 v14, s[20:23], s50 offen lds
    s_waitcnt vmcnt(14)
    s_barrier
    s_mov_b32 s50, 768
    s_mov_b32 s51, 663552
    s_mov_b32 m0, 33792
    s_nop 0
    buffer_load_dwordx4 v8, s[16:19], s50 offen lds
    s_mov_b32 m0, 37888
    s_nop 0
    buffer_load_dwordx4 v9, s[16:19], s50 offen lds
    s_mov_b32 m0, 41984
    s_nop 0
    buffer_load_dwordx4 v10, s[16:19], s50 offen lds
    s_mov_b32 m0, 46080
    s_nop 0
    buffer_load_dwordx4 v11, s[20:23], s50 offen lds
    s_mov_b32 m0, 50176
    s_nop 0
    buffer_load_dwordx4 v12, s[20:23], s50 offen lds
    s_mov_b32 m0, 54272
    s_nop 0
    buffer_load_dwordx4 v13, s[20:23], s50 offen lds
    s_mov_b32 m0, 58368
    s_nop 0
    buffer_load_dwordx4 v14, s[20:23], s50 offen lds
    s_waitcnt vmcnt(14)
    s_barrier
    s_mov_b32 s50, 896
    s_mov_b32 s51, 774144
    s_mov_b32 m0, 64512
    s_nop 0
    buffer_load_dwordx4 v8, s[16:19], s50 offen lds
    s_mov_b32 m0, 68608
    s_nop 0
    buffer_load_dwordx4 v9, s[16:19], s50 offen lds
    s_mov_b32 m0, 72704
    s_nop 0
    buffer_load_dwordx4 v10, s[16:19], s50 offen lds
    s_mov_b32 m0, 76800
    s_nop 0
    buffer_load_dwordx4 v11, s[20:23], s50 offen lds
    s_mov_b32 m0, 80896
    s_nop 0
    buffer_load_dwordx4 v12, s[20:23], s50 offen lds
    s_mov_b32 m0, 84992
    s_nop 0
    buffer_load_dwordx4 v13, s[20:23], s50 offen lds
    s_mov_b32 m0, 89088
    s_nop 0
    buffer_load_dwordx4 v14, s[20:23], s50 offen lds
    s_waitcnt vmcnt(14)
    s_barrier
    s_mov_b32 s50, 1024
    s_mov_b32 s51, 884736
    s_mov_b32 m0, 95232
    s_nop 0
    buffer_load_dwordx4 v8, s[16:19], s50 offen lds
    s_mov_b32 m0, 99328
    s_nop 0
    buffer_load_dwordx4 v9, s[16:19], s50 offen lds
    s_mov_b32 m0, 103424
    s_nop 0
    buffer_load_dwordx4 v10, s[16:19], s50 offen lds
    s_mov_b32 m0, 107520
    s_nop 0
    buffer_load_dwordx4 v11, s[20:23], s50 offen lds
    s_mov_b32 m0, 111616
    s_nop 0
    buffer_load_dwordx4 v12, s[20:23], s50 offen lds
    s_mov_b32 m0, 115712
    s_nop 0
    buffer_load_dwordx4 v13, s[20:23], s50 offen lds
    s_mov_b32 m0, 119808
    s_nop 0
    buffer_load_dwordx4 v14, s[20:23], s50 offen lds
    s_waitcnt vmcnt(14)
    s_barrier
    s_mov_b32 s50, 1152
    s_mov_b32 s51, 995328
    s_mov_b32 m0, 125952
    s_nop 0
    buffer_load_dwordx4 v8, s[16:19], s50 offen lds
    s_mov_b32 m0, 130048
    s_nop 0
    buffer_load_dwordx4 v9, s[16:19], s50 offen lds
    s_mov_b32 m0, 134144
    s_nop 0
    buffer_load_dwordx4 v10, s[16:19], s50 offen lds
    s_mov_b32 m0, 138240
    s_nop 0
    buffer_load_dwordx4 v11, s[20:23], s50 offen lds
    s_mov_b32 m0, 142336
    s_nop 0
    buffer_load_dwordx4 v12, s[20:23], s50 offen lds
    s_mov_b32 m0, 146432
    s_nop 0
    buffer_load_dwordx4 v13, s[20:23], s50 offen lds
    s_mov_b32 m0, 150528
    s_nop 0
    buffer_load_dwordx4 v14, s[20:23], s50 offen lds
    s_waitcnt vmcnt(14)
    s_barrier
    s_waitcnt vmcnt(7)
    s_barrier
    s_waitcnt vmcnt(0)
    s_barrier
    s_branch Lend_12
Lpf_15:
Lend_12:
    s_endpgm
.p2align 8
.type ln2_kernel,@function
ln2_kernel:
    s_cmp_ge_u32 s2, 128
    s_cbranch_scc1 Lend_22
    s_load_dwordx2 s[4:5], s[0:1], 104
    s_waitcnt lgkmcnt(0)
    s_add_u32 s8, s4, 0xaaf000
    s_addc_u32 s9, s5, 0
    s_mov_b32 s10, 0x6c0000
    s_mov_b32 s11, 0x00020000
    s_add_u32 s12, s4, 0x1170000
    s_addc_u32 s13, s5, 0
    s_mov_b32 s14, 0x360000
    s_mov_b32 s15, 0x00020000
    v_and_b32 v2, 63, v0
    v_lshrrev_b32 v3, 6, v0
    v_cmp_gt_u32 vcc, 54, v2
    s_nop 1
    v_cndmask_b32 v4, 0, 1.0, vcc
    s_mov_b64 s[30:31], vcc
    s_mul_i32 s3, s2, 55296
    s_add_u32 s3, s3, 1728
    v_mul_u32_u24 v7, 3456, v3
    v_lshl_add_u32 v7, v2, 4, v7
    v_mov_b32 v12, 0
    v_mov_b32 v13, 0
    v_mov_b32 v14, 0
    v_mov_b32 v15, 0
    v_mov_b32 v16, 0
    v_mov_b32 v17, 0
    v_mov_b32 v18, 0
    v_mov_b32 v19, 0
    s_mov_b64 exec, s[30:31]
    buffer_load_dwordx4 v[12:15], v7, s[8:11], s3 offen
    buffer_load_dwordx4 v[16:19], v7, s[8:11], s3 offen offset:864
    s_mov_b64 exec, -1
    v_lshlrev_b32 v8, 1, v0
    s_add_u32 s24, s3, 0
    buffer_load_ushort v48, v8, s[8:11], s24 offen
    s_add_u32 s24, s3, 3456
    buffer_load_ushort v49, v8, s[8:11], s24 offen
    s_add_u32 s24, s3, 6912
    buffer_load_ushort v50, v8, s[8:11], s24 offen
    s_add_u32 s24, s3, 10368
    buffer_load_ushort v51, v8, s[8:11], s24 offen
    s_add_u32 s24, s3, 13824
    buffer_load_ushort v52, v8, s[8:11], s24 offen
    s_add_u32 s24, s3, 17280
    buffer_load_ushort v53, v8, s[8:11], s24 offen
    s_add_u32 s24, s3, 20736
    buffer_load_ushort v54, v8, s[8:11], s24 offen
    s_add_u32 s24, s3, 24192
    buffer_load_ushort v55, v8, s[8:11], s24 offen
    s_add_u32 s24, s3, 27648
    buffer_load_ushort v56, v8, s[8:11], s24 offen
    s_add_u32 s24, s3, 31104
    buffer_load_ushort v57, v8, s[8:11], s24 offen
    s_add_u32 s24, s3, 34560
    buffer_load_ushort v58, v8, s[8:11], s24 offen
    s_add_u32 s24, s3, 38016
    buffer_load_ushort v59, v8, s[8:11], s24 offen
    s_add_u32 s24, s3, 41472
    buffer_load_ushort v60, v8, s[8:11], s24 offen
    s_add_u32 s24, s3, 44928
    buffer_load_ushort v61, v8, s[8:11], s24 offen
    s_add_u32 s24, s3, 48384
    buffer_load_ushort v62, v8, s[8:11], s24 offen
    s_add_u32 s24, s3, 51840
    buffer_load_ushort v63, v8, s[8:11], s24 offen
    s_waitcnt vmcnt(16)
    v_lshlrev_b32 v24, 16, v12
    v_and_b32 v25, 0xffff0000, v12
    v_lshlrev_b32 v26, 16, v13
    v_and_b32 v27, 0xffff0000, v13
    v_lshlrev_b32 v28, 16, v14
    v_and_b32 v29, 0xffff0000, v14
    v_lshlrev_b32 v30, 16, v15
    v_and_b32 v31, 0xffff0000, v15
    v_lshlrev_b32 v32, 16, v16
    v_and_b32 v33, 0xffff0000, v16
    v_lshlrev_b32 v34, 16, v17
    v_and_b32 v35, 0xffff0000, v17
    v_lshlrev_b32 v36, 16, v18
    v_and_b32 v37, 0xffff0000, v18
    v_lshlrev_b32 v38, 16, v19
    v_and_b32 v39, 0xffff0000, v19
    v_add_f32 v41, v24, v25
    v_mul_f32 v42, v24, v24
    v_fmac_f32 v42, v25, v25
    v_add_f32 v41, v41, v26
    v_fmac_f32 v42, v26, v26
    v_add_f32 v41, v41, v27
    v_fmac_f32 v42, v27, v27
    v_add_f32 v41, v41, v28
    v_fmac_f32 v42, v28, v28
    v_add_f32 v41, v41, v29
    v_fmac_f32 v42, v29, v29
    v_add_f32 v41, v41, v30
    v_fmac_f32 v42, v30, v30
    v_add_f32 v41, v41, v31
    v_fmac_f32 v42, v31, v31
    v_add_f32 v41, v41, v32
    v_fmac_f32 v42, v32, v32
    v_add_f32 v41, v41, v33
    v_fmac_f32 v42, v33, v33
    v_add_f32 v41, v41, v34
    v_fmac_f32 v42, v34, v34
    v_add_f32 v41, v41, v35
    v_fmac_f32 v42, v35, v35
    v_add_f32 v41, v41, v36
    v_fmac_f32 v42, v36, v36
    v_add_f32 v41, v41, v37
    v_fmac_f32 v42, v37, v37
    v_add_f32 v41, v41, v38
    v_fmac_f32 v42, v38, v38
    v_add_f32 v41, v41, v39
    v_fmac_f32 v42, v39, v39
    s_nop 0
    s_nop 0
    v_add_f32_dpp v41, v41, v41 quad_perm:[1,0,3,2] row_mask:0xf bank_mask:0xf
    v_add_f32_dpp v42, v42, v42 quad_perm:[1,0,3,2] row_mask:0xf bank_mask:0xf
    s_nop 0
    v_add_f32_dpp v41, v41, v41 quad_perm:[2,3,0,1] row_mask:0xf bank_mask:0xf
    v_add_f32_dpp v42, v42, v42 quad_perm:[2,3,0,1] row_mask:0xf bank_mask:0xf
    s_nop 0
    v_add_f32_dpp v41, v41, v41 row_half_mirror row_mask:0xf bank_mask:0xf
    v_add_f32_dpp v42, v42, v42 row_half_mirror row_mask:0xf bank_mask:0xf
    s_nop 0
    v_add_f32_dpp v41, v41, v41 row_mirror row_mask:0xf bank_mask:0xf
    v_add_f32_dpp v42, v42, v42 row_mirror row_mask:0xf bank_mask:0xf
    s_nop 0
    v_readlane_b32 s32, v41, 0
    v_readlane_b32 s33, v41, 16
    v_readlane_b32 s34, v41, 32
    v_readlane_b32 s35, v41, 48
    v_readlane_b32 s36, v42, 0
    v_readlane_b32 s37, v42, 16
    v_readlane_b32 s38, v42, 32
    v_readlane_b32 s39, v42, 48
    v_mov_b32 v41, s32
    v_mov_b32 v42, s36
    v_add_f32 v41, s33, v41
    v_add_f32 v42, s37, v42
    v_add_f32 v41, s34, v41
    v_add_f32 v42, s38, v42
    v_add_f32 v41, s35, v41
    v_add_f32 v42, s39, v42
    v_mul_f32 v41, 0x3a97b426, v41
    v_mul_f32 v42, 0x3a97b426, v42
    v_fma_f32 v42, -v41, v41, v42
    v_max_f32 v42, 0, v42
    v_cvt_pk_bf16_f32 v43, v41, v42
    v_lshlrev_b32 v41, 16, v43
    v_and_b32 v42, 0xffff0000, v43
    v_add_f32 v42, 0x3727c5ac, v42
    v_cvt_pk_bf16_f32 v43, v42, v42
    v_lshlrev_b32 v42, 16, v43
    v_sqrt_f32 v42, v42
    s_nop 0
    v_cvt_pk_bf16_f32 v43, v42, v42
    v_lshlrev_b32 v42, 16, v43
    v_rcp_f32 v42, v42
    s_nop 0
    v_lshlrev_b32 v9, 3, v3
    v_mov_b32 v44, v41
    v_mov_b32 v45, v42
    ds_write_b64 v9, v[44:45]
    s_waitcnt lgkmcnt(0)
    s_barrier
    v_cmp_gt_u32 vcc, 864, v0
    s_and_saveexec_b64 s[28:29], vcc
    s_cbranch_execz Lend_22
    v_mov_b32 v9, 0
    ds_read_b128 v[64:67], v9 offset:0
    ds_read_b128 v[68:71], v9 offset:16
    ds_read_b128 v[72:75], v9 offset:32
    ds_read_b128 v[76:79], v9 offset:48
    ds_read_b128 v[80:83], v9 offset:64
    ds_read_b128 v[84:87], v9 offset:80
    ds_read_b128 v[88:91], v9 offset:96
    ds_read_b128 v[92:95], v9 offset:112
    s_waitcnt vmcnt(0) lgkmcnt(0)
    v_lshlrev_b32 v48, 16, v48
    v_lshlrev_b32 v49, 16, v49
    v_sub_f32 v48, v48, v64
    v_sub_f32 v49, v49, v66
    v_cvt_pk_bf16_f32 v43, v48, v49
    v_lshlrev_b32 v48, 16, v43
    v_and_b32 v49, 0xffff0000, v43
    v_mul_f32 v48, v48, v65
    v_mul_f32 v49, v49, v67
    v_cvt_pk_bf16_f32 v24, v48, v49
    v_lshlrev_b32 v50, 16, v50
    v_lshlrev_b32 v51, 16, v51
    v_sub_f32 v50, v50, v68
    v_sub_f32 v51, v51, v70
    v_cvt_pk_bf16_f32 v43, v50, v51
    v_lshlrev_b32 v50, 16, v43
    v_and_b32 v51, 0xffff0000, v43
    v_mul_f32 v50, v50, v69
    v_mul_f32 v51, v51, v71
    v_cvt_pk_bf16_f32 v25, v50, v51
    v_lshlrev_b32 v52, 16, v52
    v_lshlrev_b32 v53, 16, v53
    v_sub_f32 v52, v52, v72
    v_sub_f32 v53, v53, v74
    v_cvt_pk_bf16_f32 v43, v52, v53
    v_lshlrev_b32 v52, 16, v43
    v_and_b32 v53, 0xffff0000, v43
    v_mul_f32 v52, v52, v73
    v_mul_f32 v53, v53, v75
    v_cvt_pk_bf16_f32 v26, v52, v53
    v_lshlrev_b32 v54, 16, v54
    v_lshlrev_b32 v55, 16, v55
    v_sub_f32 v54, v54, v76
    v_sub_f32 v55, v55, v78
    v_cvt_pk_bf16_f32 v43, v54, v55
    v_lshlrev_b32 v54, 16, v43
    v_and_b32 v55, 0xffff0000, v43
    v_mul_f32 v54, v54, v77
    v_mul_f32 v55, v55, v79
    v_cvt_pk_bf16_f32 v27, v54, v55
    v_lshlrev_b32 v56, 16, v56
    v_lshlrev_b32 v57, 16, v57
    v_sub_f32 v56, v56, v80
    v_sub_f32 v57, v57, v82
    v_cvt_pk_bf16_f32 v43, v56, v57
    v_lshlrev_b32 v56, 16, v43
    v_and_b32 v57, 0xffff0000, v43
    v_mul_f32 v56, v56, v81
    v_mul_f32 v57, v57, v83
    v_cvt_pk_bf16_f32 v28, v56, v57
    v_lshlrev_b32 v58, 16, v58
    v_lshlrev_b32 v59, 16, v59
    v_sub_f32 v58, v58, v84
    v_sub_f32 v59, v59, v86
    v_cvt_pk_bf16_f32 v43, v58, v59
    v_lshlrev_b32 v58, 16, v43
    v_and_b32 v59, 0xffff0000, v43
    v_mul_f32 v58, v58, v85
    v_mul_f32 v59, v59, v87
    v_cvt_pk_bf16_f32 v29, v58, v59
    v_lshlrev_b32 v60, 16, v60
    v_lshlrev_b32 v61, 16, v61
    v_sub_f32 v60, v60, v88
    v_sub_f32 v61, v61, v90
    v_cvt_pk_bf16_f32 v43, v60, v61
    v_lshlrev_b32 v60, 16, v43
    v_and_b32 v61, 0xffff0000, v43
    v_mul_f32 v60, v60, v89
    v_mul_f32 v61, v61, v91
    v_cvt_pk_bf16_f32 v30, v60, v61
    v_lshlrev_b32 v62, 16, v62
    v_lshlrev_b32 v63, 16, v63
    v_sub_f32 v62, v62, v92
    v_sub_f32 v63, v63, v94
    v_cvt_pk_bf16_f32 v43, v62, v63
    v_lshlrev_b32 v62, 16, v43
    v_and_b32 v63, 0xffff0000, v43
    v_mul_f32 v62, v62, v93
    v_mul_f32 v63, v63, v95
    v_cvt_pk_bf16_f32 v31, v62, v63
    v_lshlrev_b32 v12, 5, v0
    s_mul_i32 s3, s2, 27648
    buffer_store_dwordx4 v[24:27], v12, s[12:15], s3 offen
    buffer_store_dwordx4 v[28:31], v12, s[12:15], s3 offen offset:16
Lend_22:
    s_endpgm
.p2align 8
.type g2_kernel,@function
g2_kernel:
    s_cmp_ge_u32 s2, 256
    s_cbranch_scc1 Lend_23
    s_load_dwordx2 s[4:5], s[0:1], 104
    s_load_dwordx2 s[6:7], s[0:1], 64
    s_load_dwordx2 s[8:9], s[0:1], 72
    s_and_b32 s40, s2, 7
    s_lshr_b32 s41, s2, 3
    s_and_b32 s42, s40, 1
    s_lshr_b32 s43, s40, 1
    s_mov_b32 s45, 0x40000001
    s_mul_hi_u32 s46, s41, s45
    s_mul_i32 s45, s46, 4
    s_sub_u32 s45, s41, s45
    s_mul_i32 s42, s42, 4
    s_add_u32 s42, s42, s45
    s_mul_i32 s43, s43, 8
    s_add_u32 s43, s43, s46
    s_cmp_ge_u32 s42, 8
    s_cbranch_scc1 Lend_23
    s_mov_b32 s39, s42
    s_mul_i32 s42, s42, 112
    s_sub_u32 s38, s39, 6
    s_max_i32 s38, s38, 0
    s_lshl_b32 s38, s38, 4
    s_sub_u32 s42, s42, s38
    s_mul_i32 s43, s43, 64
    v_lshrrev_b32 v1, 6, v0
    s_nop 0
    v_readfirstlane_b32 s44, v1
    v_and_b32 v2, 63, v0
    v_lshrrev_b32 v5, 4, v2
    s_waitcnt lgkmcnt(0)
    s_cmp_ge_u32 s44, 8
    s_cbranch_scc1 Lpf_26
    s_cmp_ge_u32 s44, 4
    s_cbranch_scc1 Lload_24
    v_and_b32 v3, 15, v2
    v_lshrrev_b32 v4, 1, v3
    v_and_b32 v4, 7, v4
    v_xor_b32 v4, v4, v5
    v_lshlrev_b32 v4, 4, v4
    v_lshl_add_u32 v4, v3, 7, v4
    s_and_b32 s45, s44, 0
    s_lshr_b32 s46, s44, 0
    s_mul_i32 s47, s45, 14336
    s_mul_i32 s48, s46, 2048
    s_add_u32 s48, s48, 14336
    v_add_u32 v8, s47, v4
    v_add_u32 v9, s47, v4
    v_add_u32 v9, 45056, v9
    v_add_u32 v10, s47, v4
    v_add_u32 v10, 90112, v10
    v_add_u32 v11, s47, v4
    v_xor_b32 v11, 64, v11
    v_add_u32 v12, s47, v4
    v_xor_b32 v12, 64, v12
    v_add_u32 v12, 45056, v12
    v_add_u32 v13, s47, v4
    v_xor_b32 v13, 64, v13
    v_add_u32 v13, 90112, v13
    v_add_u32 v14, s48, v4
    v_add_u32 v15, s48, v4
    v_add_u32 v15, 45056, v15
    v_add_u32 v16, s48, v4
    v_add_u32 v16, 90112, v16
    v_add_u32 v17, s48, v4
    v_xor_b32 v17, 64, v17
    v_add_u32 v18, s48, v4
    v_xor_b32 v18, 64, v18
    v_add_u32 v18, 45056, v18
    v_add_u32 v19, s48, v4
    v_xor_b32 v19, 64, v19
    v_add_u32 v19, 90112, v19
    v_mov_b32 v84, 0
    v_mov_b32 v85, 0
    v_mov_b32 v86, 0
    v_mov_b32 v87, 0
    v_mov_b32 v88, 0
    v_mov_b32 v89, 0
    v_mov_b32 v90, 0
    v_mov_b32 v91, 0
    v_mov_b32 v92, 0
    v_mov_b32 v93, 0
    v_mov_b32 v94, 0
    v_mov_b32 v95, 0
    v_mov_b32 v96, 0
    v_mov_b32 v97, 0
    v_mov_b32 v98, 0
    v_mov_b32 v99, 0
    v_mov_b32 v100, 0
    v_mov_b32 v101, 0
    v_mov_b32 v102, 0
    v_mov_b32 v103, 0
    v_mov_b32 v104, 0
    v_mov_b32 v105, 0
    v_mov_b32 v106, 0
    v_mov_b32 v107, 0
    v_mov_b32 v108, 0
    v_mov_b32 v109, 0
    v_mov_b32 v110, 0
    v_mov_b32 v111, 0
    v_and_b32 v3, 15, v2
    s_mul_i32 s47, s46, 16
    s_add_u32 s47, s47, s43
    v_add_u32 v3, s47, v3
    v_lshrrev_b32 v4, 4, v2
    v_lshlrev_b32 v4, 2, v4
    s_mul_i32 s47, s45, 112
    s_add_u32 s47, s47, s42
    v_add_u32 v4, s47, v4
    s_barrier
    ds_read_b128 v[20:23], v8 offset:0
    ds_read_b128 v[76:79], v14 offset:0
    ds_read_b128 v[24:27], v8 offset:2048
    ds_read_b128 v[28:31], v8 offset:4096
    ds_read_b128 v[32:35], v8 offset:6144
    ds_read_b128 v[36:39], v8 offset:8192
    ds_read_b128 v[40:43], v8 offset:10240
    ds_read_b128 v[44:47], v8 offset:12288
    ds_read_b128 v[48:51], v11 offset:0
    ds_read_b128 v[80:83], v17 offset:0
    ds_read_b128 v[52:55], v11 offset:2048
    ds_read_b128 v[56:59], v11 offset:4096
    ds_read_b128 v[60:63], v11 offset:6144
    ds_read_b128 v[64:67], v11 offset:8192
    ds_read_b128 v[68:71], v11 offset:10240
    ds_read_b128 v[72:75], v11 offset:12288
    s_waitcnt lgkmcnt(8)
    v_mfma_f32_16x16x32_bf16 v[84:87], v[20:23], v[76:79], v[84:87]
    v_mfma_f32_16x16x32_bf16 v[88:91], v[24:27], v[76:79], v[88:91]
    v_mfma_f32_16x16x32_bf16 v[92:95], v[28:31], v[76:79], v[92:95]
    v_mfma_f32_16x16x32_bf16 v[96:99], v[32:35], v[76:79], v[96:99]
    v_mfma_f32_16x16x32_bf16 v[100:103], v[36:39], v[76:79], v[100:103]
    v_mfma_f32_16x16x32_bf16 v[104:107], v[40:43], v[76:79], v[104:107]
    v_mfma_f32_16x16x32_bf16 v[108:111], v[44:47], v[76:79], v[108:111]
    s_waitcnt lgkmcnt(0)
    s_barrier
    ds_read_b128 v[20:23], v8 offset:22528
    ds_read_b128 v[76:79], v14 offset:22528
    ds_read_b128 v[24:27], v8 offset:24576
    ds_read_b128 v[28:31], v8 offset:26624
    ds_read_b128 v[32:35], v8 offset:28672
    ds_read_b128 v[36:39], v8 offset:30720
    ds_read_b128 v[40:43], v8 offset:32768
    ds_read_b128 v[44:47], v8 offset:34816
    v_mfma_f32_16x16x32_bf16 v[84:87], v[48:51], v[80:83], v[84:87]
    v_mfma_f32_16x16x32_bf16 v[88:91], v[52:55], v[80:83], v[88:91]
    v_mfma_f32_16x16x32_bf16 v[92:95], v[56:59], v[80:83], v[92:95]
    v_mfma_f32_16x16x32_bf16 v[96:99], v[60:63], v[80:83], v[96:99]
    v_mfma_f32_16x16x32_bf16 v[100:103], v[64:67], v[80:83], v[100:103]
    v_mfma_f32_16x16x32_bf16 v[104:107], v[68:71], v[80:83], v[104:107]
    v_mfma_f32_16x16x32_bf16 v[108:111], v[72:75], v[80:83], v[108:111]
    ds_read_b128 v[48:51], v11 offset:22528
    ds_read_b128 v[80:83], v17 offset:22528
    ds_read_b128 v[52:55], v11 offset:24576
    ds_read_b128 v[56:59], v11 offset:26624
    ds_read_b128 v[60:63], v11 offset:28672
    ds_read_b128 v[64:67], v11 offset:30720
    ds_read_b128 v[68:71], v11 offset:32768
    ds_read_b128 v[72:75], v11 offset:34816
    s_waitcnt lgkmcnt(8)
    v_mfma_f32_16x16x32_bf16 v[84:87], v[20:23], v[76:79], v[84:87]
    v_mfma_f32_16x16x32_bf16 v[88:91], v[24:27], v[76:79], v[88:91]
    v_mfma_f32_16x16x32_bf16 v[92:95], v[28:31], v[76:79], v[92:95]
    v_mfma_f32_16x16x32_bf16 v[96:99], v[32:35], v[76:79], v[96:99]
    v_mfma_f32_16x16x32_bf16 v[100:103], v[36:39], v[76:79], v[100:103]
    v_mfma_f32_16x16x32_bf16 v[104:107], v[40:43], v[76:79], v[104:107]
    v_mfma_f32_16x16x32_bf16 v[108:111], v[44:47], v[76:79], v[108:111]
    s_waitcnt lgkmcnt(0)
    s_barrier
    ds_read_b128 v[20:23], v9 offset:0
    ds_read_b128 v[76:79], v15 offset:0
    ds_read_b128 v[24:27], v9 offset:2048
    ds_read_b128 v[28:31], v9 offset:4096
    ds_read_b128 v[32:35], v9 offset:6144
    ds_read_b128 v[36:39], v9 offset:8192
    ds_read_b128 v[40:43], v9 offset:10240
    ds_read_b128 v[44:47], v9 offset:12288
    v_mfma_f32_16x16x32_bf16 v[84:87], v[48:51], v[80:83], v[84:87]
    v_mfma_f32_16x16x32_bf16 v[88:91], v[52:55], v[80:83], v[88:91]
    v_mfma_f32_16x16x32_bf16 v[92:95], v[56:59], v[80:83], v[92:95]
    v_mfma_f32_16x16x32_bf16 v[96:99], v[60:63], v[80:83], v[96:99]
    v_mfma_f32_16x16x32_bf16 v[100:103], v[64:67], v[80:83], v[100:103]
    v_mfma_f32_16x16x32_bf16 v[104:107], v[68:71], v[80:83], v[104:107]
    v_mfma_f32_16x16x32_bf16 v[108:111], v[72:75], v[80:83], v[108:111]
    ds_read_b128 v[48:51], v12 offset:0
    ds_read_b128 v[80:83], v18 offset:0
    ds_read_b128 v[52:55], v12 offset:2048
    ds_read_b128 v[56:59], v12 offset:4096
    ds_read_b128 v[60:63], v12 offset:6144
    ds_read_b128 v[64:67], v12 offset:8192
    ds_read_b128 v[68:71], v12 offset:10240
    ds_read_b128 v[72:75], v12 offset:12288
    s_waitcnt lgkmcnt(8)
    v_mfma_f32_16x16x32_bf16 v[84:87], v[20:23], v[76:79], v[84:87]
    v_mfma_f32_16x16x32_bf16 v[88:91], v[24:27], v[76:79], v[88:91]
    v_mfma_f32_16x16x32_bf16 v[92:95], v[28:31], v[76:79], v[92:95]
    v_mfma_f32_16x16x32_bf16 v[96:99], v[32:35], v[76:79], v[96:99]
    v_mfma_f32_16x16x32_bf16 v[100:103], v[36:39], v[76:79], v[100:103]
    v_mfma_f32_16x16x32_bf16 v[104:107], v[40:43], v[76:79], v[104:107]
    v_mfma_f32_16x16x32_bf16 v[108:111], v[44:47], v[76:79], v[108:111]
    s_waitcnt lgkmcnt(0)
    s_barrier
    ds_read_b128 v[20:23], v9 offset:22528
    ds_read_b128 v[76:79], v15 offset:22528
    ds_read_b128 v[24:27], v9 offset:24576
    ds_read_b128 v[28:31], v9 offset:26624
    ds_read_b128 v[32:35], v9 offset:28672
    ds_read_b128 v[36:39], v9 offset:30720
    ds_read_b128 v[40:43], v9 offset:32768
    ds_read_b128 v[44:47], v9 offset:34816
    s_add_u32 s24, s4, 0xaaf000
    s_addc_u32 s25, s5, 0
    s_mov_b32 s26, 0x6c0000
    s_mov_b32 s27, 0x00020000
    s_add_u32 s28, s4, 0x14d1000
    s_addc_u32 s29, s5, 0
    s_mov_b32 s30, 0x360000
    s_mov_b32 s31, 0x00020000
    s_mov_b32 s32, s8
    s_mov_b32 s33, s9
    s_mov_b32 s34, 0x1000
    s_mov_b32 s35, 0x00020000
    v_mul_u32_u24 v5, 3456, v3
    v_lshl_add_u32 v5, v4, 1, v5
    v_mul_u32_u24 v6, 1728, v3
    v_lshl_add_u32 v6, v4, 1, v6
    v_lshlrev_b32 v7, 1, v3
    buffer_load_ushort v112, v7, s[32:35], 0 offen offset:0
    buffer_load_dwordx2 v[116:117], v5, s[24:27], 0 offen offset:0
    buffer_load_dwordx2 v[118:119], v5, s[24:27], 0 offen offset:32
    buffer_load_dwordx2 v[120:121], v5, s[24:27], 0 offen offset:64
    buffer_load_dwordx2 v[122:123], v5, s[24:27], 0 offen offset:96
    buffer_load_dwordx2 v[124:125], v5, s[24:27], 0 offen offset:128
    buffer_load_dwordx2 v[126:127], v5, s[24:27], 0 offen offset:160
    buffer_load_dwordx2 v[128:129], v5, s[24:27], 0 offen offset:192
    v_add_u32 v5, 55296, v5
    v_mfma_f32_16x16x32_bf16 v[84:87], v[48:51], v[80:83], v[84:87]
    v_mfma_f32_16x16x32_bf16 v[88:91], v[52:55], v[80:83], v[88:91]
    v_mfma_f32_16x16x32_bf16 v[92:95], v[56:59], v[80:83], v[92:95]
    v_mfma_f32_16x16x32_bf16 v[96:99], v[60:63], v[80:83], v[96:99]
    v_mfma_f32_16x16x32_bf16 v[100:103], v[64:67], v[80:83], v[100:103]
    v_mfma_f32_16x16x32_bf16 v[104:107], v[68:71], v[80:83], v[104:107]
    v_mfma_f32_16x16x32_bf16 v[108:111], v[72:75], v[80:83], v[108:111]
    ds_read_b128 v[48:51], v12 offset:22528
    ds_read_b128 v[80:83], v18 offset:22528
    ds_read_b128 v[52:55], v12 offset:24576
    ds_read_b128 v[56:59], v12 offset:26624
    ds_read_b128 v[60:63], v12 offset:28672
    ds_read_b128 v[64:67], v12 offset:30720
    ds_read_b128 v[68:71], v12 offset:32768
    ds_read_b128 v[72:75], v12 offset:34816
    s_waitcnt lgkmcnt(8)
    v_mfma_f32_16x16x32_bf16 v[84:87], v[20:23], v[76:79], v[84:87]
    v_mfma_f32_16x16x32_bf16 v[88:91], v[24:27], v[76:79], v[88:91]
    v_mfma_f32_16x16x32_bf16 v[92:95], v[28:31], v[76:79], v[92:95]
    v_mfma_f32_16x16x32_bf16 v[96:99], v[32:35], v[76:79], v[96:99]
    v_mfma_f32_16x16x32_bf16 v[100:103], v[36:39], v[76:79], v[100:103]
    v_mfma_f32_16x16x32_bf16 v[104:107], v[40:43], v[76:79], v[104:107]
    v_mfma_f32_16x16x32_bf16 v[108:111], v[44:47], v[76:79], v[108:111]
    s_waitcnt lgkmcnt(0)
    s_barrier
    ds_read_b128 v[20:23], v10 offset:0
    ds_read_b128 v[76:79], v16 offset:0
    ds_read_b128 v[24:27], v10 offset:2048
    ds_read_b128 v[28:31], v10 offset:4096
    ds_read_b128 v[32:35], v10 offset:6144
    ds_read_b128 v[36:39], v10 offset:8192
    ds_read_b128 v[40:43], v10 offset:10240
    ds_read_b128 v[44:47], v10 offset:12288
    v_mfma_f32_16x16x32_bf16 v[84:87], v[48:51], v[80:83], v[84:87]
    v_mfma_f32_16x16x32_bf16 v[88:91], v[52:55], v[80:83], v[88:91]
    v_mfma_f32_16x16x32_bf16 v[92:95], v[56:59], v[80:83], v[92:95]
    v_mfma_f32_16x16x32_bf16 v[96:99], v[60:63], v[80:83], v[96:99]
    v_mfma_f32_16x16x32_bf16 v[100:103], v[64:67], v[80:83], v[100:103]
    v_mfma_f32_16x16x32_bf16 v[104:107], v[68:71], v[80:83], v[104:107]
    v_mfma_f32_16x16x32_bf16 v[108:111], v[72:75], v[80:83], v[108:111]
    ds_read_b128 v[48:51], v13 offset:0
    ds_read_b128 v[80:83], v19 offset:0
    ds_read_b128 v[52:55], v13 offset:2048
    ds_read_b128 v[56:59], v13 offset:4096
    ds_read_b128 v[60:63], v13 offset:6144
    ds_read_b128 v[64:67], v13 offset:8192
    ds_read_b128 v[68:71], v13 offset:10240
    ds_read_b128 v[72:75], v13 offset:12288
    s_waitcnt lgkmcnt(8)
    v_mfma_f32_16x16x32_bf16 v[84:87], v[20:23], v[76:79], v[84:87]
    v_mfma_f32_16x16x32_bf16 v[88:91], v[24:27], v[76:79], v[88:91]
    v_mfma_f32_16x16x32_bf16 v[92:95], v[28:31], v[76:79], v[92:95]
    v_mfma_f32_16x16x32_bf16 v[96:99], v[32:35], v[76:79], v[96:99]
    v_mfma_f32_16x16x32_bf16 v[100:103], v[36:39], v[76:79], v[100:103]
    v_mfma_f32_16x16x32_bf16 v[104:107], v[40:43], v[76:79], v[104:107]
    v_mfma_f32_16x16x32_bf16 v[108:111], v[44:47], v[76:79], v[108:111]
    s_waitcnt lgkmcnt(0)
    s_barrier
    ds_read_b128 v[20:23], v10 offset:22528
    ds_read_b128 v[76:79], v16 offset:22528
    ds_read_b128 v[24:27], v10 offset:24576
    ds_read_b128 v[28:31], v10 offset:26624
    ds_read_b128 v[32:35], v10 offset:28672
    ds_read_b128 v[36:39], v10 offset:30720
    ds_read_b128 v[40:43], v10 offset:32768
    ds_read_b128 v[44:47], v10 offset:34816
    v_mfma_f32_16x16x32_bf16 v[84:87], v[48:51], v[80:83], v[84:87]
    v_mfma_f32_16x16x32_bf16 v[88:91], v[52:55], v[80:83], v[88:91]
    v_mfma_f32_16x16x32_bf16 v[92:95], v[56:59], v[80:83], v[92:95]
    v_mfma_f32_16x16x32_bf16 v[96:99], v[60:63], v[80:83], v[96:99]
    v_mfma_f32_16x16x32_bf16 v[100:103], v[64:67], v[80:83], v[100:103]
    v_mfma_f32_16x16x32_bf16 v[104:107], v[68:71], v[80:83], v[104:107]
    v_mfma_f32_16x16x32_bf16 v[108:111], v[72:75], v[80:83], v[108:111]
    ds_read_b128 v[48:51], v13 offset:22528
    ds_read_b128 v[80:83], v19 offset:22528
    ds_read_b128 v[52:55], v13 offset:24576
    ds_read_b128 v[56:59], v13 offset:26624
    ds_read_b128 v[60:63], v13 offset:28672
    ds_read_b128 v[64:67], v13 offset:30720
    ds_read_b128 v[68:71], v13 offset:32768
    ds_read_b128 v[72:75], v13 offset:34816
    s_waitcnt lgkmcnt(8)
    v_mfma_f32_16x16x32_bf16 v[84:87], v[20:23], v[76:79], v[84:87]
    v_mfma_f32_16x16x32_bf16 v[88:91], v[24:27], v[76:79], v[88:91]
    v_mfma_f32_16x16x32_bf16 v[92:95], v[28:31], v[76:79], v[92:95]
    v_mfma_f32_16x16x32_bf16 v[96:99], v[32:35], v[76:79], v[96:99]
    v_mfma_f32_16x16x32_bf16 v[100:103], v[36:39], v[76:79], v[100:103]
    v_mfma_f32_16x16x32_bf16 v[104:107], v[40:43], v[76:79], v[104:107]
    v_mfma_f32_16x16x32_bf16 v[108:111], v[44:47], v[76:79], v[108:111]
    s_waitcnt lgkmcnt(0)
    s_barrier
    ds_read_b128 v[20:23], v8 offset:0
    ds_read_b128 v[76:79], v14 offset:0
    ds_read_b128 v[24:27], v8 offset:2048
    ds_read_b128 v[28:31], v8 offset:4096
    ds_read_b128 v[32:35], v8 offset:6144
    ds_read_b128 v[36:39], v8 offset:8192
    ds_read_b128 v[40:43], v8 offset:10240
    ds_read_b128 v[44:47], v8 offset:12288
    v_mfma_f32_16x16x32_bf16 v[84:87], v[48:51], v[80:83], v[84:87]
    v_mfma_f32_16x16x32_bf16 v[88:91], v[52:55], v[80:83], v[88:91]
    v_mfma_f32_16x16x32_bf16 v[92:95], v[56:59], v[80:83], v[92:95]
    v_mfma_f32_16x16x32_bf16 v[96:99], v[60:63], v[80:83], v[96:99]
    v_mfma_f32_16x16x32_bf16 v[100:103], v[64:67], v[80:83], v[100:103]
    v_mfma_f32_16x16x32_bf16 v[104:107], v[68:71], v[80:83], v[104:107]
    v_mfma_f32_16x16x32_bf16 v[108:111], v[72:75], v[80:83], v[108:111]
    ds_read_b128 v[48:51], v11 offset:0
    ds_read_b128 v[80:83], v17 offset:0
    ds_read_b128 v[52:55], v11 offset:2048
    ds_read_b128 v[56:59], v11 offset:4096
    ds_read_b128 v[60:63], v11 offset:6144
    ds_read_b128 v[64:67], v11 offset:8192
    ds_read_b128 v[68:71], v11 offset:10240
    ds_read_b128 v[72:75], v11 offset:12288
    s_waitcnt lgkmcnt(8)
    v_mfma_f32_16x16x32_bf16 v[84:87], v[20:23], v[76:79], v[84:87]
    v_mfma_f32_16x16x32_bf16 v[88:91], v[24:27], v[76:79], v[88:91]
    v_mfma_f32_16x16x32_bf16 v[92:95], v[28:31], v[76:79], v[92:95]
    v_mfma_f32_16x16x32_bf16 v[96:99], v[32:35], v[76:79], v[96:99]
    v_mfma_f32_16x16x32_bf16 v[100:103], v[36:39], v[76:79], v[100:103]
    v_mfma_f32_16x16x32_bf16 v[104:107], v[40:43], v[76:79], v[104:107]
    v_mfma_f32_16x16x32_bf16 v[108:111], v[44:47], v[76:79], v[108:111]
    s_waitcnt lgkmcnt(0)
    s_barrier
    ds_read_b128 v[20:23], v8 offset:22528
    ds_read_b128 v[76:79], v14 offset:22528
    ds_read_b128 v[24:27], v8 offset:24576
    ds_read_b128 v[28:31], v8 offset:26624
    ds_read_b128 v[32:35], v8 offset:28672
    ds_read_b128 v[36:39], v8 offset:30720
    ds_read_b128 v[40:43], v8 offset:32768
    ds_read_b128 v[44:47], v8 offset:34816
    v_mfma_f32_16x16x32_bf16 v[84:87], v[48:51], v[80:83], v[84:87]
    v_mfma_f32_16x16x32_bf16 v[88:91], v[52:55], v[80:83], v[88:91]
    v_mfma_f32_16x16x32_bf16 v[92:95], v[56:59], v[80:83], v[92:95]
    v_mfma_f32_16x16x32_bf16 v[96:99], v[60:63], v[80:83], v[96:99]
    v_mfma_f32_16x16x32_bf16 v[100:103], v[64:67], v[80:83], v[100:103]
    v_mfma_f32_16x16x32_bf16 v[104:107], v[68:71], v[80:83], v[104:107]
    v_mfma_f32_16x16x32_bf16 v[108:111], v[72:75], v[80:83], v[108:111]
    ds_read_b128 v[48:51], v11 offset:22528
    ds_read_b128 v[80:83], v17 offset:22528
    ds_read_b128 v[52:55], v11 offset:24576
    ds_read_b128 v[56:59], v11 offset:26624
    ds_read_b128 v[60:63], v11 offset:28672
    ds_read_b128 v[64:67], v11 offset:30720
    ds_read_b128 v[68:71], v11 offset:32768
    ds_read_b128 v[72:75], v11 offset:34816
    s_waitcnt lgkmcnt(8)
    v_mfma_f32_16x16x32_bf16 v[84:87], v[20:23], v[76:79], v[84:87]
    v_mfma_f32_16x16x32_bf16 v[88:91], v[24:27], v[76:79], v[88:91]
    v_mfma_f32_16x16x32_bf16 v[92:95], v[28:31], v[76:79], v[92:95]
    v_mfma_f32_16x16x32_bf16 v[96:99], v[32:35], v[76:79], v[96:99]
    v_mfma_f32_16x16x32_bf16 v[100:103], v[36:39], v[76:79], v[100:103]
    v_mfma_f32_16x16x32_bf16 v[104:107], v[40:43], v[76:79], v[104:107]
    v_mfma_f32_16x16x32_bf16 v[108:111], v[44:47], v[76:79], v[108:111]
    s_waitcnt lgkmcnt(0)
    s_barrier
    ds_read_b128 v[20:23], v9 offset:0
    ds_read_b128 v[76:79], v15 offset:0
    ds_read_b128 v[24:27], v9 offset:2048
    ds_read_b128 v[28:31], v9 offset:4096
    ds_read_b128 v[32:35], v9 offset:6144
    ds_read_b128 v[36:39], v9 offset:8192
    ds_read_b128 v[40:43], v9 offset:10240
    ds_read_b128 v[44:47], v9 offset:12288
    v_mfma_f32_16x16x32_bf16 v[84:87], v[48:51], v[80:83], v[84:87]
    v_mfma_f32_16x16x32_bf16 v[88:91], v[52:55], v[80:83], v[88:91]
    v_mfma_f32_16x16x32_bf16 v[92:95], v[56:59], v[80:83], v[92:95]
    v_mfma_f32_16x16x32_bf16 v[96:99], v[60:63], v[80:83], v[96:99]
    v_mfma_f32_16x16x32_bf16 v[100:103], v[64:67], v[80:83], v[100:103]
    v_mfma_f32_16x16x32_bf16 v[104:107], v[68:71], v[80:83], v[104:107]
    v_mfma_f32_16x16x32_bf16 v[108:111], v[72:75], v[80:83], v[108:111]
    ds_read_b128 v[48:51], v12 offset:0
    ds_read_b128 v[80:83], v18 offset:0
    ds_read_b128 v[52:55], v12 offset:2048
    ds_read_b128 v[56:59], v12 offset:4096
    ds_read_b128 v[60:63], v12 offset:6144
    ds_read_b128 v[64:67], v12 offset:8192
    ds_read_b128 v[68:71], v12 offset:10240
    ds_read_b128 v[72:75], v12 offset:12288
    s_waitcnt lgkmcnt(8)
    v_mfma_f32_16x16x32_bf16 v[84:87], v[20:23], v[76:79], v[84:87]
    v_mfma_f32_16x16x32_bf16 v[88:91], v[24:27], v[76:79], v[88:91]
    v_mfma_f32_16x16x32_bf16 v[92:95], v[28:31], v[76:79], v[92:95]
    v_mfma_f32_16x16x32_bf16 v[96:99], v[32:35], v[76:79], v[96:99]
    v_mfma_f32_16x16x32_bf16 v[100:103], v[36:39], v[76:79], v[100:103]
    v_mfma_f32_16x16x32_bf16 v[104:107], v[40:43], v[76:79], v[104:107]
    v_mfma_f32_16x16x32_bf16 v[108:111], v[44:47], v[76:79], v[108:111]
    s_waitcnt lgkmcnt(0)
    s_barrier
    ds_read_b128 v[20:23], v9 offset:22528
    ds_read_b128 v[76:79], v15 offset:22528
    ds_read_b128 v[24:27], v9 offset:24576
    ds_read_b128 v[28:31], v9 offset:26624
    ds_read_b128 v[32:35], v9 offset:28672
    ds_read_b128 v[36:39], v9 offset:30720
    ds_read_b128 v[40:43], v9 offset:32768
    ds_read_b128 v[44:47], v9 offset:34816
    v_mfma_f32_16x16x32_bf16 v[84:87], v[48:51], v[80:83], v[84:87]
    v_mfma_f32_16x16x32_bf16 v[88:91], v[52:55], v[80:83], v[88:91]
    v_mfma_f32_16x16x32_bf16 v[92:95], v[56:59], v[80:83], v[92:95]
    v_mfma_f32_16x16x32_bf16 v[96:99], v[60:63], v[80:83], v[96:99]
    v_mfma_f32_16x16x32_bf16 v[100:103], v[64:67], v[80:83], v[100:103]
    v_mfma_f32_16x16x32_bf16 v[104:107], v[68:71], v[80:83], v[104:107]
    v_mfma_f32_16x16x32_bf16 v[108:111], v[72:75], v[80:83], v[108:111]
    ds_read_b128 v[48:51], v12 offset:22528
    ds_read_b128 v[80:83], v18 offset:22528
    ds_read_b128 v[52:55], v12 offset:24576
    ds_read_b128 v[56:59], v12 offset:26624
    ds_read_b128 v[60:63], v12 offset:28672
    ds_read_b128 v[64:67], v12 offset:30720
    ds_read_b128 v[68:71], v12 offset:32768
    ds_read_b128 v[72:75], v12 offset:34816
    s_waitcnt lgkmcnt(8)
    v_mfma_f32_16x16x32_bf16 v[84:87], v[20:23], v[76:79], v[84:87]
    v_mfma_f32_16x16x32_bf16 v[88:91], v[24:27], v[76:79], v[88:91]
    v_mfma_f32_16x16x32_bf16 v[92:95], v[28:31], v[76:79], v[92:95]
    v_mfma_f32_16x16x32_bf16 v[96:99], v[32:35], v[76:79], v[96:99]
    v_mfma_f32_16x16x32_bf16 v[100:103], v[36:39], v[76:79], v[100:103]
    v_mfma_f32_16x16x32_bf16 v[104:107], v[40:43], v[76:79], v[104:107]
    v_mfma_f32_16x16x32_bf16 v[108:111], v[44:47], v[76:79], v[108:111]
    s_waitcnt lgkmcnt(0)
    s_barrier
    ds_read_b128 v[20:23], v10 offset:0
    ds_read_b128 v[76:79], v16 offset:0
    ds_read_b128 v[24:27], v10 offset:2048
    ds_read_b128 v[28:31], v10 offset:4096
    ds_read_b128 v[32:35], v10 offset:6144
    ds_read_b128 v[36:39], v10 offset:8192
    ds_read_b128 v[40:43], v10 offset:10240
    ds_read_b128 v[44:47], v10 offset:12288
    v_mfma_f32_16x16x32_bf16 v[84:87], v[48:51], v[80:83], v[84:87]
    v_mfma_f32_16x16x32_bf16 v[88:91], v[52:55], v[80:83], v[88:91]
    v_mfma_f32_16x16x32_bf16 v[92:95], v[56:59], v[80:83], v[92:95]
    v_mfma_f32_16x16x32_bf16 v[96:99], v[60:63], v[80:83], v[96:99]
    v_mfma_f32_16x16x32_bf16 v[100:103], v[64:67], v[80:83], v[100:103]
    v_mfma_f32_16x16x32_bf16 v[104:107], v[68:71], v[80:83], v[104:107]
    v_mfma_f32_16x16x32_bf16 v[108:111], v[72:75], v[80:83], v[108:111]
    ds_read_b128 v[48:51], v13 offset:0
    ds_read_b128 v[80:83], v19 offset:0
    ds_read_b128 v[52:55], v13 offset:2048
    ds_read_b128 v[56:59], v13 offset:4096
    ds_read_b128 v[60:63], v13 offset:6144
    ds_read_b128 v[64:67], v13 offset:8192
    ds_read_b128 v[68:71], v13 offset:10240
    ds_read_b128 v[72:75], v13 offset:12288
    s_waitcnt lgkmcnt(8)
    v_mfma_f32_16x16x32_bf16 v[84:87], v[20:23], v[76:79], v[84:87]
    v_mfma_f32_16x16x32_bf16 v[88:91], v[24:27], v[76:79], v[88:91]
    v_mfma_f32_16x16x32_bf16 v[92:95], v[28:31], v[76:79], v[92:95]
    v_mfma_f32_16x16x32_bf16 v[96:99], v[32:35], v[76:79], v[96:99]
    v_mfma_f32_16x16x32_bf16 v[100:103], v[36:39], v[76:79], v[100:103]
    v_mfma_f32_16x16x32_bf16 v[104:107], v[40:43], v[76:79], v[104:107]
    v_mfma_f32_16x16x32_bf16 v[108:111], v[44:47], v[76:79], v[108:111]
    s_waitcnt lgkmcnt(0)
    s_barrier
    ds_read_b128 v[20:23], v10 offset:22528
    ds_read_b128 v[76:79], v16 offset:22528
    ds_read_b128 v[24:27], v10 offset:24576
    ds_read_b128 v[28:31], v10 offset:26624
    ds_read_b128 v[32:35], v10 offset:28672
    ds_read_b128 v[36:39], v10 offset:30720
    ds_read_b128 v[40:43], v10 offset:32768
    ds_read_b128 v[44:47], v10 offset:34816
    v_mfma_f32_16x16x32_bf16 v[84:87], v[48:51], v[80:83], v[84:87]
    v_mfma_f32_16x16x32_bf16 v[88:91], v[52:55], v[80:83], v[88:91]
    v_mfma_f32_16x16x32_bf16 v[92:95], v[56:59], v[80:83], v[92:95]
    v_mfma_f32_16x16x32_bf16 v[96:99], v[60:63], v[80:83], v[96:99]
    v_mfma_f32_16x16x32_bf16 v[100:103], v[64:67], v[80:83], v[100:103]
    v_mfma_f32_16x16x32_bf16 v[104:107], v[68:71], v[80:83], v[104:107]
    v_mfma_f32_16x16x32_bf16 v[108:111], v[72:75], v[80:83], v[108:111]
    ds_read_b128 v[48:51], v13 offset:22528
    ds_read_b128 v[80:83], v19 offset:22528
    ds_read_b128 v[52:55], v13 offset:24576
    ds_read_b128 v[56:59], v13 offset:26624
    ds_read_b128 v[60:63], v13 offset:28672
    ds_read_b128 v[64:67], v13 offset:30720
    ds_read_b128 v[68:71], v13 offset:32768
    ds_read_b128 v[72:75], v13 offset:34816
    s_waitcnt lgkmcnt(8)
    v_mfma_f32_16x16x32_bf16 v[84:87], v[20:23], v[76:79], v[84:87]
    v_mfma_f32_16x16x32_bf16 v[88:91], v[24:27], v[76:79], v[88:91]
    v_mfma_f32_16x16x32_bf16 v[92:95], v[28:31], v[76:79], v[92:95]
    v_mfma_f32_16x16x32_bf16 v[96:99], v[32:35], v[76:79], v[96:99]
    v_mfma_f32_16x16x32_bf16 v[100:103], v[36:39], v[76:79], v[100:103]
    v_mfma_f32_16x16x32_bf16 v[104:107], v[40:43], v[76:79], v[104:107]
    v_mfma_f32_16x16x32_bf16 v[108:111], v[44:47], v[76:79], v[108:111]
    s_waitcnt lgkmcnt(0)
    s_barrier
    ds_read_b128 v[20:23], v8 offset:0
    ds_read_b128 v[76:79], v14 offset:0
    ds_read_b128 v[24:27], v8 offset:2048
    ds_read_b128 v[28:31], v8 offset:4096
    ds_read_b128 v[32:35], v8 offset:6144
    ds_read_b128 v[36:39], v8 offset:8192
    ds_read_b128 v[40:43], v8 offset:10240
    ds_read_b128 v[44:47], v8 offset:12288
    v_mfma_f32_16x16x32_bf16 v[84:87], v[48:51], v[80:83], v[84:87]
    v_mfma_f32_16x16x32_bf16 v[88:91], v[52:55], v[80:83], v[88:91]
    v_mfma_f32_16x16x32_bf16 v[92:95], v[56:59], v[80:83], v[92:95]
    v_mfma_f32_16x16x32_bf16 v[96:99], v[60:63], v[80:83], v[96:99]
    v_mfma_f32_16x16x32_bf16 v[100:103], v[64:67], v[80:83], v[100:103]
    v_mfma_f32_16x16x32_bf16 v[104:107], v[68:71], v[80:83], v[104:107]
    v_mfma_f32_16x16x32_bf16 v[108:111], v[72:75], v[80:83], v[108:111]
    ds_read_b128 v[48:51], v11 offset:0
    ds_read_b128 v[80:83], v17 offset:0
    ds_read_b128 v[52:55], v11 offset:2048
    ds_read_b128 v[56:59], v11 offset:4096
    ds_read_b128 v[60:63], v11 offset:6144
    ds_read_b128 v[64:67], v11 offset:8192
    ds_read_b128 v[68:71], v11 offset:10240
    ds_read_b128 v[72:75], v11 offset:12288
    s_waitcnt lgkmcnt(8)
    v_mfma_f32_16x16x32_bf16 v[84:87], v[20:23], v[76:79], v[84:87]
    v_mfma_f32_16x16x32_bf16 v[88:91], v[24:27], v[76:79], v[88:91]
    v_mfma_f32_16x16x32_bf16 v[92:95], v[28:31], v[76:79], v[92:95]
    v_mfma_f32_16x16x32_bf16 v[96:99], v[32:35], v[76:79], v[96:99]
    v_mfma_f32_16x16x32_bf16 v[100:103], v[36:39], v[76:79], v[100:103]
    v_mfma_f32_16x16x32_bf16 v[104:107], v[40:43], v[76:79], v[104:107]
    v_mfma_f32_16x16x32_bf16 v[108:111], v[44:47], v[76:79], v[108:111]
    s_waitcnt lgkmcnt(0)
    s_barrier
    ds_read_b128 v[20:23], v8 offset:22528
    ds_read_b128 v[76:79], v14 offset:22528
    ds_read_b128 v[24:27], v8 offset:24576
    ds_read_b128 v[28:31], v8 offset:26624
    ds_read_b128 v[32:35], v8 offset:28672
    ds_read_b128 v[36:39], v8 offset:30720
    ds_read_b128 v[40:43], v8 offset:32768
    ds_read_b128 v[44:47], v8 offset:34816
    v_mfma_f32_16x16x32_bf16 v[84:87], v[48:51], v[80:83], v[84:87]
    v_mfma_f32_16x16x32_bf16 v[88:91], v[52:55], v[80:83], v[88:91]
    v_mfma_f32_16x16x32_bf16 v[92:95], v[56:59], v[80:83], v[92:95]
    v_mfma_f32_16x16x32_bf16 v[96:99], v[60:63], v[80:83], v[96:99]
    v_mfma_f32_16x16x32_bf16 v[100:103], v[64:67], v[80:83], v[100:103]
    v_mfma_f32_16x16x32_bf16 v[104:107], v[68:71], v[80:83], v[104:107]
    v_mfma_f32_16x16x32_bf16 v[108:111], v[72:75], v[80:83], v[108:111]
    ds_read_b128 v[48:51], v11 offset:22528
    ds_read_b128 v[80:83], v17 offset:22528
    ds_read_b128 v[52:55], v11 offset:24576
    ds_read_b128 v[56:59], v11 offset:26624
    ds_read_b128 v[60:63], v11 offset:28672
    ds_read_b128 v[64:67], v11 offset:30720
    ds_read_b128 v[68:71], v11 offset:32768
    ds_read_b128 v[72:75], v11 offset:34816
    s_waitcnt lgkmcnt(8)
    v_mfma_f32_16x16x32_bf16 v[84:87], v[20:23], v[76:79], v[84:87]
    v_mfma_f32_16x16x32_bf16 v[88:91], v[24:27], v[76:79], v[88:91]
    v_mfma_f32_16x16x32_bf16 v[92:95], v[28:31], v[76:79], v[92:95]
    v_mfma_f32_16x16x32_bf16 v[96:99], v[32:35], v[76:79], v[96:99]
    v_mfma_f32_16x16x32_bf16 v[100:103], v[36:39], v[76:79], v[100:103]
    v_mfma_f32_16x16x32_bf16 v[104:107], v[40:43], v[76:79], v[104:107]
    v_mfma_f32_16x16x32_bf16 v[108:111], v[44:47], v[76:79], v[108:111]
    s_waitcnt lgkmcnt(0)
    s_barrier
    ds_read_b128 v[20:23], v9 offset:0
    ds_read_b128 v[76:79], v15 offset:0
    ds_read_b128 v[24:27], v9 offset:2048
    ds_read_b128 v[28:31], v9 offset:4096
    ds_read_b128 v[32:35], v9 offset:6144
    ds_read_b128 v[36:39], v9 offset:8192
    ds_read_b128 v[40:43], v9 offset:10240
    ds_read_b128 v[44:47], v9 offset:12288
    v_mfma_f32_16x16x32_bf16 v[84:87], v[48:51], v[80:83], v[84:87]
    v_mfma_f32_16x16x32_bf16 v[88:91], v[52:55], v[80:83], v[88:91]
    v_mfma_f32_16x16x32_bf16 v[92:95], v[56:59], v[80:83], v[92:95]
    v_mfma_f32_16x16x32_bf16 v[96:99], v[60:63], v[80:83], v[96:99]
    v_mfma_f32_16x16x32_bf16 v[100:103], v[64:67], v[80:83], v[100:103]
    v_mfma_f32_16x16x32_bf16 v[104:107], v[68:71], v[80:83], v[104:107]
    v_mfma_f32_16x16x32_bf16 v[108:111], v[72:75], v[80:83], v[108:111]
    ds_read_b128 v[48:51], v12 offset:0
    ds_read_b128 v[80:83], v18 offset:0
    ds_read_b128 v[52:55], v12 offset:2048
    ds_read_b128 v[56:59], v12 offset:4096
    ds_read_b128 v[60:63], v12 offset:6144
    ds_read_b128 v[64:67], v12 offset:8192
    ds_read_b128 v[68:71], v12 offset:10240
    ds_read_b128 v[72:75], v12 offset:12288
    s_waitcnt lgkmcnt(8)
    v_mfma_f32_16x16x32_bf16 v[84:87], v[20:23], v[76:79], v[84:87]
    v_mfma_f32_16x16x32_bf16 v[88:91], v[24:27], v[76:79], v[88:91]
    v_mfma_f32_16x16x32_bf16 v[92:95], v[28:31], v[76:79], v[92:95]
    v_mfma_f32_16x16x32_bf16 v[96:99], v[32:35], v[76:79], v[96:99]
    v_mfma_f32_16x16x32_bf16 v[100:103], v[36:39], v[76:79], v[100:103]
    v_mfma_f32_16x16x32_bf16 v[104:107], v[40:43], v[76:79], v[104:107]
    v_mfma_f32_16x16x32_bf16 v[108:111], v[44:47], v[76:79], v[108:111]
    s_waitcnt lgkmcnt(0)
    s_barrier
    ds_read_b128 v[20:23], v9 offset:22528
    ds_read_b128 v[76:79], v15 offset:22528
    ds_read_b128 v[24:27], v9 offset:24576
    ds_read_b128 v[28:31], v9 offset:26624
    ds_read_b128 v[32:35], v9 offset:28672
    ds_read_b128 v[36:39], v9 offset:30720
    ds_read_b128 v[40:43], v9 offset:32768
    ds_read_b128 v[44:47], v9 offset:34816
    v_mfma_f32_16x16x32_bf16 v[84:87], v[48:51], v[80:83], v[84:87]
    v_mfma_f32_16x16x32_bf16 v[88:91], v[52:55], v[80:83], v[88:91]
    v_mfma_f32_16x16x32_bf16 v[92:95], v[56:59], v[80:83], v[92:95]
    v_mfma_f32_16x16x32_bf16 v[96:99], v[60:63], v[80:83], v[96:99]
    v_mfma_f32_16x16x32_bf16 v[100:103], v[64:67], v[80:83], v[100:103]
    v_mfma_f32_16x16x32_bf16 v[104:107], v[68:71], v[80:83], v[104:107]
    v_mfma_f32_16x16x32_bf16 v[108:111], v[72:75], v[80:83], v[108:111]
    ds_read_b128 v[48:51], v12 offset:22528
    ds_read_b128 v[80:83], v18 offset:22528
    ds_read_b128 v[52:55], v12 offset:24576
    ds_read_b128 v[56:59], v12 offset:26624
    ds_read_b128 v[60:63], v12 offset:28672
    ds_read_b128 v[64:67], v12 offset:30720
    ds_read_b128 v[68:71], v12 offset:32768
    ds_read_b128 v[72:75], v12 offset:34816
    s_waitcnt lgkmcnt(8)
    v_mfma_f32_16x16x32_bf16 v[84:87], v[20:23], v[76:79], v[84:87]
    v_mfma_f32_16x16x32_bf16 v[88:91], v[24:27], v[76:79], v[88:91]
    v_mfma_f32_16x16x32_bf16 v[92:95], v[28:31], v[76:79], v[92:95]
    v_mfma_f32_16x16x32_bf16 v[96:99], v[32:35], v[76:79], v[96:99]
    v_mfma_f32_16x16x32_bf16 v[100:103], v[36:39], v[76:79], v[100:103]
    v_mfma_f32_16x16x32_bf16 v[104:107], v[40:43], v[76:79], v[104:107]
    v_mfma_f32_16x16x32_bf16 v[108:111], v[44:47], v[76:79], v[108:111]
    s_waitcnt lgkmcnt(0)
    s_barrier
    ds_read_b128 v[20:23], v10 offset:0
    ds_read_b128 v[76:79], v16 offset:0
    ds_read_b128 v[24:27], v10 offset:2048
    ds_read_b128 v[28:31], v10 offset:4096
    ds_read_b128 v[32:35], v10 offset:6144
    ds_read_b128 v[36:39], v10 offset:8192
    ds_read_b128 v[40:43], v10 offset:10240
    ds_read_b128 v[44:47], v10 offset:12288
    v_mfma_f32_16x16x32_bf16 v[84:87], v[48:51], v[80:83], v[84:87]
    v_mfma_f32_16x16x32_bf16 v[88:91], v[52:55], v[80:83], v[88:91]
    v_mfma_f32_16x16x32_bf16 v[92:95], v[56:59], v[80:83], v[92:95]
    v_mfma_f32_16x16x32_bf16 v[96:99], v[60:63], v[80:83], v[96:99]
    v_mfma_f32_16x16x32_bf16 v[100:103], v[64:67], v[80:83], v[100:103]
    v_mfma_f32_16x16x32_bf16 v[104:107], v[68:71], v[80:83], v[104:107]
    v_mfma_f32_16x16x32_bf16 v[108:111], v[72:75], v[80:83], v[108:111]
    ds_read_b128 v[48:51], v13 offset:0
    ds_read_b128 v[80:83], v19 offset:0
    ds_read_b128 v[52:55], v13 offset:2048
    ds_read_b128 v[56:59], v13 offset:4096
    ds_read_b128 v[60:63], v13 offset:6144
    ds_read_b128 v[64:67], v13 offset:8192
    ds_read_b128 v[68:71], v13 offset:10240
    ds_read_b128 v[72:75], v13 offset:12288
    s_waitcnt lgkmcnt(8)
    v_mfma_f32_16x16x32_bf16 v[84:87], v[20:23], v[76:79], v[84:87]
    v_mfma_f32_16x16x32_bf16 v[88:91], v[24:27], v[76:79], v[88:91]
    v_mfma_f32_16x16x32_bf16 v[92:95], v[28:31], v[76:79], v[92:95]
    v_mfma_f32_16x16x32_bf16 v[96:99], v[32:35], v[76:79], v[96:99]
    v_mfma_f32_16x16x32_bf16 v[100:103], v[36:39], v[76:79], v[100:103]
    v_mfma_f32_16x16x32_bf16 v[104:107], v[40:43], v[76:79], v[104:107]
    v_mfma_f32_16x16x32_bf16 v[108:111], v[44:47], v[76:79], v[108:111]
    s_waitcnt lgkmcnt(0)
    s_barrier
    ds_read_b128 v[20:23], v10 offset:22528
    ds_read_b128 v[76:79], v16 offset:22528
    ds_read_b128 v[24:27], v10 offset:24576
    ds_read_b128 v[28:31], v10 offset:26624
    ds_read_b128 v[32:35], v10 offset:28672
    ds_read_b128 v[36:39], v10 offset:30720
    ds_read_b128 v[40:43], v10 offset:32768
    ds_read_b128 v[44:47], v10 offset:34816
    v_mfma_f32_16x16x32_bf16 v[84:87], v[48:51], v[80:83], v[84:87]
    v_mfma_f32_16x16x32_bf16 v[88:91], v[52:55], v[80:83], v[88:91]
    v_mfma_f32_16x16x32_bf16 v[92:95], v[56:59], v[80:83], v[92:95]
    v_mfma_f32_16x16x32_bf16 v[96:99], v[60:63], v[80:83], v[96:99]
    v_mfma_f32_16x16x32_bf16 v[100:103], v[64:67], v[80:83], v[100:103]
    v_mfma_f32_16x16x32_bf16 v[104:107], v[68:71], v[80:83], v[104:107]
    v_mfma_f32_16x16x32_bf16 v[108:111], v[72:75], v[80:83], v[108:111]
    ds_read_b128 v[48:51], v13 offset:22528
    ds_read_b128 v[80:83], v19 offset:22528
    ds_read_b128 v[52:55], v13 offset:24576
    ds_read_b128 v[56:59], v13 offset:26624
    ds_read_b128 v[60:63], v13 offset:28672
    ds_read_b128 v[64:67], v13 offset:30720
    ds_read_b128 v[68:71], v13 offset:32768
    ds_read_b128 v[72:75], v13 offset:34816
    s_waitcnt lgkmcnt(8)
    v_mfma_f32_16x16x32_bf16 v[84:87], v[20:23], v[76:79], v[84:87]
    v_mfma_f32_16x16x32_bf16 v[88:91], v[24:27], v[76:79], v[88:91]
    v_mfma_f32_16x16x32_bf16 v[92:95], v[28:31], v[76:79], v[92:95]
    v_mfma_f32_16x16x32_bf16 v[96:99], v[32:35], v[76:79], v[96:99]
    v_mfma_f32_16x16x32_bf16 v[100:103], v[36:39], v[76:79], v[100:103]
    v_mfma_f32_16x16x32_bf16 v[104:107], v[40:43], v[76:79], v[104:107]
    v_mfma_f32_16x16x32_bf16 v[108:111], v[44:47], v[76:79], v[108:111]
    s_waitcnt lgkmcnt(0)
    s_barrier
    ds_read_b128 v[20:23], v8 offset:0
    ds_read_b128 v[76:79], v14 offset:0
    ds_read_b128 v[24:27], v8 offset:2048
    ds_read_b128 v[28:31], v8 offset:4096
    ds_read_b128 v[32:35], v8 offset:6144
    ds_read_b128 v[36:39], v8 offset:8192
    ds_read_b128 v[40:43], v8 offset:10240
    ds_read_b128 v[44:47], v8 offset:12288
    v_mfma_f32_16x16x32_bf16 v[84:87], v[48:51], v[80:83], v[84:87]
    v_mfma_f32_16x16x32_bf16 v[88:91], v[52:55], v[80:83], v[88:91]
    v_mfma_f32_16x16x32_bf16 v[92:95], v[56:59], v[80:83], v[92:95]
    v_mfma_f32_16x16x32_bf16 v[96:99], v[60:63], v[80:83], v[96:99]
    v_mfma_f32_16x16x32_bf16 v[100:103], v[64:67], v[80:83], v[100:103]
    v_mfma_f32_16x16x32_bf16 v[104:107], v[68:71], v[80:83], v[104:107]
    v_mfma_f32_16x16x32_bf16 v[108:111], v[72:75], v[80:83], v[108:111]
    ds_read_b128 v[48:51], v11 offset:0
    ds_read_b128 v[80:83], v17 offset:0
    ds_read_b128 v[52:55], v11 offset:2048
    ds_read_b128 v[56:59], v11 offset:4096
    ds_read_b128 v[60:63], v11 offset:6144
    ds_read_b128 v[64:67], v11 offset:8192
    ds_read_b128 v[68:71], v11 offset:10240
    ds_read_b128 v[72:75], v11 offset:12288
    s_waitcnt lgkmcnt(8)
    v_mfma_f32_16x16x32_bf16 v[84:87], v[20:23], v[76:79], v[84:87]
    v_mfma_f32_16x16x32_bf16 v[88:91], v[24:27], v[76:79], v[88:91]
    v_mfma_f32_16x16x32_bf16 v[92:95], v[28:31], v[76:79], v[92:95]
    v_mfma_f32_16x16x32_bf16 v[96:99], v[32:35], v[76:79], v[96:99]
    v_mfma_f32_16x16x32_bf16 v[100:103], v[36:39], v[76:79], v[100:103]
    v_mfma_f32_16x16x32_bf16 v[104:107], v[40:43], v[76:79], v[104:107]
    v_mfma_f32_16x16x32_bf16 v[108:111], v[44:47], v[76:79], v[108:111]
    s_waitcnt lgkmcnt(0)
    s_barrier
    ds_read_b128 v[20:23], v8 offset:22528
    ds_read_b128 v[76:79], v14 offset:22528
    ds_read_b128 v[24:27], v8 offset:24576
    ds_read_b128 v[28:31], v8 offset:26624
    ds_read_b128 v[32:35], v8 offset:28672
    ds_read_b128 v[36:39], v8 offset:30720
    ds_read_b128 v[40:43], v8 offset:32768
    ds_read_b128 v[44:47], v8 offset:34816
    v_mfma_f32_16x16x32_bf16 v[84:87], v[48:51], v[80:83], v[84:87]
    v_mfma_f32_16x16x32_bf16 v[88:91], v[52:55], v[80:83], v[88:91]
    v_mfma_f32_16x16x32_bf16 v[92:95], v[56:59], v[80:83], v[92:95]
    v_mfma_f32_16x16x32_bf16 v[96:99], v[60:63], v[80:83], v[96:99]
    v_mfma_f32_16x16x32_bf16 v[100:103], v[64:67], v[80:83], v[100:103]
    v_mfma_f32_16x16x32_bf16 v[104:107], v[68:71], v[80:83], v[104:107]
    v_mfma_f32_16x16x32_bf16 v[108:111], v[72:75], v[80:83], v[108:111]
    ds_read_b128 v[48:51], v11 offset:22528
    ds_read_b128 v[80:83], v17 offset:22528
    ds_read_b128 v[52:55], v11 offset:24576
    ds_read_b128 v[56:59], v11 offset:26624
    ds_read_b128 v[60:63], v11 offset:28672
    ds_read_b128 v[64:67], v11 offset:30720
    ds_read_b128 v[68:71], v11 offset:32768
    ds_read_b128 v[72:75], v11 offset:34816
    s_waitcnt lgkmcnt(8)
    v_mfma_f32_16x16x32_bf16 v[84:87], v[20:23], v[76:79], v[84:87]
    v_mfma_f32_16x16x32_bf16 v[88:91], v[24:27], v[76:79], v[88:91]
    v_mfma_f32_16x16x32_bf16 v[92:95], v[28:31], v[76:79], v[92:95]
    v_mfma_f32_16x16x32_bf16 v[96:99], v[32:35], v[76:79], v[96:99]
    v_mfma_f32_16x16x32_bf16 v[100:103], v[36:39], v[76:79], v[100:103]
    v_mfma_f32_16x16x32_bf16 v[104:107], v[40:43], v[76:79], v[104:107]
    v_mfma_f32_16x16x32_bf16 v[108:111], v[44:47], v[76:79], v[108:111]
    s_waitcnt lgkmcnt(0)
    s_barrier
    ds_read_b128 v[20:23], v9 offset:0
    ds_read_b128 v[76:79], v15 offset:0
    ds_read_b128 v[24:27], v9 offset:2048
    ds_read_b128 v[28:31], v9 offset:4096
    ds_read_b128 v[32:35], v9 offset:6144
    ds_read_b128 v[36:39], v9 offset:8192
    ds_read_b128 v[40:43], v9 offset:10240
    ds_read_b128 v[44:47], v9 offset:12288
    v_mfma_f32_16x16x32_bf16 v[84:87], v[48:51], v[80:83], v[84:87]
    v_mfma_f32_16x16x32_bf16 v[88:91], v[52:55], v[80:83], v[88:91]
    v_mfma_f32_16x16x32_bf16 v[92:95], v[56:59], v[80:83], v[92:95]
    v_mfma_f32_16x16x32_bf16 v[96:99], v[60:63], v[80:83], v[96:99]
    v_mfma_f32_16x16x32_bf16 v[100:103], v[64:67], v[80:83], v[100:103]
    v_mfma_f32_16x16x32_bf16 v[104:107], v[68:71], v[80:83], v[104:107]
    v_mfma_f32_16x16x32_bf16 v[108:111], v[72:75], v[80:83], v[108:111]
    ds_read_b128 v[48:51], v12 offset:0
    ds_read_b128 v[80:83], v18 offset:0
    ds_read_b128 v[52:55], v12 offset:2048
    ds_read_b128 v[56:59], v12 offset:4096
    ds_read_b128 v[60:63], v12 offset:6144
    ds_read_b128 v[64:67], v12 offset:8192
    ds_read_b128 v[68:71], v12 offset:10240
    ds_read_b128 v[72:75], v12 offset:12288
    s_waitcnt lgkmcnt(8)
    v_mfma_f32_16x16x32_bf16 v[84:87], v[20:23], v[76:79], v[84:87]
    v_mfma_f32_16x16x32_bf16 v[88:91], v[24:27], v[76:79], v[88:91]
    v_mfma_f32_16x16x32_bf16 v[92:95], v[28:31], v[76:79], v[92:95]
    v_mfma_f32_16x16x32_bf16 v[96:99], v[32:35], v[76:79], v[96:99]
    v_mfma_f32_16x16x32_bf16 v[100:103], v[36:39], v[76:79], v[100:103]
    v_mfma_f32_16x16x32_bf16 v[104:107], v[40:43], v[76:79], v[104:107]
    v_mfma_f32_16x16x32_bf16 v[108:111], v[44:47], v[76:79], v[108:111]
    s_waitcnt lgkmcnt(0)
    s_barrier
    ds_read_b128 v[20:23], v9 offset:22528
    ds_read_b128 v[76:79], v15 offset:22528
    ds_read_b128 v[24:27], v9 offset:24576
    ds_read_b128 v[28:31], v9 offset:26624
    ds_read_b128 v[32:35], v9 offset:28672
    ds_read_b128 v[36:39], v9 offset:30720
    ds_read_b128 v[40:43], v9 offset:32768
    ds_read_b128 v[44:47], v9 offset:34816
    v_mfma_f32_16x16x32_bf16 v[84:87], v[48:51], v[80:83], v[84:87]
    v_mfma_f32_16x16x32_bf16 v[88:91], v[52:55], v[80:83], v[88:91]
    v_mfma_f32_16x16x32_bf16 v[92:95], v[56:59], v[80:83], v[92:95]
    v_mfma_f32_16x16x32_bf16 v[96:99], v[60:63], v[80:83], v[96:99]
    v_mfma_f32_16x16x32_bf16 v[100:103], v[64:67], v[80:83], v[100:103]
    v_mfma_f32_16x16x32_bf16 v[104:107], v[68:71], v[80:83], v[104:107]
    v_mfma_f32_16x16x32_bf16 v[108:111], v[72:75], v[80:83], v[108:111]
    ds_read_b128 v[48:51], v12 offset:22528
    ds_read_b128 v[80:83], v18 offset:22528
    ds_read_b128 v[52:55], v12 offset:24576
    ds_read_b128 v[56:59], v12 offset:26624
    ds_read_b128 v[60:63], v12 offset:28672
    ds_read_b128 v[64:67], v12 offset:30720
    ds_read_b128 v[68:71], v12 offset:32768
    ds_read_b128 v[72:75], v12 offset:34816
    s_waitcnt lgkmcnt(8)
    v_mfma_f32_16x16x32_bf16 v[84:87], v[20:23], v[76:79], v[84:87]
    v_mfma_f32_16x16x32_bf16 v[88:91], v[24:27], v[76:79], v[88:91]
    v_mfma_f32_16x16x32_bf16 v[92:95], v[28:31], v[76:79], v[92:95]
    v_mfma_f32_16x16x32_bf16 v[96:99], v[32:35], v[76:79], v[96:99]
    v_mfma_f32_16x16x32_bf16 v[100:103], v[36:39], v[76:79], v[100:103]
    v_mfma_f32_16x16x32_bf16 v[104:107], v[40:43], v[76:79], v[104:107]
    v_mfma_f32_16x16x32_bf16 v[108:111], v[44:47], v[76:79], v[108:111]
    s_waitcnt lgkmcnt(0)
    s_barrier
    ds_read_b128 v[20:23], v10 offset:0
    ds_read_b128 v[76:79], v16 offset:0
    ds_read_b128 v[24:27], v10 offset:2048
    ds_read_b128 v[28:31], v10 offset:4096
    ds_read_b128 v[32:35], v10 offset:6144
    ds_read_b128 v[36:39], v10 offset:8192
    ds_read_b128 v[40:43], v10 offset:10240
    ds_read_b128 v[44:47], v10 offset:12288
    v_mfma_f32_16x16x32_bf16 v[84:87], v[48:51], v[80:83], v[84:87]
    v_mfma_f32_16x16x32_bf16 v[88:91], v[52:55], v[80:83], v[88:91]
    v_mfma_f32_16x16x32_bf16 v[92:95], v[56:59], v[80:83], v[92:95]
    v_mfma_f32_16x16x32_bf16 v[96:99], v[60:63], v[80:83], v[96:99]
    v_mfma_f32_16x16x32_bf16 v[100:103], v[64:67], v[80:83], v[100:103]
    v_mfma_f32_16x16x32_bf16 v[104:107], v[68:71], v[80:83], v[104:107]
    v_mfma_f32_16x16x32_bf16 v[108:111], v[72:75], v[80:83], v[108:111]
    ds_read_b128 v[48:51], v13 offset:0
    ds_read_b128 v[80:83], v19 offset:0
    ds_read_b128 v[52:55], v13 offset:2048
    ds_read_b128 v[56:59], v13 offset:4096
    ds_read_b128 v[60:63], v13 offset:6144
    ds_read_b128 v[64:67], v13 offset:8192
    ds_read_b128 v[68:71], v13 offset:10240
    ds_read_b128 v[72:75], v13 offset:12288
    s_waitcnt lgkmcnt(8)
    v_mfma_f32_16x16x32_bf16 v[84:87], v[20:23], v[76:79], v[84:87]
    v_mfma_f32_16x16x32_bf16 v[88:91], v[24:27], v[76:79], v[88:91]
    v_mfma_f32_16x16x32_bf16 v[92:95], v[28:31], v[76:79], v[92:95]
    v_mfma_f32_16x16x32_bf16 v[96:99], v[32:35], v[76:79], v[96:99]
    v_mfma_f32_16x16x32_bf16 v[100:103], v[36:39], v[76:79], v[100:103]
    v_mfma_f32_16x16x32_bf16 v[104:107], v[40:43], v[76:79], v[104:107]
    v_mfma_f32_16x16x32_bf16 v[108:111], v[44:47], v[76:79], v[108:111]
    s_waitcnt lgkmcnt(0)
    s_barrier
    ds_read_b128 v[20:23], v10 offset:22528
    ds_read_b128 v[76:79], v16 offset:22528
    ds_read_b128 v[24:27], v10 offset:24576
    ds_read_b128 v[28:31], v10 offset:26624
    ds_read_b128 v[32:35], v10 offset:28672
    ds_read_b128 v[36:39], v10 offset:30720
    ds_read_b128 v[40:43], v10 offset:32768
    ds_read_b128 v[44:47], v10 offset:34816
    v_mfma_f32_16x16x32_bf16 v[84:87], v[48:51], v[80:83], v[84:87]
    v_mfma_f32_16x16x32_bf16 v[88:91], v[52:55], v[80:83], v[88:91]
    v_mfma_f32_16x16x32_bf16 v[92:95], v[56:59], v[80:83], v[92:95]
    v_mfma_f32_16x16x32_bf16 v[96:99], v[60:63], v[80:83], v[96:99]
    v_mfma_f32_16x16x32_bf16 v[100:103], v[64:67], v[80:83], v[100:103]
    v_mfma_f32_16x16x32_bf16 v[104:107], v[68:71], v[80:83], v[104:107]
    v_mfma_f32_16x16x32_bf16 v[108:111], v[72:75], v[80:83], v[108:111]
    ds_read_b128 v[48:51], v13 offset:22528
    ds_read_b128 v[80:83], v19 offset:22528
    ds_read_b128 v[52:55], v13 offset:24576
    ds_read_b128 v[56:59], v13 offset:26624
    ds_read_b128 v[60:63], v13 offset:28672
    ds_read_b128 v[64:67], v13 offset:30720
    ds_read_b128 v[68:71], v13 offset:32768
    ds_read_b128 v[72:75], v13 offset:34816
    s_waitcnt lgkmcnt(8)
    v_mfma_f32_16x16x32_bf16 v[84:87], v[20:23], v[76:79], v[84:87]
    v_mfma_f32_16x16x32_bf16 v[88:91], v[24:27], v[76:79], v[88:91]
    v_mfma_f32_16x16x32_bf16 v[92:95], v[28:31], v[76:79], v[92:95]
    v_mfma_f32_16x16x32_bf16 v[96:99], v[32:35], v[76:79], v[96:99]
    v_mfma_f32_16x16x32_bf16 v[100:103], v[36:39], v[76:79], v[100:103]
    v_mfma_f32_16x16x32_bf16 v[104:107], v[40:43], v[76:79], v[104:107]
    v_mfma_f32_16x16x32_bf16 v[108:111], v[44:47], v[76:79], v[108:111]
    s_waitcnt lgkmcnt(0)
    s_barrier
    ds_read_b128 v[20:23], v8 offset:0
    ds_read_b128 v[76:79], v14 offset:0
    ds_read_b128 v[24:27], v8 offset:2048
    ds_read_b128 v[28:31], v8 offset:4096
    ds_read_b128 v[32:35], v8 offset:6144
    ds_read_b128 v[36:39], v8 offset:8192
    ds_read_b128 v[40:43], v8 offset:10240
    ds_read_b128 v[44:47], v8 offset:12288
    v_mfma_f32_16x16x32_bf16 v[84:87], v[48:51], v[80:83], v[84:87]
    v_mfma_f32_16x16x32_bf16 v[88:91], v[52:55], v[80:83], v[88:91]
    v_mfma_f32_16x16x32_bf16 v[92:95], v[56:59], v[80:83], v[92:95]
    v_mfma_f32_16x16x32_bf16 v[96:99], v[60:63], v[80:83], v[96:99]
    v_mfma_f32_16x16x32_bf16 v[100:103], v[64:67], v[80:83], v[100:103]
    v_mfma_f32_16x16x32_bf16 v[104:107], v[68:71], v[80:83], v[104:107]
    v_mfma_f32_16x16x32_bf16 v[108:111], v[72:75], v[80:83], v[108:111]
    ds_read_b128 v[48:51], v11 offset:0
    ds_read_b128 v[80:83], v17 offset:0
    ds_read_b128 v[52:55], v11 offset:2048
    ds_read_b128 v[56:59], v11 offset:4096
    ds_read_b128 v[60:63], v11 offset:6144
    ds_read_b128 v[64:67], v11 offset:8192
    ds_read_b128 v[68:71], v11 offset:10240
    ds_read_b128 v[72:75], v11 offset:12288
    s_waitcnt lgkmcnt(8)
    v_mfma_f32_16x16x32_bf16 v[84:87], v[20:23], v[76:79], v[84:87]
    v_mfma_f32_16x16x32_bf16 v[88:91], v[24:27], v[76:79], v[88:91]
    v_mfma_f32_16x16x32_bf16 v[92:95], v[28:31], v[76:79], v[92:95]
    v_mfma_f32_16x16x32_bf16 v[96:99], v[32:35], v[76:79], v[96:99]
    v_mfma_f32_16x16x32_bf16 v[100:103], v[36:39], v[76:79], v[100:103]
    v_mfma_f32_16x16x32_bf16 v[104:107], v[40:43], v[76:79], v[104:107]
    v_mfma_f32_16x16x32_bf16 v[108:111], v[44:47], v[76:79], v[108:111]
    s_waitcnt lgkmcnt(0)
    s_barrier
    ds_read_b128 v[20:23], v8 offset:22528
    ds_read_b128 v[76:79], v14 offset:22528
    ds_read_b128 v[24:27], v8 offset:24576
    ds_read_b128 v[28:31], v8 offset:26624
    ds_read_b128 v[32:35], v8 offset:28672
    ds_read_b128 v[36:39], v8 offset:30720
    ds_read_b128 v[40:43], v8 offset:32768
    ds_read_b128 v[44:47], v8 offset:34816
    v_mfma_f32_16x16x32_bf16 v[84:87], v[48:51], v[80:83], v[84:87]
    v_mfma_f32_16x16x32_bf16 v[88:91], v[52:55], v[80:83], v[88:91]
    v_mfma_f32_16x16x32_bf16 v[92:95], v[56:59], v[80:83], v[92:95]
    v_mfma_f32_16x16x32_bf16 v[96:99], v[60:63], v[80:83], v[96:99]
    v_mfma_f32_16x16x32_bf16 v[100:103], v[64:67], v[80:83], v[100:103]
    v_mfma_f32_16x16x32_bf16 v[104:107], v[68:71], v[80:83], v[104:107]
    v_mfma_f32_16x16x32_bf16 v[108:111], v[72:75], v[80:83], v[108:111]
    ds_read_b128 v[48:51], v11 offset:22528
    ds_read_b128 v[80:83], v17 offset:22528
    ds_read_b128 v[52:55], v11 offset:24576
    ds_read_b128 v[56:59], v11 offset:26624
    ds_read_b128 v[60:63], v11 offset:28672
    ds_read_b128 v[64:67], v11 offset:30720
    ds_read_b128 v[68:71], v11 offset:32768
    ds_read_b128 v[72:75], v11 offset:34816
    s_waitcnt lgkmcnt(8)
    v_mfma_f32_16x16x32_bf16 v[84:87], v[20:23], v[76:79], v[84:87]
    v_mfma_f32_16x16x32_bf16 v[88:91], v[24:27], v[76:79], v[88:91]
    v_mfma_f32_16x16x32_bf16 v[92:95], v[28:31], v[76:79], v[92:95]
    v_mfma_f32_16x16x32_bf16 v[96:99], v[32:35], v[76:79], v[96:99]
    v_mfma_f32_16x16x32_bf16 v[100:103], v[36:39], v[76:79], v[100:103]
    v_mfma_f32_16x16x32_bf16 v[104:107], v[40:43], v[76:79], v[104:107]
    v_mfma_f32_16x16x32_bf16 v[108:111], v[44:47], v[76:79], v[108:111]
    s_waitcnt lgkmcnt(0)
    s_barrier
    ds_read_b128 v[20:23], v9 offset:0
    ds_read_b128 v[76:79], v15 offset:0
    ds_read_b128 v[24:27], v9 offset:2048
    ds_read_b128 v[28:31], v9 offset:4096
    ds_read_b128 v[32:35], v9 offset:6144
    ds_read_b128 v[36:39], v9 offset:8192
    ds_read_b128 v[40:43], v9 offset:10240
    ds_read_b128 v[44:47], v9 offset:12288
    v_mfma_f32_16x16x32_bf16 v[84:87], v[48:51], v[80:83], v[84:87]
    v_mfma_f32_16x16x32_bf16 v[88:91], v[52:55], v[80:83], v[88:91]
    v_mfma_f32_16x16x32_bf16 v[92:95], v[56:59], v[80:83], v[92:95]
    v_mfma_f32_16x16x32_bf16 v[96:99], v[60:63], v[80:83], v[96:99]
    v_mfma_f32_16x16x32_bf16 v[100:103], v[64:67], v[80:83], v[100:103]
    v_mfma_f32_16x16x32_bf16 v[104:107], v[68:71], v[80:83], v[104:107]
    v_mfma_f32_16x16x32_bf16 v[108:111], v[72:75], v[80:83], v[108:111]
    ds_read_b128 v[48:51], v12 offset:0
    ds_read_b128 v[80:83], v18 offset:0
    ds_read_b128 v[52:55], v12 offset:2048
    ds_read_b128 v[56:59], v12 offset:4096
    ds_read_b128 v[60:63], v12 offset:6144
    ds_read_b128 v[64:67], v12 offset:8192
    ds_read_b128 v[68:71], v12 offset:10240
    ds_read_b128 v[72:75], v12 offset:12288
    s_waitcnt lgkmcnt(8)
    v_mfma_f32_16x16x32_bf16 v[84:87], v[20:23], v[76:79], v[84:87]
    v_mfma_f32_16x16x32_bf16 v[88:91], v[24:27], v[76:79], v[88:91]
    v_mfma_f32_16x16x32_bf16 v[92:95], v[28:31], v[76:79], v[92:95]
    v_mfma_f32_16x16x32_bf16 v[96:99], v[32:35], v[76:79], v[96:99]
    v_mfma_f32_16x16x32_bf16 v[100:103], v[36:39], v[76:79], v[100:103]
    v_mfma_f32_16x16x32_bf16 v[104:107], v[40:43], v[76:79], v[104:107]
    v_mfma_f32_16x16x32_bf16 v[108:111], v[44:47], v[76:79], v[108:111]
    s_waitcnt lgkmcnt(0)
    s_barrier
    ds_read_b128 v[20:23], v9 offset:22528
    ds_read_b128 v[76:79], v15 offset:22528
    ds_read_b128 v[24:27], v9 offset:24576
    ds_read_b128 v[28:31], v9 offset:26624
    ds_read_b128 v[32:35], v9 offset:28672
    ds_read_b128 v[36:39], v9 offset:30720
    ds_read_b128 v[40:43], v9 offset:32768
    ds_read_b128 v[44:47], v9 offset:34816
    v_mfma_f32_16x16x32_bf16 v[84:87], v[48:51], v[80:83], v[84:87]
    v_mfma_f32_16x16x32_bf16 v[88:91], v[52:55], v[80:83], v[88:91]
    v_mfma_f32_16x16x32_bf16 v[92:95], v[56:59], v[80:83], v[92:95]
    v_mfma_f32_16x16x32_bf16 v[96:99], v[60:63], v[80:83], v[96:99]
    v_mfma_f32_16x16x32_bf16 v[100:103], v[64:67], v[80:83], v[100:103]
    v_mfma_f32_16x16x32_bf16 v[104:107], v[68:71], v[80:83], v[104:107]
    v_mfma_f32_16x16x32_bf16 v[108:111], v[72:75], v[80:83], v[108:111]
    ds_read_b128 v[48:51], v12 offset:22528
    ds_read_b128 v[80:83], v18 offset:22528
    ds_read_b128 v[52:55], v12 offset:24576
    ds_read_b128 v[56:59], v12 offset:26624
    ds_read_b128 v[60:63], v12 offset:28672
    ds_read_b128 v[64:67], v12 offset:30720
    ds_read_b128 v[68:71], v12 offset:32768
    ds_read_b128 v[72:75], v12 offset:34816
    s_waitcnt lgkmcnt(8)
    v_mfma_f32_16x16x32_bf16 v[84:87], v[20:23], v[76:79], v[84:87]
    v_mfma_f32_16x16x32_bf16 v[88:91], v[24:27], v[76:79], v[88:91]
    v_mfma_f32_16x16x32_bf16 v[92:95], v[28:31], v[76:79], v[92:95]
    v_mfma_f32_16x16x32_bf16 v[96:99], v[32:35], v[76:79], v[96:99]
    v_mfma_f32_16x16x32_bf16 v[100:103], v[36:39], v[76:79], v[100:103]
    v_mfma_f32_16x16x32_bf16 v[104:107], v[40:43], v[76:79], v[104:107]
    v_mfma_f32_16x16x32_bf16 v[108:111], v[44:47], v[76:79], v[108:111]
    s_waitcnt lgkmcnt(0)
    s_barrier
    ds_read_b128 v[20:23], v10 offset:0
    ds_read_b128 v[76:79], v16 offset:0
    ds_read_b128 v[24:27], v10 offset:2048
    ds_read_b128 v[28:31], v10 offset:4096
    ds_read_b128 v[32:35], v10 offset:6144
    ds_read_b128 v[36:39], v10 offset:8192
    ds_read_b128 v[40:43], v10 offset:10240
    ds_read_b128 v[44:47], v10 offset:12288
    v_mfma_f32_16x16x32_bf16 v[84:87], v[48:51], v[80:83], v[84:87]
    v_mfma_f32_16x16x32_bf16 v[88:91], v[52:55], v[80:83], v[88:91]
    v_mfma_f32_16x16x32_bf16 v[92:95], v[56:59], v[80:83], v[92:95]
    v_mfma_f32_16x16x32_bf16 v[96:99], v[60:63], v[80:83], v[96:99]
    v_mfma_f32_16x16x32_bf16 v[100:103], v[64:67], v[80:83], v[100:103]
    v_mfma_f32_16x16x32_bf16 v[104:107], v[68:71], v[80:83], v[104:107]
    v_mfma_f32_16x16x32_bf16 v[108:111], v[72:75], v[80:83], v[108:111]
    ds_read_b128 v[48:51], v13 offset:0
    ds_read_b128 v[80:83], v19 offset:0
    ds_read_b128 v[52:55], v13 offset:2048
    ds_read_b128 v[56:59], v13 offset:4096
    ds_read_b128 v[60:63], v13 offset:6144
    ds_read_b128 v[64:67], v13 offset:8192
    ds_read_b128 v[68:71], v13 offset:10240
    ds_read_b128 v[72:75], v13 offset:12288
    s_waitcnt lgkmcnt(8)
    v_mfma_f32_16x16x32_bf16 v[84:87], v[20:23], v[76:79], v[84:87]
    v_mfma_f32_16x16x32_bf16 v[88:91], v[24:27], v[76:79], v[88:91]
    v_mfma_f32_16x16x32_bf16 v[92:95], v[28:31], v[76:79], v[92:95]
    v_mfma_f32_16x16x32_bf16 v[96:99], v[32:35], v[76:79], v[96:99]
    v_mfma_f32_16x16x32_bf16 v[100:103], v[36:39], v[76:79], v[100:103]
    v_mfma_f32_16x16x32_bf16 v[104:107], v[40:43], v[76:79], v[104:107]
    v_mfma_f32_16x16x32_bf16 v[108:111], v[44:47], v[76:79], v[108:111]
    s_waitcnt lgkmcnt(0)
    s_barrier
    ds_read_b128 v[20:23], v10 offset:22528
    ds_read_b128 v[76:79], v16 offset:22528
    ds_read_b128 v[24:27], v10 offset:24576
    ds_read_b128 v[28:31], v10 offset:26624
    ds_read_b128 v[32:35], v10 offset:28672
    ds_read_b128 v[36:39], v10 offset:30720
    ds_read_b128 v[40:43], v10 offset:32768
    ds_read_b128 v[44:47], v10 offset:34816
    v_mfma_f32_16x16x32_bf16 v[84:87], v[48:51], v[80:83], v[84:87]
    v_mfma_f32_16x16x32_bf16 v[88:91], v[52:55], v[80:83], v[88:91]
    v_mfma_f32_16x16x32_bf16 v[92:95], v[56:59], v[80:83], v[92:95]
    v_mfma_f32_16x16x32_bf16 v[96:99], v[60:63], v[80:83], v[96:99]
    v_mfma_f32_16x16x32_bf16 v[100:103], v[64:67], v[80:83], v[100:103]
    v_mfma_f32_16x16x32_bf16 v[104:107], v[68:71], v[80:83], v[104:107]
    v_mfma_f32_16x16x32_bf16 v[108:111], v[72:75], v[80:83], v[108:111]
    ds_read_b128 v[48:51], v13 offset:22528
    ds_read_b128 v[80:83], v19 offset:22528
    ds_read_b128 v[52:55], v13 offset:24576
    ds_read_b128 v[56:59], v13 offset:26624
    ds_read_b128 v[60:63], v13 offset:28672
    ds_read_b128 v[64:67], v13 offset:30720
    ds_read_b128 v[68:71], v13 offset:32768
    ds_read_b128 v[72:75], v13 offset:34816
    s_waitcnt lgkmcnt(8)
    v_mfma_f32_16x16x32_bf16 v[84:87], v[20:23], v[76:79], v[84:87]
    v_mfma_f32_16x16x32_bf16 v[88:91], v[24:27], v[76:79], v[88:91]
    v_mfma_f32_16x16x32_bf16 v[92:95], v[28:31], v[76:79], v[92:95]
    v_mfma_f32_16x16x32_bf16 v[96:99], v[32:35], v[76:79], v[96:99]
    v_mfma_f32_16x16x32_bf16 v[100:103], v[36:39], v[76:79], v[100:103]
    v_mfma_f32_16x16x32_bf16 v[104:107], v[40:43], v[76:79], v[104:107]
    v_mfma_f32_16x16x32_bf16 v[108:111], v[44:47], v[76:79], v[108:111]
    s_waitcnt lgkmcnt(0)
    s_barrier
    ds_read_b128 v[20:23], v8 offset:0
    ds_read_b128 v[76:79], v14 offset:0
    ds_read_b128 v[24:27], v8 offset:2048
    ds_read_b128 v[28:31], v8 offset:4096
    ds_read_b128 v[32:35], v8 offset:6144
    ds_read_b128 v[36:39], v8 offset:8192
    ds_read_b128 v[40:43], v8 offset:10240
    ds_read_b128 v[44:47], v8 offset:12288
    v_mfma_f32_16x16x32_bf16 v[84:87], v[48:51], v[80:83], v[84:87]
    v_mfma_f32_16x16x32_bf16 v[88:91], v[52:55], v[80:83], v[88:91]
    v_mfma_f32_16x16x32_bf16 v[92:95], v[56:59], v[80:83], v[92:95]
    v_mfma_f32_16x16x32_bf16 v[96:99], v[60:63], v[80:83], v[96:99]
    v_mfma_f32_16x16x32_bf16 v[100:103], v[64:67], v[80:83], v[100:103]
    v_mfma_f32_16x16x32_bf16 v[104:107], v[68:71], v[80:83], v[104:107]
    v_mfma_f32_16x16x32_bf16 v[108:111], v[72:75], v[80:83], v[108:111]
    ds_read_b128 v[48:51], v11 offset:0
    ds_read_b128 v[80:83], v17 offset:0
    ds_read_b128 v[52:55], v11 offset:2048
    ds_read_b128 v[56:59], v11 offset:4096
    ds_read_b128 v[60:63], v11 offset:6144
    ds_read_b128 v[64:67], v11 offset:8192
    ds_read_b128 v[68:71], v11 offset:10240
    ds_read_b128 v[72:75], v11 offset:12288
    s_waitcnt lgkmcnt(8)
    v_mfma_f32_16x16x32_bf16 v[84:87], v[20:23], v[76:79], v[84:87]
    v_mfma_f32_16x16x32_bf16 v[88:91], v[24:27], v[76:79], v[88:91]
    v_mfma_f32_16x16x32_bf16 v[92:95], v[28:31], v[76:79], v[92:95]
    v_mfma_f32_16x16x32_bf16 v[96:99], v[32:35], v[76:79], v[96:99]
    v_mfma_f32_16x16x32_bf16 v[100:103], v[36:39], v[76:79], v[100:103]
    v_mfma_f32_16x16x32_bf16 v[104:107], v[40:43], v[76:79], v[104:107]
    v_mfma_f32_16x16x32_bf16 v[108:111], v[44:47], v[76:79], v[108:111]
    s_waitcnt lgkmcnt(0)
    s_barrier
    ds_read_b128 v[20:23], v8 offset:22528
    ds_read_b128 v[76:79], v14 offset:22528
    ds_read_b128 v[24:27], v8 offset:24576
    ds_read_b128 v[28:31], v8 offset:26624
    ds_read_b128 v[32:35], v8 offset:28672
    ds_read_b128 v[36:39], v8 offset:30720
    ds_read_b128 v[40:43], v8 offset:32768
    ds_read_b128 v[44:47], v8 offset:34816
    v_mfma_f32_16x16x32_bf16 v[84:87], v[48:51], v[80:83], v[84:87]
    v_mfma_f32_16x16x32_bf16 v[88:91], v[52:55], v[80:83], v[88:91]
    v_mfma_f32_16x16x32_bf16 v[92:95], v[56:59], v[80:83], v[92:95]
    v_mfma_f32_16x16x32_bf16 v[96:99], v[60:63], v[80:83], v[96:99]
    v_mfma_f32_16x16x32_bf16 v[100:103], v[64:67], v[80:83], v[100:103]
    v_mfma_f32_16x16x32_bf16 v[104:107], v[68:71], v[80:83], v[104:107]
    v_mfma_f32_16x16x32_bf16 v[108:111], v[72:75], v[80:83], v[108:111]
    ds_read_b128 v[48:51], v11 offset:22528
    ds_read_b128 v[80:83], v17 offset:22528
    ds_read_b128 v[52:55], v11 offset:24576
    ds_read_b128 v[56:59], v11 offset:26624
    ds_read_b128 v[60:63], v11 offset:28672
    ds_read_b128 v[64:67], v11 offset:30720
    ds_read_b128 v[68:71], v11 offset:32768
    ds_read_b128 v[72:75], v11 offset:34816
    s_waitcnt lgkmcnt(8)
    v_mfma_f32_16x16x32_bf16 v[84:87], v[20:23], v[76:79], v[84:87]
    v_mfma_f32_16x16x32_bf16 v[88:91], v[24:27], v[76:79], v[88:91]
    v_mfma_f32_16x16x32_bf16 v[92:95], v[28:31], v[76:79], v[92:95]
    v_mfma_f32_16x16x32_bf16 v[96:99], v[32:35], v[76:79], v[96:99]
    v_mfma_f32_16x16x32_bf16 v[100:103], v[36:39], v[76:79], v[100:103]
    v_mfma_f32_16x16x32_bf16 v[104:107], v[40:43], v[76:79], v[104:107]
    v_mfma_f32_16x16x32_bf16 v[108:111], v[44:47], v[76:79], v[108:111]
    s_waitcnt lgkmcnt(0)
    v_mfma_f32_16x16x32_bf16 v[84:87], v[48:51], v[80:83], v[84:87]
    v_mfma_f32_16x16x32_bf16 v[88:91], v[52:55], v[80:83], v[88:91]
    v_mfma_f32_16x16x32_bf16 v[92:95], v[56:59], v[80:83], v[92:95]
    v_mfma_f32_16x16x32_bf16 v[96:99], v[60:63], v[80:83], v[96:99]
    v_mfma_f32_16x16x32_bf16 v[100:103], v[64:67], v[80:83], v[100:103]
    v_mfma_f32_16x16x32_bf16 v[104:107], v[68:71], v[80:83], v[104:107]
    v_mfma_f32_16x16x32_bf16 v[108:111], v[72:75], v[80:83], v[108:111]
    s_nop 15
    s_waitcnt vmcnt(0)
    v_lshlrev_b32 v112, 16, v112
    v_cvt_pk_bf16_f32 v20, v84, v85
    v_lshlrev_b32 v84, 16, v20
    v_and_b32 v85, 0xffff0000, v20
    v_cvt_pk_bf16_f32 v20, v86, v87
    v_lshlrev_b32 v86, 16, v20
    v_and_b32 v87, 0xffff0000, v20
    v_add_f32 v84, v84, v112
    v_add_f32 v85, v85, v112
    v_add_f32 v86, v86, v112
    v_add_f32 v87, v87, v112
    v_cvt_pk_bf16_f32 v20, v84, v85
    v_lshlrev_b32 v84, 16, v20
    v_and_b32 v85, 0xffff0000, v20
    v_cvt_pk_bf16_f32 v20, v86, v87
    v_lshlrev_b32 v86, 16, v20
    v_and_b32 v87, 0xffff0000, v20
    v_lshlrev_b32 v20, 16, v116
    v_and_b32 v21, 0xffff0000, v116
    v_lshlrev_b32 v22, 16, v117
    v_and_b32 v23, 0xffff0000, v117
    v_pk_mul_f32 v[84:85], v[84:85], v[20:21]
    v_pk_mul_f32 v[86:87], v[86:87], v[22:23]
    v_cvt_pk_bf16_f32 v84, v84, v85
    v_cvt_pk_bf16_f32 v85, v86, v87
    buffer_store_dwordx2 v[84:85], v6, s[28:31], 0 offen offset:0
    v_cvt_pk_bf16_f32 v20, v88, v89
    v_lshlrev_b32 v88, 16, v20
    v_and_b32 v89, 0xffff0000, v20
    v_cvt_pk_bf16_f32 v20, v90, v91
    v_lshlrev_b32 v90, 16, v20
    v_and_b32 v91, 0xffff0000, v20
    v_add_f32 v88, v88, v112
    v_add_f32 v89, v89, v112
    v_add_f32 v90, v90, v112
    v_add_f32 v91, v91, v112
    v_cvt_pk_bf16_f32 v20, v88, v89
    v_lshlrev_b32 v88, 16, v20
    v_and_b32 v89, 0xffff0000, v20
    v_cvt_pk_bf16_f32 v20, v90, v91
    v_lshlrev_b32 v90, 16, v20
    v_and_b32 v91, 0xffff0000, v20
    v_lshlrev_b32 v20, 16, v118
    v_and_b32 v21, 0xffff0000, v118
    v_lshlrev_b32 v22, 16, v119
    v_and_b32 v23, 0xffff0000, v119
    v_pk_mul_f32 v[88:89], v[88:89], v[20:21]
    v_pk_mul_f32 v[90:91], v[90:91], v[22:23]
    v_cvt_pk_bf16_f32 v88, v88, v89
    v_cvt_pk_bf16_f32 v89, v90, v91
    buffer_store_dwordx2 v[88:89], v6, s[28:31], 0 offen offset:32
    v_cvt_pk_bf16_f32 v20, v92, v93
    v_lshlrev_b32 v92, 16, v20
    v_and_b32 v93, 0xffff0000, v20
    v_cvt_pk_bf16_f32 v20, v94, v95
    v_lshlrev_b32 v94, 16, v20
    v_and_b32 v95, 0xffff0000, v20
    v_add_f32 v92, v92, v112
    v_add_f32 v93, v93, v112
    v_add_f32 v94, v94, v112
    v_add_f32 v95, v95, v112
    v_cvt_pk_bf16_f32 v20, v92, v93
    v_lshlrev_b32 v92, 16, v20
    v_and_b32 v93, 0xffff0000, v20
    v_cvt_pk_bf16_f32 v20, v94, v95
    v_lshlrev_b32 v94, 16, v20
    v_and_b32 v95, 0xffff0000, v20
    v_lshlrev_b32 v20, 16, v120
    v_and_b32 v21, 0xffff0000, v120
    v_lshlrev_b32 v22, 16, v121
    v_and_b32 v23, 0xffff0000, v121
    v_pk_mul_f32 v[92:93], v[92:93], v[20:21]
    v_pk_mul_f32 v[94:95], v[94:95], v[22:23]
    v_cvt_pk_bf16_f32 v92, v92, v93
    v_cvt_pk_bf16_f32 v93, v94, v95
    buffer_store_dwordx2 v[92:93], v6, s[28:31], 0 offen offset:64
    v_cvt_pk_bf16_f32 v20, v96, v97
    v_lshlrev_b32 v96, 16, v20
    v_and_b32 v97, 0xffff0000, v20
    v_cvt_pk_bf16_f32 v20, v98, v99
    v_lshlrev_b32 v98, 16, v20
    v_and_b32 v99, 0xffff0000, v20
    v_add_f32 v96, v96, v112
    v_add_f32 v97, v97, v112
    v_add_f32 v98, v98, v112
    v_add_f32 v99, v99, v112
    v_cvt_pk_bf16_f32 v20, v96, v97
    v_lshlrev_b32 v96, 16, v20
    v_and_b32 v97, 0xffff0000, v20
    v_cvt_pk_bf16_f32 v20, v98, v99
    v_lshlrev_b32 v98, 16, v20
    v_and_b32 v99, 0xffff0000, v20
    v_lshlrev_b32 v20, 16, v122
    v_and_b32 v21, 0xffff0000, v122
    v_lshlrev_b32 v22, 16, v123
    v_and_b32 v23, 0xffff0000, v123
    v_pk_mul_f32 v[96:97], v[96:97], v[20:21]
    v_pk_mul_f32 v[98:99], v[98:99], v[22:23]
    v_cvt_pk_bf16_f32 v96, v96, v97
    v_cvt_pk_bf16_f32 v97, v98, v99
    buffer_store_dwordx2 v[96:97], v6, s[28:31], 0 offen offset:96
    v_cvt_pk_bf16_f32 v20, v100, v101
    v_lshlrev_b32 v100, 16, v20
    v_and_b32 v101, 0xffff0000, v20
    v_cvt_pk_bf16_f32 v20, v102, v103
    v_lshlrev_b32 v102, 16, v20
    v_and_b32 v103, 0xffff0000, v20
    v_add_f32 v100, v100, v112
    v_add_f32 v101, v101, v112
    v_add_f32 v102, v102, v112
    v_add_f32 v103, v103, v112
    v_cvt_pk_bf16_f32 v20, v100, v101
    v_lshlrev_b32 v100, 16, v20
    v_and_b32 v101, 0xffff0000, v20
    v_cvt_pk_bf16_f32 v20, v102, v103
    v_lshlrev_b32 v102, 16, v20
    v_and_b32 v103, 0xffff0000, v20
    v_lshlrev_b32 v20, 16, v124
    v_and_b32 v21, 0xffff0000, v124
    v_lshlrev_b32 v22, 16, v125
    v_and_b32 v23, 0xffff0000, v125
    v_pk_mul_f32 v[100:101], v[100:101], v[20:21]
    v_pk_mul_f32 v[102:103], v[102:103], v[22:23]
    v_cvt_pk_bf16_f32 v100, v100, v101
    v_cvt_pk_bf16_f32 v101, v102, v103
    buffer_store_dwordx2 v[100:101], v6, s[28:31], 0 offen offset:128
    v_cvt_pk_bf16_f32 v20, v104, v105
    v_lshlrev_b32 v104, 16, v20
    v_and_b32 v105, 0xffff0000, v20
    v_cvt_pk_bf16_f32 v20, v106, v107
    v_lshlrev_b32 v106, 16, v20
    v_and_b32 v107, 0xffff0000, v20
    v_add_f32 v104, v104, v112
    v_add_f32 v105, v105, v112
    v_add_f32 v106, v106, v112
    v_add_f32 v107, v107, v112
    v_cvt_pk_bf16_f32 v20, v104, v105
    v_lshlrev_b32 v104, 16, v20
    v_and_b32 v105, 0xffff0000, v20
    v_cvt_pk_bf16_f32 v20, v106, v107
    v_lshlrev_b32 v106, 16, v20
    v_and_b32 v107, 0xffff0000, v20
    v_lshlrev_b32 v20, 16, v126
    v_and_b32 v21, 0xffff0000, v126
    v_lshlrev_b32 v22, 16, v127
    v_and_b32 v23, 0xffff0000, v127
    v_pk_mul_f32 v[104:105], v[104:105], v[20:21]
    v_pk_mul_f32 v[106:107], v[106:107], v[22:23]
    v_cvt_pk_bf16_f32 v104, v104, v105
    v_cvt_pk_bf16_f32 v105, v106, v107
    buffer_store_dwordx2 v[104:105], v6, s[28:31], 0 offen offset:160
    v_cvt_pk_bf16_f32 v20, v108, v109
    v_lshlrev_b32 v108, 16, v20
    v_and_b32 v109, 0xffff0000, v20
    v_cvt_pk_bf16_f32 v20, v110, v111
    v_lshlrev_b32 v110, 16, v20
    v_and_b32 v111, 0xffff0000, v20
    v_add_f32 v108, v108, v112
    v_add_f32 v109, v109, v112
    v_add_f32 v110, v110, v112
    v_add_f32 v111, v111, v112
    v_cvt_pk_bf16_f32 v20, v108, v109
    v_lshlrev_b32 v108, 16, v20
    v_and_b32 v109, 0xffff0000, v20
    v_cvt_pk_bf16_f32 v20, v110, v111
    v_lshlrev_b32 v110, 16, v20
    v_and_b32 v111, 0xffff0000, v20
    v_lshlrev_b32 v20, 16, v128
    v_and_b32 v21, 0xffff0000, v128
    v_lshlrev_b32 v22, 16, v129
    v_and_b32 v23, 0xffff0000, v129
    v_pk_mul_f32 v[108:109], v[108:109], v[20:21]
    v_pk_mul_f32 v[110:111], v[110:111], v[22:23]
    v_cvt_pk_bf16_f32 v108, v108, v109
    v_cvt_pk_bf16_f32 v109, v110, v111
    s_cmp_ge_u32 s39, 6
    s_cbranch_scc1 Lsk_27
    buffer_store_dwordx2 v[108:109], v6, s[28:31], 0 offen offset:192
Lsk_27:
    v_add_u32 v6, 27648, v6
    s_branch Lend_23
Lload_24:
    s_add_u32 s16, s4, 0x1170000
    s_addc_u32 s17, s5, 0
    s_mov_b32 s18, 0x361000
    s_mov_b32 s19, 0x00020000
    s_mov_b32 s20, s6
    s_mov_b32 s21, s7
    s_mov_b32 s22, 0x800000
    s_mov_b32 s23, 0x00020000
    v_lshrrev_b32 v3, 3, v2
    v_and_b32 v4, 7, v2
    s_cmp_eq_u32 s44, 5
    s_cbranch_scc1 Lld_29
    s_cmp_eq_u32 s44, 6
    s_cbranch_scc1 Lld_30
    s_cmp_eq_u32 s44, 7
    s_cbranch_scc1 Lld_31
Lld_28:
    v_add_u32 v6, 0, v5
    v_and_b32 v6, 7, v6
    v_xor_b32 v6, v6, v4
    v_add_u32 v7, s42, v3
    v_lshlrev_b32 v7, 5, v7
    v_lshrrev_b32 v8, 1, v6
    v_mul_u32_u24 v8, 27648, v8
    v_add_u32 v7, v7, v8
    v_and_b32 v6, 1, v6
    v_lshl_add_u32 v8, v6, 4, v7
    v_add_u32 v6, 0, v5
    v_and_b32 v6, 7, v6
    v_xor_b32 v6, v6, v4
    v_add_u32 v7, s42, v3
    v_add_u32 v7, 32, v7
    v_lshlrev_b32 v7, 5, v7
    v_lshrrev_b32 v9, 1, v6
    v_mul_u32_u24 v9, 27648, v9
    v_add_u32 v7, v7, v9
    v_and_b32 v6, 1, v6
    v_lshl_add_u32 v9, v6, 4, v7
    v_add_u32 v6, 0, v5
    v_and_b32 v6, 7, v6
    v_xor_b32 v6, v6, v4
    v_add_u32 v7, s42, v3
    v_add_u32 v7, 64, v7
    v_lshlrev_b32 v7, 5, v7
    v_lshrrev_b32 v10, 1, v6
    v_mul_u32_u24 v10, 27648, v10
    v_add_u32 v7, v7, v10
    v_and_b32 v6, 1, v6
    v_lshl_add_u32 v10, v6, 4, v7
    v_add_u32 v6, 0, v5
    v_and_b32 v6, 7, v6
    v_xor_b32 v6, v6, v4
    v_add_u32 v7, s42, v3
    v_add_u32 v7, 96, v7
    v_lshlrev_b32 v7, 5, v7
    v_lshrrev_b32 v11, 1, v6
    v_mul_u32_u24 v11, 27648, v11
    v_add_u32 v7, v7, v11
    v_and_b32 v6, 1, v6
    v_lshl_add_u32 v11, v6, 4, v7
    v_add_u32 v6, 0, v5
    v_and_b32 v6, 7, v6
    v_xor_b32 v6, v6, v4
    v_add_u32 v7, s43, v3
    v_add_u32 v7, 16, v7
    s_mov_b32 s47, 4096
    v_mul_lo_u32 v7, v7, s47
    v_lshl_add_u32 v12, v6, 4, v7
    v_add_u32 v6, 0, v5
    v_and_b32 v6, 7, v6
    v_xor_b32 v6, v6, v4
    v_add_u32 v7, s43, v3
    v_add_u32 v7, 48, v7
    s_mov_b32 s47, 4096
    v_mul_lo_u32 v7, v7, s47
    v_lshl_add_u32 v13, v6, 4, v7
    s_mov_b32 s50, 0
    s_mov_b32 s51, 0
    s_mov_b32 m0, 0
    s_nop 0
    buffer_load_dwordx4 v8, s[16:19], s51 offen lds
    s_mov_b32 m0, 4096
    s_nop 0
    buffer_load_dwordx4 v9, s[16:19], s51 offen lds
    s_mov_b32 m0, 8192
    s_nop 0
    buffer_load_dwordx4 v10, s[16:19], s51 offen lds
    s_mov_b32 m0, 12288
    s_nop 0
    buffer_load_dwordx4 v11, s[16:19], s51 offen lds
    s_mov_b32 m0, 16384
    s_nop 0
    buffer_load_dwordx4 v12, s[20:23], s50 offen lds
    s_mov_b32 m0, 20480
    s_nop 0
    buffer_load_dwordx4 v13, s[20:23], s50 offen lds
    s_mov_b32 s50, 128
    s_mov_b32 s51, 110592
    s_mov_b32 m0, 22528
    s_nop 0
    buffer_load_dwordx4 v8, s[16:19], s51 offen lds
    s_mov_b32 m0, 26624
    s_nop 0
    buffer_load_dwordx4 v9, s[16:19], s51 offen lds
    s_mov_b32 m0, 30720
    s_nop 0
    buffer_load_dwordx4 v10, s[16:19], s51 offen lds
    s_mov_b32 m0, 34816
    s_nop 0
    buffer_load_dwordx4 v11, s[16:19], s51 offen lds
    s_mov_b32 m0, 38912
    s_nop 0
    buffer_load_dwordx4 v12, s[20:23], s50 offen lds
    s_mov_b32 m0, 43008
    s_nop 0
    buffer_load_dwordx4 v13, s[20:23], s50 offen lds
    s_mov_b32 s50, 256
    s_mov_b32 s51, 221184
    s_mov_b32 m0, 45056
    s_nop 0
    buffer_load_dwordx4 v8, s[16:19], s51 offen lds
    s_mov_b32 m0, 49152
    s_nop 0
    buffer_load_dwordx4 v9, s[16:19], s51 offen lds
    s_mov_b32 m0, 53248
    s_nop 0
    buffer_load_dwordx4 v10, s[16:19], s51 offen lds
    s_mov_b32 m0, 57344
    s_nop 0
    buffer_load_dwordx4 v11, s[16:19], s51 offen lds
    s_mov_b32 m0, 61440
    s_nop 0
    buffer_load_dwordx4 v12, s[20:23], s50 offen lds
    s_mov_b32 m0, 65536
    s_nop 0
    buffer_load_dwordx4 v13, s[20:23], s50 offen lds
    s_mov_b32 s50, 384
    s_mov_b32 s51, 331776
    s_mov_b32 m0, 67584
    s_nop 0
    buffer_load_dwordx4 v8, s[16:19], s51 offen lds
    s_mov_b32 m0, 71680
    s_nop 0
    buffer_load_dwordx4 v9, s[16:19], s51 offen lds
    s_mov_b32 m0, 75776
    s_nop 0
    buffer_load_dwordx4 v10, s[16:19], s51 offen lds
    s_mov_b32 m0, 79872
    s_nop 0
    buffer_load_dwordx4 v11, s[16:19], s51 offen lds
    s_mov_b32 m0, 83968
    s_nop 0
    buffer_load_dwordx4 v12, s[20:23], s50 offen lds
    s_mov_b32 m0, 88064
    s_nop 0
    buffer_load_dwordx4 v13, s[20:23], s50 offen lds
    s_mov_b32 s50, 512
    s_mov_b32 s51, 442368
    s_mov_b32 m0, 90112
    s_nop 0
    buffer_load_dwordx4 v8, s[16:19], s51 offen lds
    s_mov_b32 m0, 94208
    s_nop 0
    buffer_load_dwordx4 v9, s[16:19], s51 offen lds
    s_mov_b32 m0, 98304
    s_nop 0
    buffer_load_dwordx4 v10, s[16:19], s51 offen lds
    s_mov_b32 m0, 102400
    s_nop 0
    buffer_load_dwordx4 v11, s[16:19], s51 offen lds
    s_mov_b32 m0, 106496
    s_nop 0
    buffer_load_dwordx4 v12, s[20:23], s50 offen lds
    s_mov_b32 m0, 110592
    s_nop 0
    buffer_load_dwordx4 v13, s[20:23], s50 offen lds
    s_waitcnt vmcnt(24)
    s_barrier
    s_waitcnt vmcnt(18)
    s_barrier
    s_mov_b32 s50, 640
    s_mov_b32 s51, 552960
    s_mov_b32 m0, 112640
    s_nop 0
    buffer_load_dwordx4 v8, s[16:19], s51 offen lds
    s_mov_b32 m0, 116736
    s_nop 0
    buffer_load_dwordx4 v9, s[16:19], s51 offen lds
    s_mov_b32 m0, 120832
    s_nop 0
    buffer_load_dwordx4 v10, s[16:19], s51 offen lds
    s_mov_b32 m0, 124928
    s_nop 0
    buffer_load_dwordx4 v11, s[16:19], s51 offen lds
    s_mov_b32 m0, 129024
    s_nop 0
    buffer_load_dwordx4 v12, s[20:23], s50 offen lds
    s_mov_b32 m0, 133120
    s_nop 0
    buffer_load_dwordx4 v13, s[20:23], s50 offen lds
    s_waitcnt vmcnt(18)
    s_barrier
    s_mov_b32 s50, 768
    s_mov_b32 s51, 663552
    s_mov_b32 m0, 0
    s_nop 0
    buffer_load_dwordx4 v8, s[16:19], s51 offen lds
    s_mov_b32 m0, 4096
    s_nop 0
    buffer_load_dwordx4 v9, s[16:19], s51 offen lds
    s_mov_b32 m0, 8192
    s_nop 0
    buffer_load_dwordx4 v10, s[16:19], s51 offen lds
    s_mov_b32 m0, 12288
    s_nop 0
    buffer_load_dwordx4 v11, s[16:19], s51 offen lds
    s_mov_b32 m0, 16384
    s_nop 0
    buffer_load_dwordx4 v12, s[20:23], s50 offen lds
    s_mov_b32 m0, 20480
    s_nop 0
    buffer_load_dwordx4 v13, s[20:23], s50 offen lds
    s_waitcnt vmcnt(18)
    s_barrier
    s_mov_b32 s50, 896
    s_mov_b32 s51, 774144
    s_mov_b32 m0, 22528
    s_nop 0
    buffer_load_dwordx4 v8, s[16:19], s51 offen lds
    s_mov_b32 m0, 26624
    s_nop 0
    buffer_load_dwordx4 v9, s[16:19], s51 offen lds
    s_mov_b32 m0, 30720
    s_nop 0
    buffer_load_dwordx4 v10, s[16:19], s51 offen lds
    s_mov_b32 m0, 34816
    s_nop 0
    buffer_load_dwordx4 v11, s[16:19], s51 offen lds
    s_mov_b32 m0, 38912
    s_nop 0
    buffer_load_dwordx4 v12, s[20:23], s50 offen lds
    s_mov_b32 m0, 43008
    s_nop 0
    buffer_load_dwordx4 v13, s[20:23], s50 offen lds
    s_waitcnt vmcnt(18)
    s_barrier
    s_mov_b32 s50, 1024
    s_mov_b32 s51, 884736
    s_mov_b32 m0, 45056
    s_nop 0
    buffer_load_dwordx4 v8, s[16:19], s51 offen lds
    s_mov_b32 m0, 49152
    s_nop 0
    buffer_load_dwordx4 v9, s[16:19], s51 offen lds
    s_mov_b32 m0, 53248
    s_nop 0
    buffer_load_dwordx4 v10, s[16:19], s51 offen lds
    s_mov_b32 m0, 57344
    s_nop 0
    buffer_load_dwordx4 v11, s[16:19], s51 offen lds
    s_mov_b32 m0, 61440
    s_nop 0
    buffer_load_dwordx4 v12, s[20:23], s50 offen lds
    s_mov_b32 m0, 65536
    s_nop 0
    buffer_load_dwordx4 v13, s[20:23], s50 offen lds
    s_waitcnt vmcnt(18)
    s_barrier
    s_mov_b32 s50, 1152
    s_mov_b32 s51, 995328
    s_mov_b32 m0, 67584
    s_nop 0
    buffer_load_dwordx4 v8, s[16:19], s51 offen lds
    s_mov_b32 m0, 71680
    s_nop 0
    buffer_load_dwordx4 v9, s[16:19], s51 offen lds
    s_mov_b32 m0, 75776
    s_nop 0
    buffer_load_dwordx4 v10, s[16:19], s51 offen lds
    s_mov_b32 m0, 79872
    s_nop 0
    buffer_load_dwordx4 v11, s[16:19], s51 offen lds
    s_mov_b32 m0, 83968
    s_nop 0
    buffer_load_dwordx4 v12, s[20:23], s50 offen lds
    s_mov_b32 m0, 88064
    s_nop 0
    buffer_load_dwordx4 v13, s[20:23], s50 offen lds
    s_waitcnt vmcnt(18)
    s_barrier
    s_mov_b32 s50, 1280
    s_mov_b32 s51, 1105920
    s_mov_b32 m0, 90112
    s_nop 0
    buffer_load_dwordx4 v8, s[16:19], s51 offen lds
    s_mov_b32 m0, 94208
    s_nop 0
    buffer_load_dwordx4 v9, s[16:19], s51 offen lds
    s_mov_b32 m0, 98304
    s_nop 0
    buffer_load_dwordx4 v10, s[16:19], s51 offen lds
    s_mov_b32 m0, 102400
    s_nop 0
    buffer_load_dwordx4 v11, s[16:19], s51 offen lds
    s_mov_b32 m0, 106496
    s_nop 0
    buffer_load_dwordx4 v12, s[20:23], s50 offen lds
    s_mov_b32 m0, 110592
    s_nop 0
    buffer_load_dwordx4 v13, s[20:23], s50 offen lds
    s_waitcnt vmcnt(18)
    s_barrier
    s_mov_b32 s50, 1408
    s_mov_b32 s51, 1216512
    s_mov_b32 m0, 112640
    s_nop 0
    buffer_load_dwordx4 v8, s[16:19], s51 offen lds
    s_mov_b32 m0, 116736
    s_nop 0
    buffer_load_dwordx4 v9, s[16:19], s51 offen lds
    s_mov_b32 m0, 120832
    s_nop 0
    buffer_load_dwordx4 v10, s[16:19], s51 offen lds
    s_mov_b32 m0, 124928
    s_nop 0
    buffer_load_dwordx4 v11, s[16:19], s51 offen lds
    s_mov_b32 m0, 129024
    s_nop 0
    buffer_load_dwordx4 v12, s[20:23], s50 offen lds
    s_mov_b32 m0, 133120
    s_nop 0
    buffer_load_dwordx4 v13, s[20:23], s50 offen lds
    s_waitcnt vmcnt(18)
    s_barrier
    s_mov_b32 s50, 1536
    s_mov_b32 s51, 1327104
    s_mov_b32 m0, 0
    s_nop 0
    buffer_load_dwordx4 v8, s[16:19], s51 offen lds
    s_mov_b32 m0, 4096
    s_nop 0
    buffer_load_dwordx4 v9, s[16:19], s51 offen lds
    s_mov_b32 m0, 8192
    s_nop 0
    buffer_load_dwordx4 v10, s[16:19], s51 offen lds
    s_mov_b32 m0, 12288
    s_nop 0
    buffer_load_dwordx4 v11, s[16:19], s51 offen lds
    s_mov_b32 m0, 16384
    s_nop 0
    buffer_load_dwordx4 v12, s[20:23], s50 offen lds
    s_mov_b32 m0, 20480
    s_nop 0
    buffer_load_dwordx4 v13, s[20:23], s50 offen lds
    s_waitcnt vmcnt(18)
    s_barrier
    s_mov_b32 s50, 1664
    s_mov_b32 s51, 1437696
    s_mov_b32 m0, 22528
    s_nop 0
    buffer_load_dwordx4 v8, s[16:19], s51 offen lds
    s_mov_b32 m0, 26624
    s_nop 0
    buffer_load_dwordx4 v9, s[16:19], s51 offen lds
    s_mov_b32 m0, 30720
    s_nop 0
    buffer_load_dwordx4 v10, s[16:19], s51 offen lds
    s_mov_b32 m0, 34816
    s_nop 0
    buffer_load_dwordx4 v11, s[16:19], s51 offen lds
    s_mov_b32 m0, 38912
    s_nop 0
    buffer_load_dwordx4 v12, s[20:23], s50 offen lds
    s_mov_b32 m0, 43008
    s_nop 0
    buffer_load_dwordx4 v13, s[20:23], s50 offen lds
    s_waitcnt vmcnt(18)
    s_barrier
    s_mov_b32 s50, 1792
    s_mov_b32 s51, 1548288
    s_mov_b32 m0, 45056
    s_nop 0
    buffer_load_dwordx4 v8, s[16:19], s51 offen lds
    s_mov_b32 m0, 49152
    s_nop 0
    buffer_load_dwordx4 v9, s[16:19], s51 offen lds
    s_mov_b32 m0, 53248
    s_nop 0
    buffer_load_dwordx4 v10, s[16:19], s51 offen lds
    s_mov_b32 m0, 57344
    s_nop 0
    buffer_load_dwordx4 v11, s[16:19], s51 offen lds
    s_mov_b32 m0, 61440
    s_nop 0
    buffer_load_dwordx4 v12, s[20:23], s50 offen lds
    s_mov_b32 m0, 65536
    s_nop 0
    buffer_load_dwordx4 v13, s[20:23], s50 offen lds
    s_waitcnt vmcnt(18)
    s_barrier
    s_mov_b32 s50, 1920
    s_mov_b32 s51, 1658880
    s_mov_b32 m0, 67584
    s_nop 0
    buffer_load_dwordx4 v8, s[16:19], s51 offen lds
    s_mov_b32 m0, 71680
    s_nop 0
    buffer_load_dwordx4 v9, s[16:19], s51 offen lds
    s_mov_b32 m0, 75776
    s_nop 0
    buffer_load_dwordx4 v10, s[16:19], s51 offen lds
    s_mov_b32 m0, 79872
    s_nop 0
    buffer_load_dwordx4 v11, s[16:19], s51 offen lds
    s_mov_b32 m0, 83968
    s_nop 0
    buffer_load_dwordx4 v12, s[20:23], s50 offen lds
    s_mov_b32 m0, 88064
    s_nop 0
    buffer_load_dwordx4 v13, s[20:23], s50 offen lds
    s_waitcnt vmcnt(18)
    s_barrier
    s_mov_b32 s50, 2048
    s_mov_b32 s51, 1769472
    s_mov_b32 m0, 90112
    s_nop 0
    buffer_load_dwordx4 v8, s[16:19], s51 offen lds
    s_mov_b32 m0, 94208
    s_nop 0
    buffer_load_dwordx4 v9, s[16:19], s51 offen lds
    s_mov_b32 m0, 98304
    s_nop 0
    buffer_load_dwordx4 v10, s[16:19], s51 offen lds
    s_mov_b32 m0, 102400
    s_nop 0
    buffer_load_dwordx4 v11, s[16:19], s51 offen lds
    s_mov_b32 m0, 106496
    s_nop 0
    buffer_load_dwordx4 v12, s[20:23], s50 offen lds
    s_mov_b32 m0, 110592
    s_nop 0
    buffer_load_dwordx4 v13, s[20:23], s50 offen lds
    s_waitcnt vmcnt(18)
    s_barrier
    s_mov_b32 s50, 2176
    s_mov_b32 s51, 1880064
    s_mov_b32 m0, 112640
    s_nop 0
    buffer_load_dwordx4 v8, s[16:19], s51 offen lds
    s_mov_b32 m0, 116736
    s_nop 0
    buffer_load_dwordx4 v9, s[16:19], s51 offen lds
    s_mov_b32 m0, 120832
    s_nop 0
    buffer_load_dwordx4 v10, s[16:19], s51 offen lds
    s_mov_b32 m0, 124928
    s_nop 0
    buffer_load_dwordx4 v11, s[16:19], s51 offen lds
    s_mov_b32 m0, 129024
    s_nop 0
    buffer_load_dwordx4 v12, s[20:23], s50 offen lds
    s_mov_b32 m0, 133120
    s_nop 0
    buffer_load_dwordx4 v13, s[20:23], s50 offen lds
    s_waitcnt vmcnt(18)
    s_barrier
    s_mov_b32 s50, 2304
    s_mov_b32 s51, 1990656
    s_mov_b32 m0, 0
    s_nop 0
    buffer_load_dwordx4 v8, s[16:19], s51 offen lds
    s_mov_b32 m0, 4096
    s_nop 0
    buffer_load_dwordx4 v9, s[16:19], s51 offen lds
    s_mov_b32 m0, 8192
    s_nop 0
    buffer_load_dwordx4 v10, s[16:19], s51 offen lds
    s_mov_b32 m0, 12288
    s_nop 0
    buffer_load_dwordx4 v11, s[16:19], s51 offen lds
    s_mov_b32 m0, 16384
    s_nop 0
    buffer_load_dwordx4 v12, s[20:23], s50 offen lds
    s_mov_b32 m0, 20480
    s_nop 0
    buffer_load_dwordx4 v13, s[20:23], s50 offen lds
    s_waitcnt vmcnt(18)
    s_barrier
    s_mov_b32 s50, 2432
    s_mov_b32 s51, 2101248
    s_mov_b32 m0, 22528
    s_nop 0
    buffer_load_dwordx4 v8, s[16:19], s51 offen lds
    s_mov_b32 m0, 26624
    s_nop 0
    buffer_load_dwordx4 v9, s[16:19], s51 offen lds
    s_mov_b32 m0, 30720
    s_nop 0
    buffer_load_dwordx4 v10, s[16:19], s51 offen lds
    s_mov_b32 m0, 34816
    s_nop 0
    buffer_load_dwordx4 v11, s[16:19], s51 offen lds
    s_mov_b32 m0, 38912
    s_nop 0
    buffer_load_dwordx4 v12, s[20:23], s50 offen lds
    s_mov_b32 m0, 43008
    s_nop 0
    buffer_load_dwordx4 v13, s[20:23], s50 offen lds
    s_waitcnt vmcnt(18)
    s_barrier
    s_mov_b32 s50, 2560
    s_mov_b32 s51, 2211840
    s_mov_b32 m0, 45056
    s_nop 0
    buffer_load_dwordx4 v8, s[16:19], s51 offen lds
    s_mov_b32 m0, 49152
    s_nop 0
    buffer_load_dwordx4 v9, s[16:19], s51 offen lds
    s_mov_b32 m0, 53248
    s_nop 0
    buffer_load_dwordx4 v10, s[16:19], s51 offen lds
    s_mov_b32 m0, 57344
    s_nop 0
    buffer_load_dwordx4 v11, s[16:19], s51 offen lds
    s_mov_b32 m0, 61440
    s_nop 0
    buffer_load_dwordx4 v12, s[20:23], s50 offen lds
    s_mov_b32 m0, 65536
    s_nop 0
    buffer_load_dwordx4 v13, s[20:23], s50 offen lds
    s_waitcnt vmcnt(18)
    s_barrier
    s_mov_b32 s50, 2688
    s_mov_b32 s51, 2322432
    s_mov_b32 m0, 67584
    s_nop 0
    buffer_load_dwordx4 v8, s[16:19], s51 offen lds
    s_mov_b32 m0, 71680
    s_nop 0
    buffer_load_dwordx4 v9, s[16:19], s51 offen lds
    s_mov_b32 m0, 75776
    s_nop 0
    buffer_load_dwordx4 v10, s[16:19], s51 offen lds
    s_mov_b32 m0, 79872
    s_nop 0
    buffer_load_dwordx4 v11, s[16:19], s51 offen lds
    s_mov_b32 m0, 83968
    s_nop 0
    buffer_load_dwordx4 v12, s[20:23], s50 offen lds
    s_mov_b32 m0, 88064
    s_nop 0
    buffer_load_dwordx4 v13, s[20:23], s50 offen lds
    s_waitcnt vmcnt(18)
    s_barrier
    s_mov_b32 s50, 2816
    s_mov_b32 s51, 2433024
    s_mov_b32 m0, 90112
    s_nop 0
    buffer_load_dwordx4 v8, s[16:19], s51 offen lds
    s_mov_b32 m0, 94208
    s_nop 0
    buffer_load_dwordx4 v9, s[16:19], s51 offen lds
    s_mov_b32 m0, 98304
    s_nop 0
    buffer_load_dwordx4 v10, s[16:19], s51 offen lds
    s_mov_b32 m0, 102400
    s_nop 0
    buffer_load_dwordx4 v11, s[16:19], s51 offen lds
    s_mov_b32 m0, 106496
    s_nop 0
    buffer_load_dwordx4 v12, s[20:23], s50 offen lds
    s_mov_b32 m0, 110592
    s_nop 0
    buffer_load_dwordx4 v13, s[20:23], s50 offen lds
    s_waitcnt vmcnt(18)
    s_barrier
    s_mov_b32 s50, 2944
    s_mov_b32 s51, 2543616
    s_mov_b32 m0, 112640
    s_nop 0
    buffer_load_dwordx4 v8, s[16:19], s51 offen lds
    s_mov_b32 m0, 116736
    s_nop 0
    buffer_load_dwordx4 v9, s[16:19], s51 offen lds
    s_mov_b32 m0, 120832
    s_nop 0
    buffer_load_dwordx4 v10, s[16:19], s51 offen lds
    s_mov_b32 m0, 124928
    s_nop 0
    buffer_load_dwordx4 v11, s[16:19], s51 offen lds
    s_mov_b32 m0, 129024
    s_nop 0
    buffer_load_dwordx4 v12, s[20:23], s50 offen lds
    s_mov_b32 m0, 133120
    s_nop 0
    buffer_load_dwordx4 v13, s[20:23], s50 offen lds
    s_waitcnt vmcnt(18)
    s_barrier
    s_mov_b32 s50, 3072
    s_mov_b32 s51, 2654208
    s_mov_b32 m0, 0
    s_nop 0
    buffer_load_dwordx4 v8, s[16:19], s51 offen lds
    s_mov_b32 m0, 4096
    s_nop 0
    buffer_load_dwordx4 v9, s[16:19], s51 offen lds
    s_mov_b32 m0, 8192
    s_nop 0
    buffer_load_dwordx4 v10, s[16:19], s51 offen lds
    s_mov_b32 m0, 12288
    s_nop 0
    buffer_load_dwordx4 v11, s[16:19], s51 offen lds
    s_mov_b32 m0, 16384
    s_nop 0
    buffer_load_dwordx4 v12, s[20:23], s50 offen lds
    s_mov_b32 m0, 20480
    s_nop 0
    buffer_load_dwordx4 v13, s[20:23], s50 offen lds
    s_waitcnt vmcnt(18)
    s_barrier
    s_mov_b32 s50, 3200
    s_mov_b32 s51, 2764800
    s_mov_b32 m0, 22528
    s_nop 0
    buffer_load_dwordx4 v8, s[16:19], s51 offen lds
    s_mov_b32 m0, 26624
    s_nop 0
    buffer_load_dwordx4 v9, s[16:19], s51 offen lds
    s_mov_b32 m0, 30720
    s_nop 0
    buffer_load_dwordx4 v10, s[16:19], s51 offen lds
    s_mov_b32 m0, 34816
    s_nop 0
    buffer_load_dwordx4 v11, s[16:19], s51 offen lds
    s_mov_b32 m0, 38912
    s_nop 0
    buffer_load_dwordx4 v12, s[20:23], s50 offen lds
    s_mov_b32 m0, 43008
    s_nop 0
    buffer_load_dwordx4 v13, s[20:23], s50 offen lds
    s_waitcnt vmcnt(18)
    s_barrier
    s_mov_b32 s50, 3328
    s_mov_b32 s51, 2875392
    s_mov_b32 m0, 45056
    s_nop 0
    buffer_load_dwordx4 v8, s[16:19], s51 offen lds
    s_mov_b32 m0, 49152
    s_nop 0
    buffer_load_dwordx4 v9, s[16:19], s51 offen lds
    s_mov_b32 m0, 53248
    s_nop 0
    buffer_load_dwordx4 v10, s[16:19], s51 offen lds
    s_mov_b32 m0, 57344
    s_nop 0
    buffer_load_dwordx4 v11, s[16:19], s51 offen lds
    s_mov_b32 m0, 61440
    s_nop 0
    buffer_load_dwordx4 v12, s[20:23], s50 offen lds
    s_mov_b32 m0, 65536
    s_nop 0
    buffer_load_dwordx4 v13, s[20:23], s50 offen lds
    s_waitcnt vmcnt(18)
    s_barrier
    s_mov_b32 s50, 3456
    s_mov_b32 s51, 2985984
    s_mov_b32 m0, 67584
    s_nop 0
    buffer_load_dwordx4 v8, s[16:19], s51 offen lds
    s_mov_b32 m0, 71680
    s_nop 0
    buffer_load_dwordx4 v9, s[16:19], s51 offen lds
    s_mov_b32 m0, 75776
    s_nop 0
    buffer_load_dwordx4 v10, s[16:19], s51 offen lds
    s_mov_b32 m0, 79872
    s_nop 0
    buffer_load_dwordx4 v11, s[16:19], s51 offen lds
    s_mov_b32 m0, 83968
    s_nop 0
    buffer_load_dwordx4 v12, s[20:23], s50 offen lds
    s_mov_b32 m0, 88064
    s_nop 0
    buffer_load_dwordx4 v13, s[20:23], s50 offen lds
    s_waitcnt vmcnt(18)
    s_barrier
    s_mov_b32 s50, 3584
    s_mov_b32 s51, 3096576
    s_mov_b32 m0, 90112
    s_nop 0
    buffer_load_dwordx4 v8, s[16:19], s51 offen lds
    s_mov_b32 m0, 94208
    s_nop 0
    buffer_load_dwordx4 v9, s[16:19], s51 offen lds
    s_mov_b32 m0, 98304
    s_nop 0
    buffer_load_dwordx4 v10, s[16:19], s51 offen lds
    s_mov_b32 m0, 102400
    s_nop 0
    buffer_load_dwordx4 v11, s[16:19], s51 offen lds
    s_mov_b32 m0, 106496
    s_nop 0
    buffer_load_dwordx4 v12, s[20:23], s50 offen lds
    s_mov_b32 m0, 110592
    s_nop 0
    buffer_load_dwordx4 v13, s[20:23], s50 offen lds
    s_waitcnt vmcnt(18)
    s_barrier
    s_mov_b32 s50, 3712
    s_mov_b32 s51, 3207168
    s_mov_b32 m0, 112640
    s_nop 0
    buffer_load_dwordx4 v8, s[16:19], s51 offen lds
    s_mov_b32 m0, 116736
    s_nop 0
    buffer_load_dwordx4 v9, s[16:19], s51 offen lds
    s_mov_b32 m0, 120832
    s_nop 0
    buffer_load_dwordx4 v10, s[16:19], s51 offen lds
    s_mov_b32 m0, 124928
    s_nop 0
    buffer_load_dwordx4 v11, s[16:19], s51 offen lds
    s_mov_b32 m0, 129024
    s_nop 0
    buffer_load_dwordx4 v12, s[20:23], s50 offen lds
    s_mov_b32 m0, 133120
    s_nop 0
    buffer_load_dwordx4 v13, s[20:23], s50 offen lds
    s_waitcnt vmcnt(18)
    s_barrier
    s_mov_b32 s50, 3840
    s_mov_b32 s51, 3317760
    s_mov_b32 m0, 0
    s_nop 0
    buffer_load_dwordx4 v8, s[16:19], s51 offen lds
    s_mov_b32 m0, 4096
    s_nop 0
    buffer_load_dwordx4 v9, s[16:19], s51 offen lds
    s_mov_b32 m0, 8192
    s_nop 0
    buffer_load_dwordx4 v10, s[16:19], s51 offen lds
    s_mov_b32 m0, 12288
    s_nop 0
    buffer_load_dwordx4 v11, s[16:19], s51 offen lds
    s_mov_b32 m0, 16384
    s_nop 0
    buffer_load_dwordx4 v12, s[20:23], s50 offen lds
    s_mov_b32 m0, 20480
    s_nop 0
    buffer_load_dwordx4 v13, s[20:23], s50 offen lds
    s_waitcnt vmcnt(18)
    s_barrier
    s_mov_b32 s50, 3968
    s_mov_b32 s51, 3428352
    s_mov_b32 m0, 22528
    s_nop 0
    buffer_load_dwordx4 v8, s[16:19], s51 offen lds
    s_mov_b32 m0, 26624
    s_nop 0
    buffer_load_dwordx4 v9, s[16:19], s51 offen lds
    s_mov_b32 m0, 30720
    s_nop 0
    buffer_load_dwordx4 v10, s[16:19], s51 offen lds
    s_mov_b32 m0, 34816
    s_nop 0
    buffer_load_dwordx4 v11, s[16:19], s51 offen lds
    s_mov_b32 m0, 38912
    s_nop 0
    buffer_load_dwordx4 v12, s[20:23], s50 offen lds
    s_mov_b32 m0, 43008
    s_nop 0
    buffer_load_dwordx4 v13, s[20:23], s50 offen lds
    s_waitcnt vmcnt(18)
    s_barrier
    s_waitcnt vmcnt(12)
    s_barrier
    s_waitcnt vmcnt(6)
    s_barrier
    s_waitcnt vmcnt(0)
    s_barrier
    s_branch Lend_23
Lld_29:
    v_add_u32 v6, 4, v5
    v_and_b32 v6, 7, v6
    v_xor_b32 v6, v6, v4
    v_add_u32 v7, s42, v3
    v_add_u32 v7, 8, v7
    v_lshlrev_b32 v7, 5, v7
    v_lshrrev_b32 v8, 1, v6
    v_mul_u32_u24 v8, 27648, v8
    v_add_u32 v7, v7, v8
    v_and_b32 v6, 1, v6
    v_lshl_add_u32 v8, v6, 4, v7
    v_add_u32 v6, 4, v5
    v_and_b32 v6, 7, v6
    v_xor_b32 v6, v6, v4
    v_add_u32 v7, s42, v3
    v_add_u32 v7, 40, v7
    v_lshlrev_b32 v7, 5, v7
    v_lshrrev_b32 v9, 1, v6
    v_mul_u32_u24 v9, 27648, v9
    v_add_u32 v7, v7, v9
    v_and_b32 v6, 1, v6
    v_lshl_add_u32 v9, v6, 4, v7
    v_add_u32 v6, 4, v5
    v_and_b32 v6, 7, v6
    v_xor_b32 v6, v6, v4
    v_add_u32 v7, s42, v3
    v_add_u32 v7, 72, v7
    v_lshlrev_b32 v7, 5, v7
    v_lshrrev_b32 v10, 1, v6
    v_mul_u32_u24 v10, 27648, v10
    v_add_u32 v7, v7, v10
    v_and_b32 v6, 1, v6
    v_lshl_add_u32 v10, v6, 4, v7
    v_add_u32 v6, 4, v5
    v_and_b32 v6, 7, v6
    v_xor_b32 v6, v6, v4
    v_add_u32 v7, s42, v3
    v_add_u32 v7, 104, v7
    v_lshlrev_b32 v7, 5, v7
    v_lshrrev_b32 v11, 1, v6
    v_mul_u32_u24 v11, 27648, v11
    v_add_u32 v7, v7, v11
    v_and_b32 v6, 1, v6
    v_lshl_add_u32 v11, v6, 4, v7
    v_add_u32 v6, 4, v5
    v_and_b32 v6, 7, v6
    v_xor_b32 v6, v6, v4
    v_add_u32 v7, s43, v3
    v_add_u32 v7, 24, v7
    s_mov_b32 s47, 4096
    v_mul_lo_u32 v7, v7, s47
    v_lshl_add_u32 v12, v6, 4, v7
    v_add_u32 v6, 4, v5
    v_and_b32 v6, 7, v6
    v_xor_b32 v6, v6, v4
    v_add_u32 v7, s43, v3
    v_add_u32 v7, 56, v7
    s_mov_b32 s47, 4096
    v_mul_lo_u32 v7, v7, s47
    v_lshl_add_u32 v13, v6, 4, v7
    s_mov_b32 s50, 0
    s_mov_b32 s51, 0
    s_mov_b32 m0, 1024
    s_nop 0
    buffer_load_dwordx4 v8, s[16:19], s51 offen lds
    s_mov_b32 m0, 5120
    s_nop 0
    buffer_load_dwordx4 v9, s[16:19], s51 offen lds
    s_mov_b32 m0, 9216
    s_nop 0
    buffer_load_dwordx4 v10, s[16:19], s51 offen lds
    s_mov_b32 m0, 13312
    s_nop 0
    buffer_load_dwordx4 v11, s[16:19], s51 offen lds
    s_mov_b32 m0, 17408
    s_nop 0
    buffer_load_dwordx4 v12, s[20:23], s50 offen lds
    s_mov_b32 m0, 21504
    s_nop 0
    buffer_load_dwordx4 v13, s[20:23], s50 offen lds
    s_mov_b32 s50, 128
    s_mov_b32 s51, 110592
    s_mov_b32 m0, 23552
    s_nop 0
    buffer_load_dwordx4 v8, s[16:19], s51 offen lds
    s_mov_b32 m0, 27648
    s_nop 0
    buffer_load_dwordx4 v9, s[16:19], s51 offen lds
    s_mov_b32 m0, 31744
    s_nop 0
    buffer_load_dwordx4 v10, s[16:19], s51 offen lds
    s_mov_b32 m0, 35840
    s_nop 0
    buffer_load_dwordx4 v11, s[16:19], s51 offen lds
    s_mov_b32 m0, 39936
    s_nop 0
    buffer_load_dwordx4 v12, s[20:23], s50 offen lds
    s_mov_b32 m0, 44032
    s_nop 0
    buffer_load_dwordx4 v13, s[20:23], s50 offen lds
    s_mov_b32 s50, 256
    s_mov_b32 s51, 221184
    s_mov_b32 m0, 46080
    s_nop 0
    buffer_load_dwordx4 v8, s[16:19], s51 offen lds
    s_mov_b32 m0, 50176
    s_nop 0
    buffer_load_dwordx4 v9, s[16:19], s51 offen lds
    s_mov_b32 m0, 54272
    s_nop 0
    buffer_load_dwordx4 v10, s[16:19], s51 offen lds
    s_mov_b32 m0, 58368
    s_nop 0
    buffer_load_dwordx4 v11, s[16:19], s51 offen lds
    s_mov_b32 m0, 62464
    s_nop 0
    buffer_load_dwordx4 v12, s[20:23], s50 offen lds
    s_mov_b32 m0, 66560
    s_nop 0
    buffer_load_dwordx4 v13, s[20:23], s50 offen lds
    s_mov_b32 s50, 384
    s_mov_b32 s51, 331776
    s_mov_b32 m0, 68608
    s_nop 0
    buffer_load_dwordx4 v8, s[16:19], s51 offen lds
    s_mov_b32 m0, 72704
    s_nop 0
    buffer_load_dwordx4 v9, s[16:19], s51 offen lds
    s_mov_b32 m0, 76800
    s_nop 0
    buffer_load_dwordx4 v10, s[16:19], s51 offen lds
    s_mov_b32 m0, 80896
    s_nop 0
    buffer_load_dwordx4 v11, s[16:19], s51 offen lds
    s_mov_b32 m0, 84992
    s_nop 0
    buffer_load_dwordx4 v12, s[20:23], s50 offen lds
    s_mov_b32 m0, 89088
    s_nop 0
    buffer_load_dwordx4 v13, s[20:23], s50 offen lds
    s_mov_b32 s50, 512
    s_mov_b32 s51, 442368
    s_mov_b32 m0, 91136
    s_nop 0
    buffer_load_dwordx4 v8, s[16:19], s51 offen lds
    s_mov_b32 m0, 95232
    s_nop 0
    buffer_load_dwordx4 v9, s[16:19], s51 offen lds
    s_mov_b32 m0, 99328
    s_nop 0
    buffer_load_dwordx4 v10, s[16:19], s51 offen lds
    s_mov_b32 m0, 103424
    s_nop 0
    buffer_load_dwordx4 v11, s[16:19], s51 offen lds
    s_mov_b32 m0, 107520
    s_nop 0
    buffer_load_dwordx4 v12, s[20:23], s50 offen lds
    s_mov_b32 m0, 111616
    s_nop 0
    buffer_load_dwordx4 v13, s[20:23], s50 offen lds
    s_waitcnt vmcnt(24)
    s_barrier
    s_waitcnt vmcnt(18)
    s_barrier
    s_mov_b32 s50, 640
    s_mov_b32 s51, 552960
    s_mov_b32 m0, 113664
    s_nop 0
    buffer_load_dwordx4 v8, s[16:19], s51 offen lds
    s_mov_b32 m0, 117760
    s_nop 0
    buffer_load_dwordx4 v9, s[16:19], s51 offen lds
    s_mov_b32 m0, 121856
    s_nop 0
    buffer_load_dwordx4 v10, s[16:19], s51 offen lds
    s_mov_b32 m0, 125952
    s_nop 0
    buffer_load_dwordx4 v11, s[16:19], s51 offen lds
    s_mov_b32 m0, 130048
    s_nop 0
    buffer_load_dwordx4 v12, s[20:23], s50 offen lds
    s_mov_b32 m0, 134144
    s_nop 0
    buffer_load_dwordx4 v13, s[20:23], s50 offen lds
    s_waitcnt vmcnt(18)
    s_barrier
    s_mov_b32 s50, 768
    s_mov_b32 s51, 663552
    s_mov_b32 m0, 1024
    s_nop 0
    buffer_load_dwordx4 v8, s[16:19], s51 offen lds
    s_mov_b32 m0, 5120
    s_nop 0
    buffer_load_dwordx4 v9, s[16:19], s51 offen lds
    s_mov_b32 m0, 9216
    s_nop 0
    buffer_load_dwordx4 v10, s[16:19], s51 offen lds
    s_mov_b32 m0, 13312
    s_nop 0
    buffer_load_dwordx4 v11, s[16:19], s51 offen lds
    s_mov_b32 m0, 17408
    s_nop 0
    buffer_load_dwordx4 v12, s[20:23], s50 offen lds
    s_mov_b32 m0, 21504
    s_nop 0
    buffer_load_dwordx4 v13, s[20:23], s50 offen lds
    s_waitcnt vmcnt(18)
    s_barrier
    s_mov_b32 s50, 896
    s_mov_b32 s51, 774144
    s_mov_b32 m0, 23552
    s_nop 0
    buffer_load_dwordx4 v8, s[16:19], s51 offen lds
    s_mov_b32 m0, 27648
    s_nop 0
    buffer_load_dwordx4 v9, s[16:19], s51 offen lds
    s_mov_b32 m0, 31744
    s_nop 0
    buffer_load_dwordx4 v10, s[16:19], s51 offen lds
    s_mov_b32 m0, 35840
    s_nop 0
    buffer_load_dwordx4 v11, s[16:19], s51 offen lds
    s_mov_b32 m0, 39936
    s_nop 0
    buffer_load_dwordx4 v12, s[20:23], s50 offen lds
    s_mov_b32 m0, 44032
    s_nop 0
    buffer_load_dwordx4 v13, s[20:23], s50 offen lds
    s_waitcnt vmcnt(18)
    s_barrier
    s_mov_b32 s50, 1024
    s_mov_b32 s51, 884736
    s_mov_b32 m0, 46080
    s_nop 0
    buffer_load_dwordx4 v8, s[16:19], s51 offen lds
    s_mov_b32 m0, 50176
    s_nop 0
    buffer_load_dwordx4 v9, s[16:19], s51 offen lds
    s_mov_b32 m0, 54272
    s_nop 0
    buffer_load_dwordx4 v10, s[16:19], s51 offen lds
    s_mov_b32 m0, 58368
    s_nop 0
    buffer_load_dwordx4 v11, s[16:19], s51 offen lds
    s_mov_b32 m0, 62464
    s_nop 0
    buffer_load_dwordx4 v12, s[20:23], s50 offen lds
    s_mov_b32 m0, 66560
    s_nop 0
    buffer_load_dwordx4 v13, s[20:23], s50 offen lds
    s_waitcnt vmcnt(18)
    s_barrier
    s_mov_b32 s50, 1152
    s_mov_b32 s51, 995328
    s_mov_b32 m0, 68608
    s_nop 0
    buffer_load_dwordx4 v8, s[16:19], s51 offen lds
    s_mov_b32 m0, 72704
    s_nop 0
    buffer_load_dwordx4 v9, s[16:19], s51 offen lds
    s_mov_b32 m0, 76800
    s_nop 0
    buffer_load_dwordx4 v10, s[16:19], s51 offen lds
    s_mov_b32 m0, 80896
    s_nop 0
    buffer_load_dwordx4 v11, s[16:19], s51 offen lds
    s_mov_b32 m0, 84992
    s_nop 0
    buffer_load_dwordx4 v12, s[20:23], s50 offen lds
    s_mov_b32 m0, 89088
    s_nop 0
    buffer_load_dwordx4 v13, s[20:23], s50 offen lds
    s_waitcnt vmcnt(18)
    s_barrier
    s_mov_b32 s50, 1280
    s_mov_b32 s51, 1105920
    s_mov_b32 m0, 91136
    s_nop 0
    buffer_load_dwordx4 v8, s[16:19], s51 offen lds
    s_mov_b32 m0, 95232
    s_nop 0
    buffer_load_dwordx4 v9, s[16:19], s51 offen lds
    s_mov_b32 m0, 99328
    s_nop 0
    buffer_load_dwordx4 v10, s[16:19], s51 offen lds
    s_mov_b32 m0, 103424
    s_nop 0
    buffer_load_dwordx4 v11, s[16:19], s51 offen lds
    s_mov_b32 m0, 107520
    s_nop 0
    buffer_load_dwordx4 v12, s[20:23], s50 offen lds
    s_mov_b32 m0, 111616
    s_nop 0
    buffer_load_dwordx4 v13, s[20:23], s50 offen lds
    s_waitcnt vmcnt(18)
    s_barrier
    s_mov_b32 s50, 1408
    s_mov_b32 s51, 1216512
    s_mov_b32 m0, 113664
    s_nop 0
    buffer_load_dwordx4 v8, s[16:19], s51 offen lds
    s_mov_b32 m0, 117760
    s_nop 0
    buffer_load_dwordx4 v9, s[16:19], s51 offen lds
    s_mov_b32 m0, 121856
    s_nop 0
    buffer_load_dwordx4 v10, s[16:19], s51 offen lds
    s_mov_b32 m0, 125952
    s_nop 0
    buffer_load_dwordx4 v11, s[16:19], s51 offen lds
    s_mov_b32 m0, 130048
    s_nop 0
    buffer_load_dwordx4 v12, s[20:23], s50 offen lds
    s_mov_b32 m0, 134144
    s_nop 0
    buffer_load_dwordx4 v13, s[20:23], s50 offen lds
    s_waitcnt vmcnt(18)
    s_barrier
    s_mov_b32 s50, 1536
    s_mov_b32 s51, 1327104
    s_mov_b32 m0, 1024
    s_nop 0
    buffer_load_dwordx4 v8, s[16:19], s51 offen lds
    s_mov_b32 m0, 5120
    s_nop 0
    buffer_load_dwordx4 v9, s[16:19], s51 offen lds
    s_mov_b32 m0, 9216
    s_nop 0
    buffer_load_dwordx4 v10, s[16:19], s51 offen lds
    s_mov_b32 m0, 13312
    s_nop 0
    buffer_load_dwordx4 v11, s[16:19], s51 offen lds
    s_mov_b32 m0, 17408
    s_nop 0
    buffer_load_dwordx4 v12, s[20:23], s50 offen lds
    s_mov_b32 m0, 21504
    s_nop 0
    buffer_load_dwordx4 v13, s[20:23], s50 offen lds
    s_waitcnt vmcnt(18)
    s_barrier
    s_mov_b32 s50, 1664
    s_mov_b32 s51, 1437696
    s_mov_b32 m0, 23552
    s_nop 0
    buffer_load_dwordx4 v8, s[16:19], s51 offen lds
    s_mov_b32 m0, 27648
    s_nop 0
    buffer_load_dwordx4 v9, s[16:19], s51 offen lds
    s_mov_b32 m0, 31744
    s_nop 0
    buffer_load_dwordx4 v10, s[16:19], s51 offen lds
    s_mov_b32 m0, 35840
    s_nop 0
    buffer_load_dwordx4 v11, s[16:19], s51 offen lds
    s_mov_b32 m0, 39936
    s_nop 0
    buffer_load_dwordx4 v12, s[20:23], s50 offen lds
    s_mov_b32 m0, 44032
    s_nop 0
    buffer_load_dwordx4 v13, s[20:23], s50 offen lds
    s_waitcnt vmcnt(18)
    s_barrier
    s_mov_b32 s50, 1792
    s_mov_b32 s51, 1548288
    s_mov_b32 m0, 46080
    s_nop 0
    buffer_load_dwordx4 v8, s[16:19], s51 offen lds
    s_mov_b32 m0, 50176
    s_nop 0
    buffer_load_dwordx4 v9, s[16:19], s51 offen lds
    s_mov_b32 m0, 54272
    s_nop 0
    buffer_load_dwordx4 v10, s[16:19], s51 offen lds
    s_mov_b32 m0, 58368
    s_nop 0
    buffer_load_dwordx4 v11, s[16:19], s51 offen lds
    s_mov_b32 m0, 62464
    s_nop 0
    buffer_load_dwordx4 v12, s[20:23], s50 offen lds
    s_mov_b32 m0, 66560
    s_nop 0
    buffer_load_dwordx4 v13, s[20:23], s50 offen lds
    s_waitcnt vmcnt(18)
    s_barrier
    s_mov_b32 s50, 1920
    s_mov_b32 s51, 1658880
    s_mov_b32 m0, 68608
    s_nop 0
    buffer_load_dwordx4 v8, s[16:19], s51 offen lds
    s_mov_b32 m0, 72704
    s_nop 0
    buffer_load_dwordx4 v9, s[16:19], s51 offen lds
    s_mov_b32 m0, 76800
    s_nop 0
    buffer_load_dwordx4 v10, s[16:19], s51 offen lds
    s_mov_b32 m0, 80896
    s_nop 0
    buffer_load_dwordx4 v11, s[16:19], s51 offen lds
    s_mov_b32 m0, 84992
    s_nop 0
    buffer_load_dwordx4 v12, s[20:23], s50 offen lds
    s_mov_b32 m0, 89088
    s_nop 0
    buffer_load_dwordx4 v13, s[20:23], s50 offen lds
    s_waitcnt vmcnt(18)
    s_barrier
    s_mov_b32 s50, 2048
    s_mov_b32 s51, 1769472
    s_mov_b32 m0, 91136
    s_nop 0
    buffer_load_dwordx4 v8, s[16:19], s51 offen lds
    s_mov_b32 m0, 95232
    s_nop 0
    buffer_load_dwordx4 v9, s[16:19], s51 offen lds
    s_mov_b32 m0, 99328
    s_nop 0
    buffer_load_dwordx4 v10, s[16:19], s51 offen lds
    s_mov_b32 m0, 103424
    s_nop 0
    buffer_load_dwordx4 v11, s[16:19], s51 offen lds
    s_mov_b32 m0, 107520
    s_nop 0
    buffer_load_dwordx4 v12, s[20:23], s50 offen lds
    s_mov_b32 m0, 111616
    s_nop 0
    buffer_load_dwordx4 v13, s[20:23], s50 offen lds
    s_waitcnt vmcnt(18)
    s_barrier
    s_mov_b32 s50, 2176
    s_mov_b32 s51, 1880064
    s_mov_b32 m0, 113664
    s_nop 0
    buffer_load_dwordx4 v8, s[16:19], s51 offen lds
    s_mov_b32 m0, 117760
    s_nop 0
    buffer_load_dwordx4 v9, s[16:19], s51 offen lds
    s_mov_b32 m0, 121856
    s_nop 0
    buffer_load_dwordx4 v10, s[16:19], s51 offen lds
    s_mov_b32 m0, 125952
    s_nop 0
    buffer_load_dwordx4 v11, s[16:19], s51 offen lds
    s_mov_b32 m0, 130048
    s_nop 0
    buffer_load_dwordx4 v12, s[20:23], s50 offen lds
    s_mov_b32 m0, 134144
    s_nop 0
    buffer_load_dwordx4 v13, s[20:23], s50 offen lds
    s_waitcnt vmcnt(18)
    s_barrier
    s_mov_b32 s50, 2304
    s_mov_b32 s51, 1990656
    s_mov_b32 m0, 1024
    s_nop 0
    buffer_load_dwordx4 v8, s[16:19], s51 offen lds
    s_mov_b32 m0, 5120
    s_nop 0
    buffer_load_dwordx4 v9, s[16:19], s51 offen lds
    s_mov_b32 m0, 9216
    s_nop 0
    buffer_load_dwordx4 v10, s[16:19], s51 offen lds
    s_mov_b32 m0, 13312
    s_nop 0
    buffer_load_dwordx4 v11, s[16:19], s51 offen lds
    s_mov_b32 m0, 17408
    s_nop 0
    buffer_load_dwordx4 v12, s[20:23], s50 offen lds
    s_mov_b32 m0, 21504
    s_nop 0
    buffer_load_dwordx4 v13, s[20:23], s50 offen lds
    s_waitcnt vmcnt(18)
    s_barrier
    s_mov_b32 s50, 2432
    s_mov_b32 s51, 2101248
    s_mov_b32 m0, 23552
    s_nop 0
    buffer_load_dwordx4 v8, s[16:19], s51 offen lds
    s_mov_b32 m0, 27648
    s_nop 0
    buffer_load_dwordx4 v9, s[16:19], s51 offen lds
    s_mov_b32 m0, 31744
    s_nop 0
    buffer_load_dwordx4 v10, s[16:19], s51 offen lds
    s_mov_b32 m0, 35840
    s_nop 0
    buffer_load_dwordx4 v11, s[16:19], s51 offen lds
    s_mov_b32 m0, 39936
    s_nop 0
    buffer_load_dwordx4 v12, s[20:23], s50 offen lds
    s_mov_b32 m0, 44032
    s_nop 0
    buffer_load_dwordx4 v13, s[20:23], s50 offen lds
    s_waitcnt vmcnt(18)
    s_barrier
    s_mov_b32 s50, 2560
    s_mov_b32 s51, 2211840
    s_mov_b32 m0, 46080
    s_nop 0
    buffer_load_dwordx4 v8, s[16:19], s51 offen lds
    s_mov_b32 m0, 50176
    s_nop 0
    buffer_load_dwordx4 v9, s[16:19], s51 offen lds
    s_mov_b32 m0, 54272
    s_nop 0
    buffer_load_dwordx4 v10, s[16:19], s51 offen lds
    s_mov_b32 m0, 58368
    s_nop 0
    buffer_load_dwordx4 v11, s[16:19], s51 offen lds
    s_mov_b32 m0, 62464
    s_nop 0
    buffer_load_dwordx4 v12, s[20:23], s50 offen lds
    s_mov_b32 m0, 66560
    s_nop 0
    buffer_load_dwordx4 v13, s[20:23], s50 offen lds
    s_waitcnt vmcnt(18)
    s_barrier
    s_mov_b32 s50, 2688
    s_mov_b32 s51, 2322432
    s_mov_b32 m0, 68608
    s_nop 0
    buffer_load_dwordx4 v8, s[16:19], s51 offen lds
    s_mov_b32 m0, 72704
    s_nop 0
    buffer_load_dwordx4 v9, s[16:19], s51 offen lds
    s_mov_b32 m0, 76800
    s_nop 0
    buffer_load_dwordx4 v10, s[16:19], s51 offen lds
    s_mov_b32 m0, 80896
    s_nop 0
    buffer_load_dwordx4 v11, s[16:19], s51 offen lds
    s_mov_b32 m0, 84992
    s_nop 0
    buffer_load_dwordx4 v12, s[20:23], s50 offen lds
    s_mov_b32 m0, 89088
    s_nop 0
    buffer_load_dwordx4 v13, s[20:23], s50 offen lds
    s_waitcnt vmcnt(18)
    s_barrier
    s_mov_b32 s50, 2816
    s_mov_b32 s51, 2433024
    s_mov_b32 m0, 91136
    s_nop 0
    buffer_load_dwordx4 v8, s[16:19], s51 offen lds
    s_mov_b32 m0, 95232
    s_nop 0
    buffer_load_dwordx4 v9, s[16:19], s51 offen lds
    s_mov_b32 m0, 99328
    s_nop 0
    buffer_load_dwordx4 v10, s[16:19], s51 offen lds
    s_mov_b32 m0, 103424
    s_nop 0
    buffer_load_dwordx4 v11, s[16:19], s51 offen lds
    s_mov_b32 m0, 107520
    s_nop 0
    buffer_load_dwordx4 v12, s[20:23], s50 offen lds
    s_mov_b32 m0, 111616
    s_nop 0
    buffer_load_dwordx4 v13, s[20:23], s50 offen lds
    s_waitcnt vmcnt(18)
    s_barrier
    s_mov_b32 s50, 2944
    s_mov_b32 s51, 2543616
    s_mov_b32 m0, 113664
    s_nop 0
    buffer_load_dwordx4 v8, s[16:19], s51 offen lds
    s_mov_b32 m0, 117760
    s_nop 0
    buffer_load_dwordx4 v9, s[16:19], s51 offen lds
    s_mov_b32 m0, 121856
    s_nop 0
    buffer_load_dwordx4 v10, s[16:19], s51 offen lds
    s_mov_b32 m0, 125952
    s_nop 0
    buffer_load_dwordx4 v11, s[16:19], s51 offen lds
    s_mov_b32 m0, 130048
    s_nop 0
    buffer_load_dwordx4 v12, s[20:23], s50 offen lds
    s_mov_b32 m0, 134144
    s_nop 0
    buffer_load_dwordx4 v13, s[20:23], s50 offen lds
    s_waitcnt vmcnt(18)
    s_barrier
    s_mov_b32 s50, 3072
    s_mov_b32 s51, 2654208
    s_mov_b32 m0, 1024
    s_nop 0
    buffer_load_dwordx4 v8, s[16:19], s51 offen lds
    s_mov_b32 m0, 5120
    s_nop 0
    buffer_load_dwordx4 v9, s[16:19], s51 offen lds
    s_mov_b32 m0, 9216
    s_nop 0
    buffer_load_dwordx4 v10, s[16:19], s51 offen lds
    s_mov_b32 m0, 13312
    s_nop 0
    buffer_load_dwordx4 v11, s[16:19], s51 offen lds
    s_mov_b32 m0, 17408
    s_nop 0
    buffer_load_dwordx4 v12, s[20:23], s50 offen lds
    s_mov_b32 m0, 21504
    s_nop 0
    buffer_load_dwordx4 v13, s[20:23], s50 offen lds
    s_waitcnt vmcnt(18)
    s_barrier
    s_mov_b32 s50, 3200
    s_mov_b32 s51, 2764800
    s_mov_b32 m0, 23552
    s_nop 0
    buffer_load_dwordx4 v8, s[16:19], s51 offen lds
    s_mov_b32 m0, 27648
    s_nop 0
    buffer_load_dwordx4 v9, s[16:19], s51 offen lds
    s_mov_b32 m0, 31744
    s_nop 0
    buffer_load_dwordx4 v10, s[16:19], s51 offen lds
    s_mov_b32 m0, 35840
    s_nop 0
    buffer_load_dwordx4 v11, s[16:19], s51 offen lds
    s_mov_b32 m0, 39936
    s_nop 0
    buffer_load_dwordx4 v12, s[20:23], s50 offen lds
    s_mov_b32 m0, 44032
    s_nop 0
    buffer_load_dwordx4 v13, s[20:23], s50 offen lds
    s_waitcnt vmcnt(18)
    s_barrier
    s_mov_b32 s50, 3328
    s_mov_b32 s51, 2875392
    s_mov_b32 m0, 46080
    s_nop 0
    buffer_load_dwordx4 v8, s[16:19], s51 offen lds
    s_mov_b32 m0, 50176
    s_nop 0
    buffer_load_dwordx4 v9, s[16:19], s51 offen lds
    s_mov_b32 m0, 54272
    s_nop 0
    buffer_load_dwordx4 v10, s[16:19], s51 offen lds
    s_mov_b32 m0, 58368
    s_nop 0
    buffer_load_dwordx4 v11, s[16:19], s51 offen lds
    s_mov_b32 m0, 62464
    s_nop 0
    buffer_load_dwordx4 v12, s[20:23], s50 offen lds
    s_mov_b32 m0, 66560
    s_nop 0
    buffer_load_dwordx4 v13, s[20:23], s50 offen lds
    s_waitcnt vmcnt(18)
    s_barrier
    s_mov_b32 s50, 3456
    s_mov_b32 s51, 2985984
    s_mov_b32 m0, 68608
    s_nop 0
    buffer_load_dwordx4 v8, s[16:19], s51 offen lds
    s_mov_b32 m0, 72704
    s_nop 0
    buffer_load_dwordx4 v9, s[16:19], s51 offen lds
    s_mov_b32 m0, 76800
    s_nop 0
    buffer_load_dwordx4 v10, s[16:19], s51 offen lds
    s_mov_b32 m0, 80896
    s_nop 0
    buffer_load_dwordx4 v11, s[16:19], s51 offen lds
    s_mov_b32 m0, 84992
    s_nop 0
    buffer_load_dwordx4 v12, s[20:23], s50 offen lds
    s_mov_b32 m0, 89088
    s_nop 0
    buffer_load_dwordx4 v13, s[20:23], s50 offen lds
    s_waitcnt vmcnt(18)
    s_barrier
    s_mov_b32 s50, 3584
    s_mov_b32 s51, 3096576
    s_mov_b32 m0, 91136
    s_nop 0
    buffer_load_dwordx4 v8, s[16:19], s51 offen lds
    s_mov_b32 m0, 95232
    s_nop 0
    buffer_load_dwordx4 v9, s[16:19], s51 offen lds
    s_mov_b32 m0, 99328
    s_nop 0
    buffer_load_dwordx4 v10, s[16:19], s51 offen lds
    s_mov_b32 m0, 103424
    s_nop 0
    buffer_load_dwordx4 v11, s[16:19], s51 offen lds
    s_mov_b32 m0, 107520
    s_nop 0
    buffer_load_dwordx4 v12, s[20:23], s50 offen lds
    s_mov_b32 m0, 111616
    s_nop 0
    buffer_load_dwordx4 v13, s[20:23], s50 offen lds
    s_waitcnt vmcnt(18)
    s_barrier
    s_mov_b32 s50, 3712
    s_mov_b32 s51, 3207168
    s_mov_b32 m0, 113664
    s_nop 0
    buffer_load_dwordx4 v8, s[16:19], s51 offen lds
    s_mov_b32 m0, 117760
    s_nop 0
    buffer_load_dwordx4 v9, s[16:19], s51 offen lds
    s_mov_b32 m0, 121856
    s_nop 0
    buffer_load_dwordx4 v10, s[16:19], s51 offen lds
    s_mov_b32 m0, 125952
    s_nop 0
    buffer_load_dwordx4 v11, s[16:19], s51 offen lds
    s_mov_b32 m0, 130048
    s_nop 0
    buffer_load_dwordx4 v12, s[20:23], s50 offen lds
    s_mov_b32 m0, 134144
    s_nop 0
    buffer_load_dwordx4 v13, s[20:23], s50 offen lds
    s_waitcnt vmcnt(18)
    s_barrier
    s_mov_b32 s50, 3840
    s_mov_b32 s51, 3317760
    s_mov_b32 m0, 1024
    s_nop 0
    buffer_load_dwordx4 v8, s[16:19], s51 offen lds
    s_mov_b32 m0, 5120
    s_nop 0
    buffer_load_dwordx4 v9, s[16:19], s51 offen lds
    s_mov_b32 m0, 9216
    s_nop 0
    buffer_load_dwordx4 v10, s[16:19], s51 offen lds
    s_mov_b32 m0, 13312
    s_nop 0
    buffer_load_dwordx4 v11, s[16:19], s51 offen lds
    s_mov_b32 m0, 17408
    s_nop 0
    buffer_load_dwordx4 v12, s[20:23], s50 offen lds
    s_mov_b32 m0, 21504
    s_nop 0
    buffer_load_dwordx4 v13, s[20:23], s50 offen lds
    s_waitcnt vmcnt(18)
    s_barrier
    s_mov_b32 s50, 3968
    s_mov_b32 s51, 3428352
    s_mov_b32 m0, 23552
    s_nop 0
    buffer_load_dwordx4 v8, s[16:19], s51 offen lds
    s_mov_b32 m0, 27648
    s_nop 0
    buffer_load_dwordx4 v9, s[16:19], s51 offen lds
    s_mov_b32 m0, 31744
    s_nop 0
    buffer_load_dwordx4 v10, s[16:19], s51 offen lds
    s_mov_b32 m0, 35840
    s_nop 0
    buffer_load_dwordx4 v11, s[16:19], s51 offen lds
    s_mov_b32 m0, 39936
    s_nop 0
    buffer_load_dwordx4 v12, s[20:23], s50 offen lds
    s_mov_b32 m0, 44032
    s_nop 0
    buffer_load_dwordx4 v13, s[20:23], s50 offen lds
    s_waitcnt vmcnt(18)
    s_barrier
    s_waitcnt vmcnt(12)
    s_barrier
    s_waitcnt vmcnt(6)
    s_barrier
    s_waitcnt vmcnt(0)
    s_barrier
    s_branch Lend_23
Lld_30:
    v_add_u32 v6, 0, v5
    v_and_b32 v6, 7, v6
    v_xor_b32 v6, v6, v4
    v_add_u32 v7, s42, v3
    v_add_u32 v7, 16, v7
    v_lshlrev_b32 v7, 5, v7
    v_lshrrev_b32 v8, 1, v6
    v_mul_u32_u24 v8, 27648, v8
    v_add_u32 v7, v7, v8
    v_and_b32 v6, 1, v6
    v_lshl_add_u32 v8, v6, 4, v7
    v_add_u32 v6, 0, v5
    v_and_b32 v6, 7, v6
    v_xor_b32 v6, v6, v4
    v_add_u32 v7, s42, v3
    v_add_u32 v7, 48, v7
    v_lshlrev_b32 v7, 5, v7
    v_lshrrev_b32 v9, 1, v6
    v_mul_u32_u24 v9, 27648, v9
    v_add_u32 v7, v7, v9
    v_and_b32 v6, 1, v6
    v_lshl_add_u32 v9, v6, 4, v7
    v_add_u32 v6, 0, v5
    v_and_b32 v6, 7, v6
    v_xor_b32 v6, v6, v4
    v_add_u32 v7, s42, v3
    v_add_u32 v7, 80, v7
    v_lshlrev_b32 v7, 5, v7
    v_lshrrev_b32 v10, 1, v6
    v_mul_u32_u24 v10, 27648, v10
    v_add_u32 v7, v7, v10
    v_and_b32 v6, 1, v6
    v_lshl_add_u32 v10, v6, 4, v7
    v_add_u32 v6, 0, v5
    v_and_b32 v6, 7, v6
    v_xor_b32 v6, v6, v4
    v_add_u32 v7, s43, v3
    s_mov_b32 s47, 4096
    v_mul_lo_u32 v7, v7, s47
    v_lshl_add_u32 v11, v6, 4, v7
    v_add_u32 v6, 0, v5
    v_and_b32 v6, 7, v6
    v_xor_b32 v6, v6, v4
    v_add_u32 v7, s43, v3
    v_add_u32 v7, 32, v7
    s_mov_b32 s47, 4096
    v_mul_lo_u32 v7, v7, s47
    v_lshl_add_u32 v12, v6, 4, v7
    s_mov_b32 s50, 0
    s_mov_b32 s51, 0
    s_mov_b32 m0, 2048
    s_nop 0
    buffer_load_dwordx4 v8, s[16:19], s51 offen lds
    s_mov_b32 m0, 6144
    s_nop 0
    buffer_load_dwordx4 v9, s[16:19], s51 offen lds
    s_mov_b32 m0, 10240
    s_nop 0
    buffer_load_dwordx4 v10, s[16:19], s51 offen lds
    s_mov_b32 m0, 14336
    s_nop 0
    buffer_load_dwordx4 v11, s[20:23], s50 offen lds
    s_mov_b32 m0, 18432
    s_nop 0
    buffer_load_dwordx4 v12, s[20:23], s50 offen lds
    s_mov_b32 s50, 128
    s_mov_b32 s51, 110592
    s_mov_b32 m0, 24576
    s_nop 0
    buffer_load_dwordx4 v8, s[16:19], s51 offen lds
    s_mov_b32 m0, 28672
    s_nop 0
    buffer_load_dwordx4 v9, s[16:19], s51 offen lds
    s_mov_b32 m0, 32768
    s_nop 0
    buffer_load_dwordx4 v10, s[16:19], s51 offen lds
    s_mov_b32 m0, 36864
    s_nop 0
    buffer_load_dwordx4 v11, s[20:23], s50 offen lds
    s_mov_b32 m0, 40960
    s_nop 0
    buffer_load_dwordx4 v12, s[20:23], s50 offen lds
    s_mov_b32 s50, 256
    s_mov_b32 s51, 221184
    s_mov_b32 m0, 47104
    s_nop 0
    buffer_load_dwordx4 v8, s[16:19], s51 offen lds
    s_mov_b32 m0, 51200
    s_nop 0
    buffer_load_dwordx4 v9, s[16:19], s51 offen lds
    s_mov_b32 m0, 55296
    s_nop 0
    buffer_load_dwordx4 v10, s[16:19], s51 offen lds
    s_mov_b32 m0, 59392
    s_nop 0
    buffer_load_dwordx4 v11, s[20:23], s50 offen lds
    s_mov_b32 m0, 63488
    s_nop 0
    buffer_load_dwordx4 v12, s[20:23], s50 offen lds
    s_mov_b32 s50, 384
    s_mov_b32 s51, 331776
    s_mov_b32 m0, 69632
    s_nop 0
    buffer_load_dwordx4 v8, s[16:19], s51 offen lds
    s_mov_b32 m0, 73728
    s_nop 0
    buffer_load_dwordx4 v9, s[16:19], s51 offen lds
    s_mov_b32 m0, 77824
    s_nop 0
    buffer_load_dwordx4 v10, s[16:19], s51 offen lds
    s_mov_b32 m0, 81920
    s_nop 0
    buffer_load_dwordx4 v11, s[20:23], s50 offen lds
    s_mov_b32 m0, 86016
    s_nop 0
    buffer_load_dwordx4 v12, s[20:23], s50 offen lds
    s_mov_b32 s50, 512
    s_mov_b32 s51, 442368
    s_mov_b32 m0, 92160
    s_nop 0
    buffer_load_dwordx4 v8, s[16:19], s51 offen lds
    s_mov_b32 m0, 96256
    s_nop 0
    buffer_load_dwordx4 v9, s[16:19], s51 offen lds
    s_mov_b32 m0, 100352
    s_nop 0
    buffer_load_dwordx4 v10, s[16:19], s51 offen lds
    s_mov_b32 m0, 104448
    s_nop 0
    buffer_load_dwordx4 v11, s[20:23], s50 offen lds
    s_mov_b32 m0, 108544
    s_nop 0
    buffer_load_dwordx4 v12, s[20:23], s50 offen lds
    s_waitcnt vmcnt(20)
    s_barrier
    s_waitcnt vmcnt(15)
    s_barrier
    s_mov_b32 s50, 640
    s_mov_b32 s51, 552960
    s_mov_b32 m0, 114688
    s_nop 0
    buffer_load_dwordx4 v8, s[16:19], s51 offen lds
    s_mov_b32 m0, 118784
    s_nop 0
    buffer_load_dwordx4 v9, s[16:19], s51 offen lds
    s_mov_b32 m0, 122880
    s_nop 0
    buffer_load_dwordx4 v10, s[16:19], s51 offen lds
    s_mov_b32 m0, 126976
    s_nop 0
    buffer_load_dwordx4 v11, s[20:23], s50 offen lds
    s_mov_b32 m0, 131072
    s_nop 0
    buffer_load_dwordx4 v12, s[20:23], s50 offen lds
    s_waitcnt vmcnt(15)
    s_barrier
    s_mov_b32 s50, 768
    s_mov_b32 s51, 663552
    s_mov_b32 m0, 2048
    s_nop 0
    buffer_load_dwordx4 v8, s[16:19], s51 offen lds
    s_mov_b32 m0, 6144
    s_nop 0
    buffer_load_dwordx4 v9, s[16:19], s51 offen lds
    s_mov_b32 m0, 10240
    s_nop 0
    buffer_load_dwordx4 v10, s[16:19], s51 offen lds
    s_mov_b32 m0, 14336
    s_nop 0
    buffer_load_dwordx4 v11, s[20:23], s50 offen lds
    s_mov_b32 m0, 18432
    s_nop 0
    buffer_load_dwordx4 v12, s[20:23], s50 offen lds
    s_waitcnt vmcnt(15)
    s_barrier
    s_mov_b32 s50, 896
    s_mov_b32 s51, 774144
    s_mov_b32 m0, 24576
    s_nop 0
    buffer_load_dwordx4 v8, s[16:19], s51 offen lds
    s_mov_b32 m0, 28672
    s_nop 0
    buffer_load_dwordx4 v9, s[16:19], s51 offen lds
    s_mov_b32 m0, 32768
    s_nop 0
    buffer_load_dwordx4 v10, s[16:19], s51 offen lds
    s_mov_b32 m0, 36864
    s_nop 0
    buffer_load_dwordx4 v11, s[20:23], s50 offen lds
    s_mov_b32 m0, 40960
    s_nop 0
    buffer_load_dwordx4 v12, s[20:23], s50 offen lds
    s_waitcnt vmcnt(15)
    s_barrier
    s_mov_b32 s50, 1024
    s_mov_b32 s51, 884736
    s_mov_b32 m0, 47104
    s_nop 0
    buffer_load_dwordx4 v8, s[16:19], s51 offen lds
    s_mov_b32 m0, 51200
    s_nop 0
    buffer_load_dwordx4 v9, s[16:19], s51 offen lds
    s_mov_b32 m0, 55296
    s_nop 0
    buffer_load_dwordx4 v10, s[16:19], s51 offen lds
    s_mov_b32 m0, 59392
    s_nop 0
    buffer_load_dwordx4 v11, s[20:23], s50 offen lds
    s_mov_b32 m0, 63488
    s_nop 0
    buffer_load_dwordx4 v12, s[20:23], s50 offen lds
    s_waitcnt vmcnt(15)
    s_barrier
    s_mov_b32 s50, 1152
    s_mov_b32 s51, 995328
    s_mov_b32 m0, 69632
    s_nop 0
    buffer_load_dwordx4 v8, s[16:19], s51 offen lds
    s_mov_b32 m0, 73728
    s_nop 0
    buffer_load_dwordx4 v9, s[16:19], s51 offen lds
    s_mov_b32 m0, 77824
    s_nop 0
    buffer_load_dwordx4 v10, s[16:19], s51 offen lds
    s_mov_b32 m0, 81920
    s_nop 0
    buffer_load_dwordx4 v11, s[20:23], s50 offen lds
    s_mov_b32 m0, 86016
    s_nop 0
    buffer_load_dwordx4 v12, s[20:23], s50 offen lds
    s_waitcnt vmcnt(15)
    s_barrier
    s_mov_b32 s50, 1280
    s_mov_b32 s51, 1105920
    s_mov_b32 m0, 92160
    s_nop 0
    buffer_load_dwordx4 v8, s[16:19], s51 offen lds
    s_mov_b32 m0, 96256
    s_nop 0
    buffer_load_dwordx4 v9, s[16:19], s51 offen lds
    s_mov_b32 m0, 100352
    s_nop 0
    buffer_load_dwordx4 v10, s[16:19], s51 offen lds
    s_mov_b32 m0, 104448
    s_nop 0
    buffer_load_dwordx4 v11, s[20:23], s50 offen lds
    s_mov_b32 m0, 108544
    s_nop 0
    buffer_load_dwordx4 v12, s[20:23], s50 offen lds
    s_waitcnt vmcnt(15)
    s_barrier
    s_mov_b32 s50, 1408
    s_mov_b32 s51, 1216512
    s_mov_b32 m0, 114688
    s_nop 0
    buffer_load_dwordx4 v8, s[16:19], s51 offen lds
    s_mov_b32 m0, 118784
    s_nop 0
    buffer_load_dwordx4 v9, s[16:19], s51 offen lds
    s_mov_b32 m0, 122880
    s_nop 0
    buffer_load_dwordx4 v10, s[16:19], s51 offen lds
    s_mov_b32 m0, 126976
    s_nop 0
    buffer_load_dwordx4 v11, s[20:23], s50 offen lds
    s_mov_b32 m0, 131072
    s_nop 0
    buffer_load_dwordx4 v12, s[20:23], s50 offen lds
    s_waitcnt vmcnt(15)
    s_barrier
    s_mov_b32 s50, 1536
    s_mov_b32 s51, 1327104
    s_mov_b32 m0, 2048
    s_nop 0
    buffer_load_dwordx4 v8, s[16:19], s51 offen lds
    s_mov_b32 m0, 6144
    s_nop 0
    buffer_load_dwordx4 v9, s[16:19], s51 offen lds
    s_mov_b32 m0, 10240
    s_nop 0
    buffer_load_dwordx4 v10, s[16:19], s51 offen lds
    s_mov_b32 m0, 14336
    s_nop 0
    buffer_load_dwordx4 v11, s[20:23], s50 offen lds
    s_mov_b32 m0, 18432
    s_nop 0
    buffer_load_dwordx4 v12, s[20:23], s50 offen lds
    s_waitcnt vmcnt(15)
    s_barrier
    s_mov_b32 s50, 1664
    s_mov_b32 s51, 1437696
    s_mov_b32 m0, 24576
    s_nop 0
    buffer_load_dwordx4 v8, s[16:19], s51 offen lds
    s_mov_b32 m0, 28672
    s_nop 0
    buffer_load_dwordx4 v9, s[16:19], s51 offen lds
    s_mov_b32 m0, 32768
    s_nop 0
    buffer_load_dwordx4 v10, s[16:19], s51 offen lds
    s_mov_b32 m0, 36864
    s_nop 0
    buffer_load_dwordx4 v11, s[20:23], s50 offen lds
    s_mov_b32 m0, 40960
    s_nop 0
    buffer_load_dwordx4 v12, s[20:23], s50 offen lds
    s_waitcnt vmcnt(15)
    s_barrier
    s_mov_b32 s50, 1792
    s_mov_b32 s51, 1548288
    s_mov_b32 m0, 47104
    s_nop 0
    buffer_load_dwordx4 v8, s[16:19], s51 offen lds
    s_mov_b32 m0, 51200
    s_nop 0
    buffer_load_dwordx4 v9, s[16:19], s51 offen lds
    s_mov_b32 m0, 55296
    s_nop 0
    buffer_load_dwordx4 v10, s[16:19], s51 offen lds
    s_mov_b32 m0, 59392
    s_nop 0
    buffer_load_dwordx4 v11, s[20:23], s50 offen lds
    s_mov_b32 m0, 63488
    s_nop 0
    buffer_load_dwordx4 v12, s[20:23], s50 offen lds
    s_waitcnt vmcnt(15)
    s_barrier
    s_mov_b32 s50, 1920
    s_mov_b32 s51, 1658880
    s_mov_b32 m0, 69632
    s_nop 0
    buffer_load_dwordx4 v8, s[16:19], s51 offen lds
    s_mov_b32 m0, 73728
    s_nop 0
    buffer_load_dwordx4 v9, s[16:19], s51 offen lds
    s_mov_b32 m0, 77824
    s_nop 0
    buffer_load_dwordx4 v10, s[16:19], s51 offen lds
    s_mov_b32 m0, 81920
    s_nop 0
    buffer_load_dwordx4 v11, s[20:23], s50 offen lds
    s_mov_b32 m0, 86016
    s_nop 0
    buffer_load_dwordx4 v12, s[20:23], s50 offen lds
    s_waitcnt vmcnt(15)
    s_barrier
    s_mov_b32 s50, 2048
    s_mov_b32 s51, 1769472
    s_mov_b32 m0, 92160
    s_nop 0
    buffer_load_dwordx4 v8, s[16:19], s51 offen lds
    s_mov_b32 m0, 96256
    s_nop 0
    buffer_load_dwordx4 v9, s[16:19], s51 offen lds
    s_mov_b32 m0, 100352
    s_nop 0
    buffer_load_dwordx4 v10, s[16:19], s51 offen lds
    s_mov_b32 m0, 104448
    s_nop 0
    buffer_load_dwordx4 v11, s[20:23], s50 offen lds
    s_mov_b32 m0, 108544
    s_nop 0
    buffer_load_dwordx4 v12, s[20:23], s50 offen lds
    s_waitcnt vmcnt(15)
    s_barrier
    s_mov_b32 s50, 2176
    s_mov_b32 s51, 1880064
    s_mov_b32 m0, 114688
    s_nop 0
    buffer_load_dwordx4 v8, s[16:19], s51 offen lds
    s_mov_b32 m0, 118784
    s_nop 0
    buffer_load_dwordx4 v9, s[16:19], s51 offen lds
    s_mov_b32 m0, 122880
    s_nop 0
    buffer_load_dwordx4 v10, s[16:19], s51 offen lds
    s_mov_b32 m0, 126976
    s_nop 0
    buffer_load_dwordx4 v11, s[20:23], s50 offen lds
    s_mov_b32 m0, 131072
    s_nop 0
    buffer_load_dwordx4 v12, s[20:23], s50 offen lds
    s_waitcnt vmcnt(15)
    s_barrier
    s_mov_b32 s50, 2304
    s_mov_b32 s51, 1990656
    s_mov_b32 m0, 2048
    s_nop 0
    buffer_load_dwordx4 v8, s[16:19], s51 offen lds
    s_mov_b32 m0, 6144
    s_nop 0
    buffer_load_dwordx4 v9, s[16:19], s51 offen lds
    s_mov_b32 m0, 10240
    s_nop 0
    buffer_load_dwordx4 v10, s[16:19], s51 offen lds
    s_mov_b32 m0, 14336
    s_nop 0
    buffer_load_dwordx4 v11, s[20:23], s50 offen lds
    s_mov_b32 m0, 18432
    s_nop 0
    buffer_load_dwordx4 v12, s[20:23], s50 offen lds
    s_waitcnt vmcnt(15)
    s_barrier
    s_mov_b32 s50, 2432
    s_mov_b32 s51, 2101248
    s_mov_b32 m0, 24576
    s_nop 0
    buffer_load_dwordx4 v8, s[16:19], s51 offen lds
    s_mov_b32 m0, 28672
    s_nop 0
    buffer_load_dwordx4 v9, s[16:19], s51 offen lds
    s_mov_b32 m0, 32768
    s_nop 0
    buffer_load_dwordx4 v10, s[16:19], s51 offen lds
    s_mov_b32 m0, 36864
    s_nop 0
    buffer_load_dwordx4 v11, s[20:23], s50 offen lds
    s_mov_b32 m0, 40960
    s_nop 0
    buffer_load_dwordx4 v12, s[20:23], s50 offen lds
    s_waitcnt vmcnt(15)
    s_barrier
    s_mov_b32 s50, 2560
    s_mov_b32 s51, 2211840
    s_mov_b32 m0, 47104
    s_nop 0
    buffer_load_dwordx4 v8, s[16:19], s51 offen lds
    s_mov_b32 m0, 51200
    s_nop 0
    buffer_load_dwordx4 v9, s[16:19], s51 offen lds
    s_mov_b32 m0, 55296
    s_nop 0
    buffer_load_dwordx4 v10, s[16:19], s51 offen lds
    s_mov_b32 m0, 59392
    s_nop 0
    buffer_load_dwordx4 v11, s[20:23], s50 offen lds
    s_mov_b32 m0, 63488
    s_nop 0
    buffer_load_dwordx4 v12, s[20:23], s50 offen lds
    s_waitcnt vmcnt(15)
    s_barrier
    s_mov_b32 s50, 2688
    s_mov_b32 s51, 2322432
    s_mov_b32 m0, 69632
    s_nop 0
    buffer_load_dwordx4 v8, s[16:19], s51 offen lds
    s_mov_b32 m0, 73728
    s_nop 0
    buffer_load_dwordx4 v9, s[16:19], s51 offen lds
    s_mov_b32 m0, 77824
    s_nop 0
    buffer_load_dwordx4 v10, s[16:19], s51 offen lds
    s_mov_b32 m0, 81920
    s_nop 0
    buffer_load_dwordx4 v11, s[20:23], s50 offen lds
    s_mov_b32 m0, 86016
    s_nop 0
    buffer_load_dwordx4 v12, s[20:23], s50 offen lds
    s_waitcnt vmcnt(15)
    s_barrier
    s_mov_b32 s50, 2816
    s_mov_b32 s51, 2433024
    s_mov_b32 m0, 92160
    s_nop 0
    buffer_load_dwordx4 v8, s[16:19], s51 offen lds
    s_mov_b32 m0, 96256
    s_nop 0
    buffer_load_dwordx4 v9, s[16:19], s51 offen lds
    s_mov_b32 m0, 100352
    s_nop 0
    buffer_load_dwordx4 v10, s[16:19], s51 offen lds
    s_mov_b32 m0, 104448
    s_nop 0
    buffer_load_dwordx4 v11, s[20:23], s50 offen lds
    s_mov_b32 m0, 108544
    s_nop 0
    buffer_load_dwordx4 v12, s[20:23], s50 offen lds
    s_waitcnt vmcnt(15)
    s_barrier
    s_mov_b32 s50, 2944
    s_mov_b32 s51, 2543616
    s_mov_b32 m0, 114688
    s_nop 0
    buffer_load_dwordx4 v8, s[16:19], s51 offen lds
    s_mov_b32 m0, 118784
    s_nop 0
    buffer_load_dwordx4 v9, s[16:19], s51 offen lds
    s_mov_b32 m0, 122880
    s_nop 0
    buffer_load_dwordx4 v10, s[16:19], s51 offen lds
    s_mov_b32 m0, 126976
    s_nop 0
    buffer_load_dwordx4 v11, s[20:23], s50 offen lds
    s_mov_b32 m0, 131072
    s_nop 0
    buffer_load_dwordx4 v12, s[20:23], s50 offen lds
    s_waitcnt vmcnt(15)
    s_barrier
    s_mov_b32 s50, 3072
    s_mov_b32 s51, 2654208
    s_mov_b32 m0, 2048
    s_nop 0
    buffer_load_dwordx4 v8, s[16:19], s51 offen lds
    s_mov_b32 m0, 6144
    s_nop 0
    buffer_load_dwordx4 v9, s[16:19], s51 offen lds
    s_mov_b32 m0, 10240
    s_nop 0
    buffer_load_dwordx4 v10, s[16:19], s51 offen lds
    s_mov_b32 m0, 14336
    s_nop 0
    buffer_load_dwordx4 v11, s[20:23], s50 offen lds
    s_mov_b32 m0, 18432
    s_nop 0
    buffer_load_dwordx4 v12, s[20:23], s50 offen lds
    s_waitcnt vmcnt(15)
    s_barrier
    s_mov_b32 s50, 3200
    s_mov_b32 s51, 2764800
    s_mov_b32 m0, 24576
    s_nop 0
    buffer_load_dwordx4 v8, s[16:19], s51 offen lds
    s_mov_b32 m0, 28672
    s_nop 0
    buffer_load_dwordx4 v9, s[16:19], s51 offen lds
    s_mov_b32 m0, 32768
    s_nop 0
    buffer_load_dwordx4 v10, s[16:19], s51 offen lds
    s_mov_b32 m0, 36864
    s_nop 0
    buffer_load_dwordx4 v11, s[20:23], s50 offen lds
    s_mov_b32 m0, 40960
    s_nop 0
    buffer_load_dwordx4 v12, s[20:23], s50 offen lds
    s_waitcnt vmcnt(15)
    s_barrier
    s_mov_b32 s50, 3328
    s_mov_b32 s51, 2875392
    s_mov_b32 m0, 47104
    s_nop 0
    buffer_load_dwordx4 v8, s[16:19], s51 offen lds
    s_mov_b32 m0, 51200
    s_nop 0
    buffer_load_dwordx4 v9, s[16:19], s51 offen lds
    s_mov_b32 m0, 55296
    s_nop 0
    buffer_load_dwordx4 v10, s[16:19], s51 offen lds
    s_mov_b32 m0, 59392
    s_nop 0
    buffer_load_dwordx4 v11, s[20:23], s50 offen lds
    s_mov_b32 m0, 63488
    s_nop 0
    buffer_load_dwordx4 v12, s[20:23], s50 offen lds
    s_waitcnt vmcnt(15)
    s_barrier
    s_mov_b32 s50, 3456
    s_mov_b32 s51, 2985984
    s_mov_b32 m0, 69632
    s_nop 0
    buffer_load_dwordx4 v8, s[16:19], s51 offen lds
    s_mov_b32 m0, 73728
    s_nop 0
    buffer_load_dwordx4 v9, s[16:19], s51 offen lds
    s_mov_b32 m0, 77824
    s_nop 0
    buffer_load_dwordx4 v10, s[16:19], s51 offen lds
    s_mov_b32 m0, 81920
    s_nop 0
    buffer_load_dwordx4 v11, s[20:23], s50 offen lds
    s_mov_b32 m0, 86016
    s_nop 0
    buffer_load_dwordx4 v12, s[20:23], s50 offen lds
    s_waitcnt vmcnt(15)
    s_barrier
    s_mov_b32 s50, 3584
    s_mov_b32 s51, 3096576
    s_mov_b32 m0, 92160
    s_nop 0
    buffer_load_dwordx4 v8, s[16:19], s51 offen lds
    s_mov_b32 m0, 96256
    s_nop 0
    buffer_load_dwordx4 v9, s[16:19], s51 offen lds
    s_mov_b32 m0, 100352
    s_nop 0
    buffer_load_dwordx4 v10, s[16:19], s51 offen lds
    s_mov_b32 m0, 104448
    s_nop 0
    buffer_load_dwordx4 v11, s[20:23], s50 offen lds
    s_mov_b32 m0, 108544
    s_nop 0
    buffer_load_dwordx4 v12, s[20:23], s50 offen lds
    s_waitcnt vmcnt(15)
    s_barrier
    s_mov_b32 s50, 3712
    s_mov_b32 s51, 3207168
    s_mov_b32 m0, 114688
    s_nop 0
    buffer_load_dwordx4 v8, s[16:19], s51 offen lds
    s_mov_b32 m0, 118784
    s_nop 0
    buffer_load_dwordx4 v9, s[16:19], s51 offen lds
    s_mov_b32 m0, 122880
    s_nop 0
    buffer_load_dwordx4 v10, s[16:19], s51 offen lds
    s_mov_b32 m0, 126976
    s_nop 0
    buffer_load_dwordx4 v11, s[20:23], s50 offen lds
    s_mov_b32 m0, 131072
    s_nop 0
    buffer_load_dwordx4 v12, s[20:23], s50 offen lds
    s_waitcnt vmcnt(15)
    s_barrier
    s_mov_b32 s50, 3840
    s_mov_b32 s51, 3317760
    s_mov_b32 m0, 2048
    s_nop 0
    buffer_load_dwordx4 v8, s[16:19], s51 offen lds
    s_mov_b32 m0, 6144
    s_nop 0
    buffer_load_dwordx4 v9, s[16:19], s51 offen lds
    s_mov_b32 m0, 10240
    s_nop 0
    buffer_load_dwordx4 v10, s[16:19], s51 offen lds
    s_mov_b32 m0, 14336
    s_nop 0
    buffer_load_dwordx4 v11, s[20:23], s50 offen lds
    s_mov_b32 m0, 18432
    s_nop 0
    buffer_load_dwordx4 v12, s[20:23], s50 offen lds
    s_waitcnt vmcnt(15)
    s_barrier
    s_mov_b32 s50, 3968
    s_mov_b32 s51, 3428352
    s_mov_b32 m0, 24576
    s_nop 0
    buffer_load_dwordx4 v8, s[16:19], s51 offen lds
    s_mov_b32 m0, 28672
    s_nop 0
    buffer_load_dwordx4 v9, s[16:19], s51 offen lds
    s_mov_b32 m0, 32768
    s_nop 0
    buffer_load_dwordx4 v10, s[16:19], s51 offen lds
    s_mov_b32 m0, 36864
    s_nop 0
    buffer_load_dwordx4 v11, s[20:23], s50 offen lds
    s_mov_b32 m0, 40960
    s_nop 0
    buffer_load_dwordx4 v12, s[20:23], s50 offen lds
    s_waitcnt vmcnt(15)
    s_barrier
    s_waitcnt vmcnt(10)
    s_barrier
    s_waitcnt vmcnt(5)
    s_barrier
    s_waitcnt vmcnt(0)
    s_barrier
    s_branch Lend_23
Lld_31:
    v_add_u32 v6, 4, v5
    v_and_b32 v6, 7, v6
    v_xor_b32 v6, v6, v4
    v_add_u32 v7, s42, v3
    v_add_u32 v7, 24, v7
    v_lshlrev_b32 v7, 5, v7
    v_lshrrev_b32 v8, 1, v6
    v_mul_u32_u24 v8, 27648, v8
    v_add_u32 v7, v7, v8
    v_and_b32 v6, 1, v6
    v_lshl_add_u32 v8, v6, 4, v7
    v_add_u32 v6, 4, v5
    v_and_b32 v6, 7, v6
    v_xor_b32 v6, v6, v4
    v_add_u32 v7, s42, v3
    v_add_u32 v7, 56, v7
    v_lshlrev_b32 v7, 5, v7
    v_lshrrev_b32 v9, 1, v6
    v_mul_u32_u24 v9, 27648, v9
    v_add_u32 v7, v7, v9
    v_and_b32 v6, 1, v6
    v_lshl_add_u32 v9, v6, 4, v7
    v_add_u32 v6, 4, v5
    v_and_b32 v6, 7, v6
    v_xor_b32 v6, v6, v4
    v_add_u32 v7, s42, v3
    v_add_u32 v7, 88, v7
    v_lshlrev_b32 v7, 5, v7
    v_lshrrev_b32 v10, 1, v6
    v_mul_u32_u24 v10, 27648, v10
    v_add_u32 v7, v7, v10
    v_and_b32 v6, 1, v6
    v_lshl_add_u32 v10, v6, 4, v7
    v_add_u32 v6, 4, v5
    v_and_b32 v6, 7, v6
    v_xor_b32 v6, v6, v4
    v_add_u32 v7, s43, v3
    v_add_u32 v7, 8, v7
    s_mov_b32 s47, 4096
    v_mul_lo_u32 v7, v7, s47
    v_lshl_add_u32 v11, v6, 4, v7
    v_add_u32 v6, 4, v5
    v_and_b32 v6, 7, v6
    v_xor_b32 v6, v6, v4
    v_add_u32 v7, s43, v3
    v_add_u32 v7, 40, v7
    s_mov_b32 s47, 4096
    v_mul_lo_u32 v7, v7, s47
    v_lshl_add_u32 v12, v6, 4, v7
    s_mov_b32 s50, 0
    s_mov_b32 s51, 0
    s_mov_b32 m0, 3072
    s_nop 0
    buffer_load_dwordx4 v8, s[16:19], s51 offen lds
    s_mov_b32 m0, 7168
    s_nop 0
    buffer_load_dwordx4 v9, s[16:19], s51 offen lds
    s_mov_b32 m0, 11264
    s_nop 0
    buffer_load_dwordx4 v10, s[16:19], s51 offen lds
    s_mov_b32 m0, 15360
    s_nop 0
    buffer_load_dwordx4 v11, s[20:23], s50 offen lds
    s_mov_b32 m0, 19456
    s_nop 0
    buffer_load_dwordx4 v12, s[20:23], s50 offen lds
    s_mov_b32 s50, 128
    s_mov_b32 s51, 110592
    s_mov_b32 m0, 25600
    s_nop 0
    buffer_load_dwordx4 v8, s[16:19], s51 offen lds
    s_mov_b32 m0, 29696
    s_nop 0
    buffer_load_dwordx4 v9, s[16:19], s51 offen lds
    s_mov_b32 m0, 33792
    s_nop 0
    buffer_load_dwordx4 v10, s[16:19], s51 offen lds
    s_mov_b32 m0, 37888
    s_nop 0
    buffer_load_dwordx4 v11, s[20:23], s50 offen lds
    s_mov_b32 m0, 41984
    s_nop 0
    buffer_load_dwordx4 v12, s[20:23], s50 offen lds
    s_mov_b32 s50, 256
    s_mov_b32 s51, 221184
    s_mov_b32 m0, 48128
    s_nop 0
    buffer_load_dwordx4 v8, s[16:19], s51 offen lds
    s_mov_b32 m0, 52224
    s_nop 0
    buffer_load_dwordx4 v9, s[16:19], s51 offen lds
    s_mov_b32 m0, 56320
    s_nop 0
    buffer_load_dwordx4 v10, s[16:19], s51 offen lds
    s_mov_b32 m0, 60416
    s_nop 0
    buffer_load_dwordx4 v11, s[20:23], s50 offen lds
    s_mov_b32 m0, 64512
    s_nop 0
    buffer_load_dwordx4 v12, s[20:23], s50 offen lds
    s_mov_b32 s50, 384
    s_mov_b32 s51, 331776
    s_mov_b32 m0, 70656
    s_nop 0
    buffer_load_dwordx4 v8, s[16:19], s51 offen lds
    s_mov_b32 m0, 74752
    s_nop 0
    buffer_load_dwordx4 v9, s[16:19], s51 offen lds
    s_mov_b32 m0, 78848
    s_nop 0
    buffer_load_dwordx4 v10, s[16:19], s51 offen lds
    s_mov_b32 m0, 82944
    s_nop 0
    buffer_load_dwordx4 v11, s[20:23], s50 offen lds
    s_mov_b32 m0, 87040
    s_nop 0
    buffer_load_dwordx4 v12, s[20:23], s50 offen lds
    s_mov_b32 s50, 512
    s_mov_b32 s51, 442368
    s_mov_b32 m0, 93184
    s_nop 0
    buffer_load_dwordx4 v8, s[16:19], s51 offen lds
    s_mov_b32 m0, 97280
    s_nop 0
    buffer_load_dwordx4 v9, s[16:19], s51 offen lds
    s_mov_b32 m0, 101376
    s_nop 0
    buffer_load_dwordx4 v10, s[16:19], s51 offen lds
    s_mov_b32 m0, 105472
    s_nop 0
    buffer_load_dwordx4 v11, s[20:23], s50 offen lds
    s_mov_b32 m0, 109568
    s_nop 0
    buffer_load_dwordx4 v12, s[20:23], s50 offen lds
    s_waitcnt vmcnt(20)
    s_barrier
    s_waitcnt vmcnt(15)
    s_barrier
    s_mov_b32 s50, 640
    s_mov_b32 s51, 552960
    s_mov_b32 m0, 115712
    s_nop 0
    buffer_load_dwordx4 v8, s[16:19], s51 offen lds
    s_mov_b32 m0, 119808
    s_nop 0
    buffer_load_dwordx4 v9, s[16:19], s51 offen lds
    s_mov_b32 m0, 123904
    s_nop 0
    buffer_load_dwordx4 v10, s[16:19], s51 offen lds
    s_mov_b32 m0, 128000
    s_nop 0
    buffer_load_dwordx4 v11, s[20:23], s50 offen lds
    s_mov_b32 m0, 132096
    s_nop 0
    buffer_load_dwordx4 v12, s[20:23], s50 offen lds
    s_waitcnt vmcnt(15)
    s_barrier
    s_mov_b32 s50, 768
    s_mov_b32 s51, 663552
    s_mov_b32 m0, 3072
    s_nop 0
    buffer_load_dwordx4 v8, s[16:19], s51 offen lds
    s_mov_b32 m0, 7168
    s_nop 0
    buffer_load_dwordx4 v9, s[16:19], s51 offen lds
    s_mov_b32 m0, 11264
    s_nop 0
    buffer_load_dwordx4 v10, s[16:19], s51 offen lds
    s_mov_b32 m0, 15360
    s_nop 0
    buffer_load_dwordx4 v11, s[20:23], s50 offen lds
    s_mov_b32 m0, 19456
    s_nop 0
    buffer_load_dwordx4 v12, s[20:23], s50 offen lds
    s_waitcnt vmcnt(15)
    s_barrier
    s_mov_b32 s50, 896
    s_mov_b32 s51, 774144
    s_mov_b32 m0, 25600
    s_nop 0
    buffer_load_dwordx4 v8, s[16:19], s51 offen lds
    s_mov_b32 m0, 29696
    s_nop 0
    buffer_load_dwordx4 v9, s[16:19], s51 offen lds
    s_mov_b32 m0, 33792
    s_nop 0
    buffer_load_dwordx4 v10, s[16:19], s51 offen lds
    s_mov_b32 m0, 37888
    s_nop 0
    buffer_load_dwordx4 v11, s[20:23], s50 offen lds
    s_mov_b32 m0, 41984
    s_nop 0
    buffer_load_dwordx4 v12, s[20:23], s50 offen lds
    s_waitcnt vmcnt(15)
    s_barrier
    s_mov_b32 s50, 1024
    s_mov_b32 s51, 884736
    s_mov_b32 m0, 48128
    s_nop 0
    buffer_load_dwordx4 v8, s[16:19], s51 offen lds
    s_mov_b32 m0, 52224
    s_nop 0
    buffer_load_dwordx4 v9, s[16:19], s51 offen lds
    s_mov_b32 m0, 56320
    s_nop 0
    buffer_load_dwordx4 v10, s[16:19], s51 offen lds
    s_mov_b32 m0, 60416
    s_nop 0
    buffer_load_dwordx4 v11, s[20:23], s50 offen lds
    s_mov_b32 m0, 64512
    s_nop 0
    buffer_load_dwordx4 v12, s[20:23], s50 offen lds
    s_waitcnt vmcnt(15)
    s_barrier
    s_mov_b32 s50, 1152
    s_mov_b32 s51, 995328
    s_mov_b32 m0, 70656
    s_nop 0
    buffer_load_dwordx4 v8, s[16:19], s51 offen lds
    s_mov_b32 m0, 74752
    s_nop 0
    buffer_load_dwordx4 v9, s[16:19], s51 offen lds
    s_mov_b32 m0, 78848
    s_nop 0
    buffer_load_dwordx4 v10, s[16:19], s51 offen lds
    s_mov_b32 m0, 82944
    s_nop 0
    buffer_load_dwordx4 v11, s[20:23], s50 offen lds
    s_mov_b32 m0, 87040
    s_nop 0
    buffer_load_dwordx4 v12, s[20:23], s50 offen lds
    s_waitcnt vmcnt(15)
    s_barrier
    s_mov_b32 s50, 1280
    s_mov_b32 s51, 1105920
    s_mov_b32 m0, 93184
    s_nop 0
    buffer_load_dwordx4 v8, s[16:19], s51 offen lds
    s_mov_b32 m0, 97280
    s_nop 0
    buffer_load_dwordx4 v9, s[16:19], s51 offen lds
    s_mov_b32 m0, 101376
    s_nop 0
    buffer_load_dwordx4 v10, s[16:19], s51 offen lds
    s_mov_b32 m0, 105472
    s_nop 0
    buffer_load_dwordx4 v11, s[20:23], s50 offen lds
    s_mov_b32 m0, 109568
    s_nop 0
    buffer_load_dwordx4 v12, s[20:23], s50 offen lds
    s_waitcnt vmcnt(15)
    s_barrier
    s_mov_b32 s50, 1408
    s_mov_b32 s51, 1216512
    s_mov_b32 m0, 115712
    s_nop 0
    buffer_load_dwordx4 v8, s[16:19], s51 offen lds
    s_mov_b32 m0, 119808
    s_nop 0
    buffer_load_dwordx4 v9, s[16:19], s51 offen lds
    s_mov_b32 m0, 123904
    s_nop 0
    buffer_load_dwordx4 v10, s[16:19], s51 offen lds
    s_mov_b32 m0, 128000
    s_nop 0
    buffer_load_dwordx4 v11, s[20:23], s50 offen lds
    s_mov_b32 m0, 132096
    s_nop 0
    buffer_load_dwordx4 v12, s[20:23], s50 offen lds
    s_waitcnt vmcnt(15)
    s_barrier
    s_mov_b32 s50, 1536
    s_mov_b32 s51, 1327104
    s_mov_b32 m0, 3072
    s_nop 0
    buffer_load_dwordx4 v8, s[16:19], s51 offen lds
    s_mov_b32 m0, 7168
    s_nop 0
    buffer_load_dwordx4 v9, s[16:19], s51 offen lds
    s_mov_b32 m0, 11264
    s_nop 0
    buffer_load_dwordx4 v10, s[16:19], s51 offen lds
    s_mov_b32 m0, 15360
    s_nop 0
    buffer_load_dwordx4 v11, s[20:23], s50 offen lds
    s_mov_b32 m0, 19456
    s_nop 0
    buffer_load_dwordx4 v12, s[20:23], s50 offen lds
    s_waitcnt vmcnt(15)
    s_barrier
    s_mov_b32 s50, 1664
    s_mov_b32 s51, 1437696
    s_mov_b32 m0, 25600
    s_nop 0
    buffer_load_dwordx4 v8, s[16:19], s51 offen lds
    s_mov_b32 m0, 29696
    s_nop 0
    buffer_load_dwordx4 v9, s[16:19], s51 offen lds
    s_mov_b32 m0, 33792
    s_nop 0
    buffer_load_dwordx4 v10, s[16:19], s51 offen lds
    s_mov_b32 m0, 37888
    s_nop 0
    buffer_load_dwordx4 v11, s[20:23], s50 offen lds
    s_mov_b32 m0, 41984
    s_nop 0
    buffer_load_dwordx4 v12, s[20:23], s50 offen lds
    s_waitcnt vmcnt(15)
    s_barrier
    s_mov_b32 s50, 1792
    s_mov_b32 s51, 1548288
    s_mov_b32 m0, 48128
    s_nop 0
    buffer_load_dwordx4 v8, s[16:19], s51 offen lds
    s_mov_b32 m0, 52224
    s_nop 0
    buffer_load_dwordx4 v9, s[16:19], s51 offen lds
    s_mov_b32 m0, 56320
    s_nop 0
    buffer_load_dwordx4 v10, s[16:19], s51 offen lds
    s_mov_b32 m0, 60416
    s_nop 0
    buffer_load_dwordx4 v11, s[20:23], s50 offen lds
    s_mov_b32 m0, 64512
    s_nop 0
    buffer_load_dwordx4 v12, s[20:23], s50 offen lds
    s_waitcnt vmcnt(15)
    s_barrier
    s_mov_b32 s50, 1920
    s_mov_b32 s51, 1658880
    s_mov_b32 m0, 70656
    s_nop 0
    buffer_load_dwordx4 v8, s[16:19], s51 offen lds
    s_mov_b32 m0, 74752
    s_nop 0
    buffer_load_dwordx4 v9, s[16:19], s51 offen lds
    s_mov_b32 m0, 78848
    s_nop 0
    buffer_load_dwordx4 v10, s[16:19], s51 offen lds
    s_mov_b32 m0, 82944
    s_nop 0
    buffer_load_dwordx4 v11, s[20:23], s50 offen lds
    s_mov_b32 m0, 87040
    s_nop 0
    buffer_load_dwordx4 v12, s[20:23], s50 offen lds
    s_waitcnt vmcnt(15)
    s_barrier
    s_mov_b32 s50, 2048
    s_mov_b32 s51, 1769472
    s_mov_b32 m0, 93184
    s_nop 0
    buffer_load_dwordx4 v8, s[16:19], s51 offen lds
    s_mov_b32 m0, 97280
    s_nop 0
    buffer_load_dwordx4 v9, s[16:19], s51 offen lds
    s_mov_b32 m0, 101376
    s_nop 0
    buffer_load_dwordx4 v10, s[16:19], s51 offen lds
    s_mov_b32 m0, 105472
    s_nop 0
    buffer_load_dwordx4 v11, s[20:23], s50 offen lds
    s_mov_b32 m0, 109568
    s_nop 0
    buffer_load_dwordx4 v12, s[20:23], s50 offen lds
    s_waitcnt vmcnt(15)
    s_barrier
    s_mov_b32 s50, 2176
    s_mov_b32 s51, 1880064
    s_mov_b32 m0, 115712
    s_nop 0
    buffer_load_dwordx4 v8, s[16:19], s51 offen lds
    s_mov_b32 m0, 119808
    s_nop 0
    buffer_load_dwordx4 v9, s[16:19], s51 offen lds
    s_mov_b32 m0, 123904
    s_nop 0
    buffer_load_dwordx4 v10, s[16:19], s51 offen lds
    s_mov_b32 m0, 128000
    s_nop 0
    buffer_load_dwordx4 v11, s[20:23], s50 offen lds
    s_mov_b32 m0, 132096
    s_nop 0
    buffer_load_dwordx4 v12, s[20:23], s50 offen lds
    s_waitcnt vmcnt(15)
    s_barrier
    s_mov_b32 s50, 2304
    s_mov_b32 s51, 1990656
    s_mov_b32 m0, 3072
    s_nop 0
    buffer_load_dwordx4 v8, s[16:19], s51 offen lds
    s_mov_b32 m0, 7168
    s_nop 0
    buffer_load_dwordx4 v9, s[16:19], s51 offen lds
    s_mov_b32 m0, 11264
    s_nop 0
    buffer_load_dwordx4 v10, s[16:19], s51 offen lds
    s_mov_b32 m0, 15360
    s_nop 0
    buffer_load_dwordx4 v11, s[20:23], s50 offen lds
    s_mov_b32 m0, 19456
    s_nop 0
    buffer_load_dwordx4 v12, s[20:23], s50 offen lds
    s_waitcnt vmcnt(15)
    s_barrier
    s_mov_b32 s50, 2432
    s_mov_b32 s51, 2101248
    s_mov_b32 m0, 25600
    s_nop 0
    buffer_load_dwordx4 v8, s[16:19], s51 offen lds
    s_mov_b32 m0, 29696
    s_nop 0
    buffer_load_dwordx4 v9, s[16:19], s51 offen lds
    s_mov_b32 m0, 33792
    s_nop 0
    buffer_load_dwordx4 v10, s[16:19], s51 offen lds
    s_mov_b32 m0, 37888
    s_nop 0
    buffer_load_dwordx4 v11, s[20:23], s50 offen lds
    s_mov_b32 m0, 41984
    s_nop 0
    buffer_load_dwordx4 v12, s[20:23], s50 offen lds
    s_waitcnt vmcnt(15)
    s_barrier
    s_mov_b32 s50, 2560
    s_mov_b32 s51, 2211840
    s_mov_b32 m0, 48128
    s_nop 0
    buffer_load_dwordx4 v8, s[16:19], s51 offen lds
    s_mov_b32 m0, 52224
    s_nop 0
    buffer_load_dwordx4 v9, s[16:19], s51 offen lds
    s_mov_b32 m0, 56320
    s_nop 0
    buffer_load_dwordx4 v10, s[16:19], s51 offen lds
    s_mov_b32 m0, 60416
    s_nop 0
    buffer_load_dwordx4 v11, s[20:23], s50 offen lds
    s_mov_b32 m0, 64512
    s_nop 0
    buffer_load_dwordx4 v12, s[20:23], s50 offen lds
    s_waitcnt vmcnt(15)
    s_barrier
    s_mov_b32 s50, 2688
    s_mov_b32 s51, 2322432
    s_mov_b32 m0, 70656
    s_nop 0
    buffer_load_dwordx4 v8, s[16:19], s51 offen lds
    s_mov_b32 m0, 74752
    s_nop 0
    buffer_load_dwordx4 v9, s[16:19], s51 offen lds
    s_mov_b32 m0, 78848
    s_nop 0
    buffer_load_dwordx4 v10, s[16:19], s51 offen lds
    s_mov_b32 m0, 82944
    s_nop 0
    buffer_load_dwordx4 v11, s[20:23], s50 offen lds
    s_mov_b32 m0, 87040
    s_nop 0
    buffer_load_dwordx4 v12, s[20:23], s50 offen lds
    s_waitcnt vmcnt(15)
    s_barrier
    s_mov_b32 s50, 2816
    s_mov_b32 s51, 2433024
    s_mov_b32 m0, 93184
    s_nop 0
    buffer_load_dwordx4 v8, s[16:19], s51 offen lds
    s_mov_b32 m0, 97280
    s_nop 0
    buffer_load_dwordx4 v9, s[16:19], s51 offen lds
    s_mov_b32 m0, 101376
    s_nop 0
    buffer_load_dwordx4 v10, s[16:19], s51 offen lds
    s_mov_b32 m0, 105472
    s_nop 0
    buffer_load_dwordx4 v11, s[20:23], s50 offen lds
    s_mov_b32 m0, 109568
    s_nop 0
    buffer_load_dwordx4 v12, s[20:23], s50 offen lds
    s_waitcnt vmcnt(15)
    s_barrier
    s_mov_b32 s50, 2944
    s_mov_b32 s51, 2543616
    s_mov_b32 m0, 115712
    s_nop 0
    buffer_load_dwordx4 v8, s[16:19], s51 offen lds
    s_mov_b32 m0, 119808
    s_nop 0
    buffer_load_dwordx4 v9, s[16:19], s51 offen lds
    s_mov_b32 m0, 123904
    s_nop 0
    buffer_load_dwordx4 v10, s[16:19], s51 offen lds
    s_mov_b32 m0, 128000
    s_nop 0
    buffer_load_dwordx4 v11, s[20:23], s50 offen lds
    s_mov_b32 m0, 132096
    s_nop 0
    buffer_load_dwordx4 v12, s[20:23], s50 offen lds
    s_waitcnt vmcnt(15)
    s_barrier
    s_mov_b32 s50, 3072
    s_mov_b32 s51, 2654208
    s_mov_b32 m0, 3072
    s_nop 0
    buffer_load_dwordx4 v8, s[16:19], s51 offen lds
    s_mov_b32 m0, 7168
    s_nop 0
    buffer_load_dwordx4 v9, s[16:19], s51 offen lds
    s_mov_b32 m0, 11264
    s_nop 0
    buffer_load_dwordx4 v10, s[16:19], s51 offen lds
    s_mov_b32 m0, 15360
    s_nop 0
    buffer_load_dwordx4 v11, s[20:23], s50 offen lds
    s_mov_b32 m0, 19456
    s_nop 0
    buffer_load_dwordx4 v12, s[20:23], s50 offen lds
    s_waitcnt vmcnt(15)
    s_barrier
    s_mov_b32 s50, 3200
    s_mov_b32 s51, 2764800
    s_mov_b32 m0, 25600
    s_nop 0
    buffer_load_dwordx4 v8, s[16:19], s51 offen lds
    s_mov_b32 m0, 29696
    s_nop 0
    buffer_load_dwordx4 v9, s[16:19], s51 offen lds
    s_mov_b32 m0, 33792
    s_nop 0
    buffer_load_dwordx4 v10, s[16:19], s51 offen lds
    s_mov_b32 m0, 37888
    s_nop 0
    buffer_load_dwordx4 v11, s[20:23], s50 offen lds
    s_mov_b32 m0, 41984
    s_nop 0
    buffer_load_dwordx4 v12, s[20:23], s50 offen lds
    s_waitcnt vmcnt(15)
    s_barrier
    s_mov_b32 s50, 3328
    s_mov_b32 s51, 2875392
    s_mov_b32 m0, 48128
    s_nop 0
    buffer_load_dwordx4 v8, s[16:19], s51 offen lds
    s_mov_b32 m0, 52224
    s_nop 0
    buffer_load_dwordx4 v9, s[16:19], s51 offen lds
    s_mov_b32 m0, 56320
    s_nop 0
    buffer_load_dwordx4 v10, s[16:19], s51 offen lds
    s_mov_b32 m0, 60416
    s_nop 0
    buffer_load_dwordx4 v11, s[20:23], s50 offen lds
    s_mov_b32 m0, 64512
    s_nop 0
    buffer_load_dwordx4 v12, s[20:23], s50 offen lds
    s_waitcnt vmcnt(15)
    s_barrier
    s_mov_b32 s50, 3456
    s_mov_b32 s51, 2985984
    s_mov_b32 m0, 70656
    s_nop 0
    buffer_load_dwordx4 v8, s[16:19], s51 offen lds
    s_mov_b32 m0, 74752
    s_nop 0
    buffer_load_dwordx4 v9, s[16:19], s51 offen lds
    s_mov_b32 m0, 78848
    s_nop 0
    buffer_load_dwordx4 v10, s[16:19], s51 offen lds
    s_mov_b32 m0, 82944
    s_nop 0
    buffer_load_dwordx4 v11, s[20:23], s50 offen lds
    s_mov_b32 m0, 87040
    s_nop 0
    buffer_load_dwordx4 v12, s[20:23], s50 offen lds
    s_waitcnt vmcnt(15)
    s_barrier
    s_mov_b32 s50, 3584
    s_mov_b32 s51, 3096576
    s_mov_b32 m0, 93184
    s_nop 0
    buffer_load_dwordx4 v8, s[16:19], s51 offen lds
    s_mov_b32 m0, 97280
    s_nop 0
    buffer_load_dwordx4 v9, s[16:19], s51 offen lds
    s_mov_b32 m0, 101376
    s_nop 0
    buffer_load_dwordx4 v10, s[16:19], s51 offen lds
    s_mov_b32 m0, 105472
    s_nop 0
    buffer_load_dwordx4 v11, s[20:23], s50 offen lds
    s_mov_b32 m0, 109568
    s_nop 0
    buffer_load_dwordx4 v12, s[20:23], s50 offen lds
    s_waitcnt vmcnt(15)
    s_barrier
    s_mov_b32 s50, 3712
    s_mov_b32 s51, 3207168
    s_mov_b32 m0, 115712
    s_nop 0
    buffer_load_dwordx4 v8, s[16:19], s51 offen lds
    s_mov_b32 m0, 119808
    s_nop 0
    buffer_load_dwordx4 v9, s[16:19], s51 offen lds
    s_mov_b32 m0, 123904
    s_nop 0
    buffer_load_dwordx4 v10, s[16:19], s51 offen lds
    s_mov_b32 m0, 128000
    s_nop 0
    buffer_load_dwordx4 v11, s[20:23], s50 offen lds
    s_mov_b32 m0, 132096
    s_nop 0
    buffer_load_dwordx4 v12, s[20:23], s50 offen lds
    s_waitcnt vmcnt(15)
    s_barrier
    s_mov_b32 s50, 3840
    s_mov_b32 s51, 3317760
    s_mov_b32 m0, 3072
    s_nop 0
    buffer_load_dwordx4 v8, s[16:19], s51 offen lds
    s_mov_b32 m0, 7168
    s_nop 0
    buffer_load_dwordx4 v9, s[16:19], s51 offen lds
    s_mov_b32 m0, 11264
    s_nop 0
    buffer_load_dwordx4 v10, s[16:19], s51 offen lds
    s_mov_b32 m0, 15360
    s_nop 0
    buffer_load_dwordx4 v11, s[20:23], s50 offen lds
    s_mov_b32 m0, 19456
    s_nop 0
    buffer_load_dwordx4 v12, s[20:23], s50 offen lds
    s_waitcnt vmcnt(15)
    s_barrier
    s_mov_b32 s50, 3968
    s_mov_b32 s51, 3428352
    s_mov_b32 m0, 25600
    s_nop 0
    buffer_load_dwordx4 v8, s[16:19], s51 offen lds
    s_mov_b32 m0, 29696
    s_nop 0
    buffer_load_dwordx4 v9, s[16:19], s51 offen lds
    s_mov_b32 m0, 33792
    s_nop 0
    buffer_load_dwordx4 v10, s[16:19], s51 offen lds
    s_mov_b32 m0, 37888
    s_nop 0
    buffer_load_dwordx4 v11, s[20:23], s50 offen lds
    s_mov_b32 m0, 41984
    s_nop 0
    buffer_load_dwordx4 v12, s[20:23], s50 offen lds
    s_waitcnt vmcnt(15)
    s_barrier
    s_waitcnt vmcnt(10)
    s_barrier
    s_waitcnt vmcnt(5)
    s_barrier
    s_waitcnt vmcnt(0)
    s_barrier
    s_branch Lend_23
Lpf_26:
Lend_23:
    s_endpgm
.p2align 8
.type g3a_kernel,@function
g3a_kernel:
    s_cmp_ge_u32 s2, 256
    s_cbranch_scc1 Lend_32
    s_load_dwordx2 s[4:5], s[0:1], 104
    s_and_b32 s40, s2, 7
    s_lshr_b32 s41, s2, 3
    s_and_b32 s42, s40, 1
    s_lshr_b32 s43, s40, 1
    s_mov_b32 s45, 0x40000001
    s_mul_hi_u32 s46, s41, s45
    s_mul_i32 s45, s46, 4
    s_sub_u32 s45, s41, s45
    s_mul_i32 s42, s42, 4
    s_add_u32 s42, s42, s45
    s_mul_i32 s43, s43, 8
    s_add_u32 s43, s43, s46
    s_cmp_ge_u32 s42, 8
    s_cbranch_scc1 Lend_32
    s_mov_b32 s39, s42
    s_mul_i32 s42, s42, 80
    s_mul_i32 s43, s43, 64
    v_lshrrev_b32 v1, 6, v0
    s_nop 0
    v_readfirstlane_b32 s44, v1
    v_and_b32 v2, 63, v0
    v_lshrrev_b32 v5, 4, v2
    s_waitcnt lgkmcnt(0)
    s_cmp_ge_u32 s44, 8
    s_cbranch_scc1 Lpf_35
    s_cmp_ge_u32 s44, 4
    s_cbranch_scc1 Lload_33
    v_and_b32 v3, 15, v2
    v_lshrrev_b32 v4, 1, v3
    v_and_b32 v4, 7, v4
    v_xor_b32 v4, v4, v5
    v_lshlrev_b32 v4, 4, v4
    v_lshl_add_u32 v4, v3, 7, v4
    s_and_b32 s45, s44, 0
    s_lshr_b32 s46, s44, 0
    s_mul_i32 s47, s45, 10240
    s_mul_i32 s48, s46, 2048
    s_add_u32 s48, s48, 10240
    v_add_u32 v8, s47, v4
    v_add_u32 v9, s47, v4
    v_add_u32 v9, 36864, v9
    v_add_u32 v10, s47, v4
    v_add_u32 v10, 73728, v10
    v_add_u32 v11, s47, v4
    v_add_u32 v11, 110592, v11
    v_add_u32 v12, s47, v4
    v_xor_b32 v12, 64, v12
    v_add_u32 v13, s47, v4
    v_xor_b32 v13, 64, v13
    v_add_u32 v13, 36864, v13
    v_add_u32 v14, s47, v4
    v_xor_b32 v14, 64, v14
    v_add_u32 v14, 73728, v14
    v_add_u32 v15, s47, v4
    v_xor_b32 v15, 64, v15
    v_add_u32 v15, 110592, v15
    v_add_u32 v16, s48, v4
    v_add_u32 v17, s48, v4
    v_add_u32 v17, 36864, v17
    v_add_u32 v18, s48, v4
    v_add_u32 v18, 73728, v18
    v_add_u32 v19, s48, v4
    v_add_u32 v19, 110592, v19
    v_add_u32 v20, s48, v4
    v_xor_b32 v20, 64, v20
    v_add_u32 v21, s48, v4
    v_xor_b32 v21, 64, v21
    v_add_u32 v21, 36864, v21
    v_add_u32 v22, s48, v4
    v_xor_b32 v22, 64, v22
    v_add_u32 v22, 73728, v22
    v_add_u32 v23, s48, v4
    v_xor_b32 v23, 64, v23
    v_add_u32 v23, 110592, v23
    v_mov_b32 v72, 0
    v_mov_b32 v73, 0
    v_mov_b32 v74, 0
    v_mov_b32 v75, 0
    v_mov_b32 v76, 0
    v_mov_b32 v77, 0
    v_mov_b32 v78, 0
    v_mov_b32 v79, 0
    v_mov_b32 v80, 0
    v_mov_b32 v81, 0
    v_mov_b32 v82, 0
    v_mov_b32 v83, 0
    v_mov_b32 v84, 0
    v_mov_b32 v85, 0
    v_mov_b32 v86, 0
    v_mov_b32 v87, 0
    v_mov_b32 v88, 0
    v_mov_b32 v89, 0
    v_mov_b32 v90, 0
    v_mov_b32 v91, 0
    v_and_b32 v3, 15, v2
    s_mul_i32 s47, s46, 16
    s_add_u32 s47, s47, s43
    v_add_u32 v3, s47, v3
    v_lshrrev_b32 v4, 4, v2
    v_lshlrev_b32 v4, 2, v4
    s_mul_i32 s47, s45, 80
    s_add_u32 s47, s47, s42
    v_add_u32 v4, s47, v4
    s_barrier
    ds_read_b128 v[24:27], v8 offset:0
    ds_read_b128 v[64:67], v16 offset:0
    ds_read_b128 v[28:31], v8 offset:2048
    ds_read_b128 v[32:35], v8 offset:4096
    ds_read_b128 v[36:39], v8 offset:6144
    ds_read_b128 v[40:43], v8 offset:8192
    ds_read_b128 v[44:47], v12 offset:0
    ds_read_b128 v[68:71], v20 offset:0
    ds_read_b128 v[48:51], v12 offset:2048
    ds_read_b128 v[52:55], v12 offset:4096
    ds_read_b128 v[56:59], v12 offset:6144
    ds_read_b128 v[60:63], v12 offset:8192
    s_waitcnt lgkmcnt(6)
    v_mfma_f32_16x16x32_bf16 v[72:75], v[24:27], v[64:67], v[72:75]
    v_mfma_f32_16x16x32_bf16 v[76:79], v[28:31], v[64:67], v[76:79]
    v_mfma_f32_16x16x32_bf16 v[80:83], v[32:35], v[64:67], v[80:83]
    v_mfma_f32_16x16x32_bf16 v[84:87], v[36:39], v[64:67], v[84:87]
    v_mfma_f32_16x16x32_bf16 v[88:91], v[40:43], v[64:67], v[88:91]
    s_waitcnt lgkmcnt(0)
    s_barrier
    ds_read_b128 v[24:27], v8 offset:18432
    ds_read_b128 v[64:67], v16 offset:18432
    ds_read_b128 v[28:31], v8 offset:20480
    ds_read_b128 v[32:35], v8 offset:22528
    ds_read_b128 v[36:39], v8 offset:24576
    ds_read_b128 v[40:43], v8 offset:26624
    v_mfma_f32_16x16x32_bf16 v[72:75], v[44:47], v[68:71], v[72:75]
    v_mfma_f32_16x16x32_bf16 v[76:79], v[48:51], v[68:71], v[76:79]
    v_mfma_f32_16x16x32_bf16 v[80:83], v[52:55], v[68:71], v[80:83]
    v_mfma_f32_16x16x32_bf16 v[84:87], v[56:59], v[68:71], v[84:87]
    v_mfma_f32_16x16x32_bf16 v[88:91], v[60:63], v[68:71], v[88:91]
    ds_read_b128 v[44:47], v12 offset:18432
    ds_read_b128 v[68:71], v20 offset:18432
    ds_read_b128 v[48:51], v12 offset:20480
    ds_read_b128 v[52:55], v12 offset:22528
    ds_read_b128 v[56:59], v12 offset:24576
    ds_read_b128 v[60:63], v12 offset:26624
    s_waitcnt lgkmcnt(6)
    v_mfma_f32_16x16x32_bf16 v[72:75], v[24:27], v[64:67], v[72:75]
    v_mfma_f32_16x16x32_bf16 v[76:79], v[28:31], v[64:67], v[76:79]
    v_mfma_f32_16x16x32_bf16 v[80:83], v[32:35], v[64:67], v[80:83]
    v_mfma_f32_16x16x32_bf16 v[84:87], v[36:39], v[64:67], v[84:87]
    v_mfma_f32_16x16x32_bf16 v[88:91], v[40:43], v[64:67], v[88:91]
    s_waitcnt lgkmcnt(0)
    s_barrier
    ds_read_b128 v[24:27], v9 offset:0
    ds_read_b128 v[64:67], v17 offset:0
    ds_read_b128 v[28:31], v9 offset:2048
    ds_read_b128 v[32:35], v9 offset:4096
    ds_read_b128 v[36:39], v9 offset:6144
    ds_read_b128 v[40:43], v9 offset:8192
    v_mfma_f32_16x16x32_bf16 v[72:75], v[44:47], v[68:71], v[72:75]
    v_mfma_f32_16x16x32_bf16 v[76:79], v[48:51], v[68:71], v[76:79]
    v_mfma_f32_16x16x32_bf16 v[80:83], v[52:55], v[68:71], v[80:83]
    v_mfma_f32_16x16x32_bf16 v[84:87], v[56:59], v[68:71], v[84:87]
    v_mfma_f32_16x16x32_bf16 v[88:91], v[60:63], v[68:71], v[88:91]
    ds_read_b128 v[44:47], v13 offset:0
    ds_read_b128 v[68:71], v21 offset:0
    ds_read_b128 v[48:51], v13 offset:2048
    ds_read_b128 v[52:55], v13 offset:4096
    ds_read_b128 v[56:59], v13 offset:6144
    ds_read_b128 v[60:63], v13 offset:8192
    s_waitcnt lgkmcnt(6)
    v_mfma_f32_16x16x32_bf16 v[72:75], v[24:27], v[64:67], v[72:75]
    v_mfma_f32_16x16x32_bf16 v[76:79], v[28:31], v[64:67], v[76:79]
    v_mfma_f32_16x16x32_bf16 v[80:83], v[32:35], v[64:67], v[80:83]
    v_mfma_f32_16x16x32_bf16 v[84:87], v[36:39], v[64:67], v[84:87]
    v_mfma_f32_16x16x32_bf16 v[88:91], v[40:43], v[64:67], v[88:91]
    s_waitcnt lgkmcnt(0)
    s_barrier
    ds_read_b128 v[24:27], v9 offset:18432
    ds_read_b128 v[64:67], v17 offset:18432
    ds_read_b128 v[28:31], v9 offset:20480
    ds_read_b128 v[32:35], v9 offset:22528
    ds_read_b128 v[36:39], v9 offset:24576
    ds_read_b128 v[40:43], v9 offset:26624
    s_add_u32 s24, s4, 0x5ad000
    s_addc_u32 s25, s5, 0
    s_mov_b32 s26, 0x280000
    s_mov_b32 s27, 0x00020000
    s_add_u32 s28, s4, 0x1832000
    s_addc_u32 s29, s5, 0
    s_mov_b32 s30, 0x280000
    s_mov_b32 s31, 0x00020000
    v_mul_u32_u24 v5, 1280, v3
    v_lshl_add_u32 v5, v4, 1, v5
    v_mov_b32 v6, v5
    buffer_load_dwordx2 v[92:93], v5, s[24:27], 0 offen offset:0
    buffer_load_dwordx2 v[94:95], v5, s[24:27], 0 offen offset:32
    buffer_load_dwordx2 v[96:97], v5, s[24:27], 0 offen offset:64
    buffer_load_dwordx2 v[98:99], v5, s[24:27], 0 offen offset:96
    buffer_load_dwordx2 v[100:101], v5, s[24:27], 0 offen offset:128
    v_add_u32 v5, 20480, v5
    v_mfma_f32_16x16x32_bf16 v[72:75], v[44:47], v[68:71], v[72:75]
    v_mfma_f32_16x16x32_bf16 v[76:79], v[48:51], v[68:71], v[76:79]
    v_mfma_f32_16x16x32_bf16 v[80:83], v[52:55], v[68:71], v[80:83]
    v_mfma_f32_16x16x32_bf16 v[84:87], v[56:59], v[68:71], v[84:87]
    v_mfma_f32_16x16x32_bf16 v[88:91], v[60:63], v[68:71], v[88:91]
    ds_read_b128 v[44:47], v13 offset:18432
    ds_read_b128 v[68:71], v21 offset:18432
    ds_read_b128 v[48:51], v13 offset:20480
    ds_read_b128 v[52:55], v13 offset:22528
    ds_read_b128 v[56:59], v13 offset:24576
    ds_read_b128 v[60:63], v13 offset:26624
    s_waitcnt lgkmcnt(6)
    v_mfma_f32_16x16x32_bf16 v[72:75], v[24:27], v[64:67], v[72:75]
    v_mfma_f32_16x16x32_bf16 v[76:79], v[28:31], v[64:67], v[76:79]
    v_mfma_f32_16x16x32_bf16 v[80:83], v[32:35], v[64:67], v[80:83]
    v_mfma_f32_16x16x32_bf16 v[84:87], v[36:39], v[64:67], v[84:87]
    v_mfma_f32_16x16x32_bf16 v[88:91], v[40:43], v[64:67], v[88:91]
    s_waitcnt lgkmcnt(0)
    s_barrier
    ds_read_b128 v[24:27], v10 offset:0
    ds_read_b128 v[64:67], v18 offset:0
    ds_read_b128 v[28:31], v10 offset:2048
    ds_read_b128 v[32:35], v10 offset:4096
    ds_read_b128 v[36:39], v10 offset:6144
    ds_read_b128 v[40:43], v10 offset:8192
    v_mfma_f32_16x16x32_bf16 v[72:75], v[44:47], v[68:71], v[72:75]
    v_mfma_f32_16x16x32_bf16 v[76:79], v[48:51], v[68:71], v[76:79]
    v_mfma_f32_16x16x32_bf16 v[80:83], v[52:55], v[68:71], v[80:83]
    v_mfma_f32_16x16x32_bf16 v[84:87], v[56:59], v[68:71], v[84:87]
    v_mfma_f32_16x16x32_bf16 v[88:91], v[60:63], v[68:71], v[88:91]
    ds_read_b128 v[44:47], v14 offset:0
    ds_read_b128 v[68:71], v22 offset:0
    ds_read_b128 v[48:51], v14 offset:2048
    ds_read_b128 v[52:55], v14 offset:4096
    ds_read_b128 v[56:59], v14 offset:6144
    ds_read_b128 v[60:63], v14 offset:8192
    s_waitcnt lgkmcnt(6)
    v_mfma_f32_16x16x32_bf16 v[72:75], v[24:27], v[64:67], v[72:75]
    v_mfma_f32_16x16x32_bf16 v[76:79], v[28:31], v[64:67], v[76:79]
    v_mfma_f32_16x16x32_bf16 v[80:83], v[32:35], v[64:67], v[80:83]
    v_mfma_f32_16x16x32_bf16 v[84:87], v[36:39], v[64:67], v[84:87]
    v_mfma_f32_16x16x32_bf16 v[88:91], v[40:43], v[64:67], v[88:91]
    s_waitcnt lgkmcnt(0)
    s_barrier
    ds_read_b128 v[24:27], v10 offset:18432
    ds_read_b128 v[64:67], v18 offset:18432
    ds_read_b128 v[28:31], v10 offset:20480
    ds_read_b128 v[32:35], v10 offset:22528
    ds_read_b128 v[36:39], v10 offset:24576
    ds_read_b128 v[40:43], v10 offset:26624
    v_mfma_f32_16x16x32_bf16 v[72:75], v[44:47], v[68:71], v[72:75]
    v_mfma_f32_16x16x32_bf16 v[76:79], v[48:51], v[68:71], v[76:79]
    v_mfma_f32_16x16x32_bf16 v[80:83], v[52:55], v[68:71], v[80:83]
    v_mfma_f32_16x16x32_bf16 v[84:87], v[56:59], v[68:71], v[84:87]
    v_mfma_f32_16x16x32_bf16 v[88:91], v[60:63], v[68:71], v[88:91]
    ds_read_b128 v[44:47], v14 offset:18432
    ds_read_b128 v[68:71], v22 offset:18432
    ds_read_b128 v[48:51], v14 offset:20480
    ds_read_b128 v[52:55], v14 offset:22528
    ds_read_b128 v[56:59], v14 offset:24576
    ds_read_b128 v[60:63], v14 offset:26624
    s_waitcnt lgkmcnt(6)
    v_mfma_f32_16x16x32_bf16 v[72:75], v[24:27], v[64:67], v[72:75]
    v_mfma_f32_16x16x32_bf16 v[76:79], v[28:31], v[64:67], v[76:79]
    v_mfma_f32_16x16x32_bf16 v[80:83], v[32:35], v[64:67], v[80:83]
    v_mfma_f32_16x16x32_bf16 v[84:87], v[36:39], v[64:67], v[84:87]
    v_mfma_f32_16x16x32_bf16 v[88:91], v[40:43], v[64:67], v[88:91]
    s_waitcnt lgkmcnt(0)
    s_barrier
    ds_read_b128 v[24:27], v11 offset:0
    ds_read_b128 v[64:67], v19 offset:0
    ds_read_b128 v[28:31], v11 offset:2048
    ds_read_b128 v[32:35], v11 offset:4096
    ds_read_b128 v[36:39], v11 offset:6144
    ds_read_b128 v[40:43], v11 offset:8192
    v_mfma_f32_16x16x32_bf16 v[72:75], v[44:47], v[68:71], v[72:75]
    v_mfma_f32_16x16x32_bf16 v[76:79], v[48:51], v[68:71], v[76:79]
    v_mfma_f32_16x16x32_bf16 v[80:83], v[52:55], v[68:71], v[80:83]
    v_mfma_f32_16x16x32_bf16 v[84:87], v[56:59], v[68:71], v[84:87]
    v_mfma_f32_16x16x32_bf16 v[88:91], v[60:63], v[68:71], v[88:91]
    ds_read_b128 v[44:47], v15 offset:0
    ds_read_b128 v[68:71], v23 offset:0
    ds_read_b128 v[48:51], v15 offset:2048
    ds_read_b128 v[52:55], v15 offset:4096
    ds_read_b128 v[56:59], v15 offset:6144
    ds_read_b128 v[60:63], v15 offset:8192
    s_waitcnt lgkmcnt(6)
    v_mfma_f32_16x16x32_bf16 v[72:75], v[24:27], v[64:67], v[72:75]
    v_mfma_f32_16x16x32_bf16 v[76:79], v[28:31], v[64:67], v[76:79]
    v_mfma_f32_16x16x32_bf16 v[80:83], v[32:35], v[64:67], v[80:83]
    v_mfma_f32_16x16x32_bf16 v[84:87], v[36:39], v[64:67], v[84:87]
    v_mfma_f32_16x16x32_bf16 v[88:91], v[40:43], v[64:67], v[88:91]
    s_waitcnt lgkmcnt(0)
    s_barrier
    ds_read_b128 v[24:27], v8 offset:0
    ds_read_b128 v[64:67], v16 offset:0
    ds_read_b128 v[28:31], v8 offset:2048
    ds_read_b128 v[32:35], v8 offset:4096
    ds_read_b128 v[36:39], v8 offset:6144
    ds_read_b128 v[40:43], v8 offset:8192
    v_mfma_f32_16x16x32_bf16 v[72:75], v[44:47], v[68:71], v[72:75]
    v_mfma_f32_16x16x32_bf16 v[76:79], v[48:51], v[68:71], v[76:79]
    v_mfma_f32_16x16x32_bf16 v[80:83], v[52:55], v[68:71], v[80:83]
    v_mfma_f32_16x16x32_bf16 v[84:87], v[56:59], v[68:71], v[84:87]
    v_mfma_f32_16x16x32_bf16 v[88:91], v[60:63], v[68:71], v[88:91]
    ds_read_b128 v[44:47], v12 offset:0
    ds_read_b128 v[68:71], v20 offset:0
    ds_read_b128 v[48:51], v12 offset:2048
    ds_read_b128 v[52:55], v12 offset:4096
    ds_read_b128 v[56:59], v12 offset:6144
    ds_read_b128 v[60:63], v12 offset:8192
    s_waitcnt lgkmcnt(6)
    v_mfma_f32_16x16x32_bf16 v[72:75], v[24:27], v[64:67], v[72:75]
    v_mfma_f32_16x16x32_bf16 v[76:79], v[28:31], v[64:67], v[76:79]
    v_mfma_f32_16x16x32_bf16 v[80:83], v[32:35], v[64:67], v[80:83]
    v_mfma_f32_16x16x32_bf16 v[84:87], v[36:39], v[64:67], v[84:87]
    v_mfma_f32_16x16x32_bf16 v[88:91], v[40:43], v[64:67], v[88:91]
    s_waitcnt lgkmcnt(0)
    s_barrier
    ds_read_b128 v[24:27], v8 offset:18432
    ds_read_b128 v[64:67], v16 offset:18432
    ds_read_b128 v[28:31], v8 offset:20480
    ds_read_b128 v[32:35], v8 offset:22528
    ds_read_b128 v[36:39], v8 offset:24576
    ds_read_b128 v[40:43], v8 offset:26624
    v_mfma_f32_16x16x32_bf16 v[72:75], v[44:47], v[68:71], v[72:75]
    v_mfma_f32_16x16x32_bf16 v[76:79], v[48:51], v[68:71], v[76:79]
    v_mfma_f32_16x16x32_bf16 v[80:83], v[52:55], v[68:71], v[80:83]
    v_mfma_f32_16x16x32_bf16 v[84:87], v[56:59], v[68:71], v[84:87]
    v_mfma_f32_16x16x32_bf16 v[88:91], v[60:63], v[68:71], v[88:91]
    ds_read_b128 v[44:47], v12 offset:18432
    ds_read_b128 v[68:71], v20 offset:18432
    ds_read_b128 v[48:51], v12 offset:20480
    ds_read_b128 v[52:55], v12 offset:22528
    ds_read_b128 v[56:59], v12 offset:24576
    ds_read_b128 v[60:63], v12 offset:26624
    s_waitcnt lgkmcnt(6)
    v_mfma_f32_16x16x32_bf16 v[72:75], v[24:27], v[64:67], v[72:75]
    v_mfma_f32_16x16x32_bf16 v[76:79], v[28:31], v[64:67], v[76:79]
    v_mfma_f32_16x16x32_bf16 v[80:83], v[32:35], v[64:67], v[80:83]
    v_mfma_f32_16x16x32_bf16 v[84:87], v[36:39], v[64:67], v[84:87]
    v_mfma_f32_16x16x32_bf16 v[88:91], v[40:43], v[64:67], v[88:91]
    s_waitcnt lgkmcnt(0)
    s_barrier
    ds_read_b128 v[24:27], v9 offset:0
    ds_read_b128 v[64:67], v17 offset:0
    ds_read_b128 v[28:31], v9 offset:2048
    ds_read_b128 v[32:35], v9 offset:4096
    ds_read_b128 v[36:39], v9 offset:6144
    ds_read_b128 v[40:43], v9 offset:8192
    v_mfma_f32_16x16x32_bf16 v[72:75], v[44:47], v[68:71], v[72:75]
    v_mfma_f32_16x16x32_bf16 v[76:79], v[48:51], v[68:71], v[76:79]
    v_mfma_f32_16x16x32_bf16 v[80:83], v[52:55], v[68:71], v[80:83]
    v_mfma_f32_16x16x32_bf16 v[84:87], v[56:59], v[68:71], v[84:87]
    v_mfma_f32_16x16x32_bf16 v[88:91], v[60:63], v[68:71], v[88:91]
    ds_read_b128 v[44:47], v13 offset:0
    ds_read_b128 v[68:71], v21 offset:0
    ds_read_b128 v[48:51], v13 offset:2048
    ds_read_b128 v[52:55], v13 offset:4096
    ds_read_b128 v[56:59], v13 offset:6144
    ds_read_b128 v[60:63], v13 offset:8192
    s_waitcnt lgkmcnt(6)
    v_mfma_f32_16x16x32_bf16 v[72:75], v[24:27], v[64:67], v[72:75]
    v_mfma_f32_16x16x32_bf16 v[76:79], v[28:31], v[64:67], v[76:79]
    v_mfma_f32_16x16x32_bf16 v[80:83], v[32:35], v[64:67], v[80:83]
    v_mfma_f32_16x16x32_bf16 v[84:87], v[36:39], v[64:67], v[84:87]
    v_mfma_f32_16x16x32_bf16 v[88:91], v[40:43], v[64:67], v[88:91]
    s_waitcnt lgkmcnt(0)
    s_barrier
    ds_read_b128 v[24:27], v9 offset:18432
    ds_read_b128 v[64:67], v17 offset:18432
    ds_read_b128 v[28:31], v9 offset:20480
    ds_read_b128 v[32:35], v9 offset:22528
    ds_read_b128 v[36:39], v9 offset:24576
    ds_read_b128 v[40:43], v9 offset:26624
    v_mfma_f32_16x16x32_bf16 v[72:75], v[44:47], v[68:71], v[72:75]
    v_mfma_f32_16x16x32_bf16 v[76:79], v[48:51], v[68:71], v[76:79]
    v_mfma_f32_16x16x32_bf16 v[80:83], v[52:55], v[68:71], v[80:83]
    v_mfma_f32_16x16x32_bf16 v[84:87], v[56:59], v[68:71], v[84:87]
    v_mfma_f32_16x16x32_bf16 v[88:91], v[60:63], v[68:71], v[88:91]
    ds_read_b128 v[44:47], v13 offset:18432
    ds_read_b128 v[68:71], v21 offset:18432
    ds_read_b128 v[48:51], v13 offset:20480
    ds_read_b128 v[52:55], v13 offset:22528
    ds_read_b128 v[56:59], v13 offset:24576
    ds_read_b128 v[60:63], v13 offset:26624
    s_waitcnt lgkmcnt(6)
    v_mfma_f32_16x16x32_bf16 v[72:75], v[24:27], v[64:67], v[72:75]
    v_mfma_f32_16x16x32_bf16 v[76:79], v[28:31], v[64:67], v[76:79]
    v_mfma_f32_16x16x32_bf16 v[80:83], v[32:35], v[64:67], v[80:83]
    v_mfma_f32_16x16x32_bf16 v[84:87], v[36:39], v[64:67], v[84:87]
    v_mfma_f32_16x16x32_bf16 v[88:91], v[40:43], v[64:67], v[88:91]
    s_waitcnt lgkmcnt(0)
    s_barrier
    ds_read_b128 v[24:27], v10 offset:0
    ds_read_b128 v[64:67], v18 offset:0
    ds_read_b128 v[28:31], v10 offset:2048
    ds_read_b128 v[32:35], v10 offset:4096
    ds_read_b128 v[36:39], v10 offset:6144
    ds_read_b128 v[40:43], v10 offset:8192
    v_mfma_f32_16x16x32_bf16 v[72:75], v[44:47], v[68:71], v[72:75]
    v_mfma_f32_16x16x32_bf16 v[76:79], v[48:51], v[68:71], v[76:79]
    v_mfma_f32_16x16x32_bf16 v[80:83], v[52:55], v[68:71], v[80:83]
    v_mfma_f32_16x16x32_bf16 v[84:87], v[56:59], v[68:71], v[84:87]
    v_mfma_f32_16x16x32_bf16 v[88:91], v[60:63], v[68:71], v[88:91]
    ds_read_b128 v[44:47], v14 offset:0
    ds_read_b128 v[68:71], v22 offset:0
    ds_read_b128 v[48:51], v14 offset:2048
    ds_read_b128 v[52:55], v14 offset:4096
    ds_read_b128 v[56:59], v14 offset:6144
    ds_read_b128 v[60:63], v14 offset:8192
    s_waitcnt lgkmcnt(6)
    v_mfma_f32_16x16x32_bf16 v[72:75], v[24:27], v[64:67], v[72:75]
    v_mfma_f32_16x16x32_bf16 v[76:79], v[28:31], v[64:67], v[76:79]
    v_mfma_f32_16x16x32_bf16 v[80:83], v[32:35], v[64:67], v[80:83]
    v_mfma_f32_16x16x32_bf16 v[84:87], v[36:39], v[64:67], v[84:87]
    v_mfma_f32_16x16x32_bf16 v[88:91], v[40:43], v[64:67], v[88:91]
    s_waitcnt lgkmcnt(0)
    s_barrier
    ds_read_b128 v[24:27], v10 offset:18432
    ds_read_b128 v[64:67], v18 offset:18432
    ds_read_b128 v[28:31], v10 offset:20480
    ds_read_b128 v[32:35], v10 offset:22528
    ds_read_b128 v[36:39], v10 offset:24576
    ds_read_b128 v[40:43], v10 offset:26624
    v_mfma_f32_16x16x32_bf16 v[72:75], v[44:47], v[68:71], v[72:75]
    v_mfma_f32_16x16x32_bf16 v[76:79], v[48:51], v[68:71], v[76:79]
    v_mfma_f32_16x16x32_bf16 v[80:83], v[52:55], v[68:71], v[80:83]
    v_mfma_f32_16x16x32_bf16 v[84:87], v[56:59], v[68:71], v[84:87]
    v_mfma_f32_16x16x32_bf16 v[88:91], v[60:63], v[68:71], v[88:91]
    ds_read_b128 v[44:47], v14 offset:18432
    ds_read_b128 v[68:71], v22 offset:18432
    ds_read_b128 v[48:51], v14 offset:20480
    ds_read_b128 v[52:55], v14 offset:22528
    ds_read_b128 v[56:59], v14 offset:24576
    ds_read_b128 v[60:63], v14 offset:26624
    s_waitcnt lgkmcnt(6)
    v_mfma_f32_16x16x32_bf16 v[72:75], v[24:27], v[64:67], v[72:75]
    v_mfma_f32_16x16x32_bf16 v[76:79], v[28:31], v[64:67], v[76:79]
    v_mfma_f32_16x16x32_bf16 v[80:83], v[32:35], v[64:67], v[80:83]
    v_mfma_f32_16x16x32_bf16 v[84:87], v[36:39], v[64:67], v[84:87]
    v_mfma_f32_16x16x32_bf16 v[88:91], v[40:43], v[64:67], v[88:91]
    s_waitcnt lgkmcnt(0)
    s_barrier
    ds_read_b128 v[24:27], v11 offset:0
    ds_read_b128 v[64:67], v19 offset:0
    ds_read_b128 v[28:31], v11 offset:2048
    ds_read_b128 v[32:35], v11 offset:4096
    ds_read_b128 v[36:39], v11 offset:6144
    ds_read_b128 v[40:43], v11 offset:8192
    v_mfma_f32_16x16x32_bf16 v[72:75], v[44:47], v[68:71], v[72:75]
    v_mfma_f32_16x16x32_bf16 v[76:79], v[48:51], v[68:71], v[76:79]
    v_mfma_f32_16x16x32_bf16 v[80:83], v[52:55], v[68:71], v[80:83]
    v_mfma_f32_16x16x32_bf16 v[84:87], v[56:59], v[68:71], v[84:87]
    v_mfma_f32_16x16x32_bf16 v[88:91], v[60:63], v[68:71], v[88:91]
    s_waitcnt lgkmcnt(0)
    v_mfma_f32_16x16x32_bf16 v[72:75], v[24:27], v[64:67], v[72:75]
    v_mfma_f32_16x16x32_bf16 v[76:79], v[28:31], v[64:67], v[76:79]
    v_mfma_f32_16x16x32_bf16 v[80:83], v[32:35], v[64:67], v[80:83]
    v_mfma_f32_16x16x32_bf16 v[84:87], v[36:39], v[64:67], v[84:87]
    v_mfma_f32_16x16x32_bf16 v[88:91], v[40:43], v[64:67], v[88:91]
    s_nop 15
    s_waitcnt vmcnt(0)
    v_cvt_pk_bf16_f32 v24, v72, v73
    v_lshlrev_b32 v72, 16, v24
    v_and_b32 v73, 0xffff0000, v24
    v_cvt_pk_bf16_f32 v24, v74, v75
    v_lshlrev_b32 v74, 16, v24
    v_and_b32 v75, 0xffff0000, v24
    v_lshlrev_b32 v24, 16, v92
    v_and_b32 v25, 0xffff0000, v92
    v_lshlrev_b32 v26, 16, v93
    v_and_b32 v27, 0xffff0000, v93
    v_pk_add_f32 v[72:73], v[72:73], v[24:25]
    v_pk_add_f32 v[74:75], v[74:75], v[26:27]
    v_cvt_pk_bf16_f32 v72, v72, v73
    v_cvt_pk_bf16_f32 v73, v74, v75
    buffer_store_dwordx2 v[72:73], v6, s[28:31], 0 offen offset:0
    v_cvt_pk_bf16_f32 v24, v76, v77
    v_lshlrev_b32 v76, 16, v24
    v_and_b32 v77, 0xffff0000, v24
    v_cvt_pk_bf16_f32 v24, v78, v79
    v_lshlrev_b32 v78, 16, v24
    v_and_b32 v79, 0xffff0000, v24
    v_lshlrev_b32 v24, 16, v94
    v_and_b32 v25, 0xffff0000, v94
    v_lshlrev_b32 v26, 16, v95
    v_and_b32 v27, 0xffff0000, v95
    v_pk_add_f32 v[76:77], v[76:77], v[24:25]
    v_pk_add_f32 v[78:79], v[78:79], v[26:27]
    v_cvt_pk_bf16_f32 v76, v76, v77
    v_cvt_pk_bf16_f32 v77, v78, v79
    buffer_store_dwordx2 v[76:77], v6, s[28:31], 0 offen offset:32
    v_cvt_pk_bf16_f32 v24, v80, v81
    v_lshlrev_b32 v80, 16, v24
    v_and_b32 v81, 0xffff0000, v24
    v_cvt_pk_bf16_f32 v24, v82, v83
    v_lshlrev_b32 v82, 16, v24
    v_and_b32 v83, 0xffff0000, v24
    v_lshlrev_b32 v24, 16, v96
    v_and_b32 v25, 0xffff0000, v96
    v_lshlrev_b32 v26, 16, v97
    v_and_b32 v27, 0xffff0000, v97
    v_pk_add_f32 v[80:81], v[80:81], v[24:25]
    v_pk_add_f32 v[82:83], v[82:83], v[26:27]
    v_cvt_pk_bf16_f32 v80, v80, v81
    v_cvt_pk_bf16_f32 v81, v82, v83
    buffer_store_dwordx2 v[80:81], v6, s[28:31], 0 offen offset:64
    v_cvt_pk_bf16_f32 v24, v84, v85
    v_lshlrev_b32 v84, 16, v24
    v_and_b32 v85, 0xffff0000, v24
    v_cvt_pk_bf16_f32 v24, v86, v87
    v_lshlrev_b32 v86, 16, v24
    v_and_b32 v87, 0xffff0000, v24
    v_lshlrev_b32 v24, 16, v98
    v_and_b32 v25, 0xffff0000, v98
    v_lshlrev_b32 v26, 16, v99
    v_and_b32 v27, 0xffff0000, v99
    v_pk_add_f32 v[84:85], v[84:85], v[24:25]
    v_pk_add_f32 v[86:87], v[86:87], v[26:27]
    v_cvt_pk_bf16_f32 v84, v84, v85
    v_cvt_pk_bf16_f32 v85, v86, v87
    buffer_store_dwordx2 v[84:85], v6, s[28:31], 0 offen offset:96
    v_cvt_pk_bf16_f32 v24, v88, v89
    v_lshlrev_b32 v88, 16, v24
    v_and_b32 v89, 0xffff0000, v24
    v_cvt_pk_bf16_f32 v24, v90, v91
    v_lshlrev_b32 v90, 16, v24
    v_and_b32 v91, 0xffff0000, v24
    v_lshlrev_b32 v24, 16, v100
    v_and_b32 v25, 0xffff0000, v100
    v_lshlrev_b32 v26, 16, v101
    v_and_b32 v27, 0xffff0000, v101
    v_pk_add_f32 v[88:89], v[88:89], v[24:25]
    v_pk_add_f32 v[90:91], v[90:91], v[26:27]
    v_cvt_pk_bf16_f32 v88, v88, v89
    v_cvt_pk_bf16_f32 v89, v90, v91
    buffer_store_dwordx2 v[88:89], v6, s[28:31], 0 offen offset:128
    v_add_u32 v6, 20480, v6
    s_branch Lend_32
Lload_33:
    s_add_u32 s16, s4, 0x49e000
    s_addc_u32 s17, s5, 0
    s_mov_b32 s18, 0x10f000
    s_mov_b32 s19, 0x00020000
    s_add_u32 s20, s4, 0x14d1000
    s_addc_u32 s21, s5, 0
    s_mov_b32 s22, 0x361000
    s_mov_b32 s23, 0x00020000
    v_lshrrev_b32 v3, 3, v2
    v_and_b32 v4, 7, v2
    s_cmp_eq_u32 s44, 5
    s_cbranch_scc1 Lld_37
    s_cmp_eq_u32 s44, 6
    s_cbranch_scc1 Lld_38
    s_cmp_eq_u32 s44, 7
    s_cbranch_scc1 Lld_39
Lld_36:
    v_add_u32 v6, 0, v5
    v_and_b32 v6, 7, v6
    v_xor_b32 v6, v6, v4
    v_add_u32 v7, s42, v3
    s_mov_b32 s47, 1728
    v_mul_lo_u32 v7, v7, s47
    v_lshl_add_u32 v8, v6, 4, v7
    v_add_u32 v6, 0, v5
    v_and_b32 v6, 7, v6
    v_xor_b32 v6, v6, v4
    v_add_u32 v7, s42, v3
    v_add_u32 v7, 32, v7
    s_mov_b32 s47, 1728
    v_mul_lo_u32 v7, v7, s47
    v_lshl_add_u32 v9, v6, 4, v7
    v_add_u32 v6, 0, v5
    v_and_b32 v6, 7, v6
    v_xor_b32 v6, v6, v4
    v_add_u32 v7, s42, v3
    v_add_u32 v7, 64, v7
    s_mov_b32 s47, 1728
    v_mul_lo_u32 v7, v7, s47
    v_lshl_add_u32 v10, v6, 4, v7
    v_add_u32 v6, 0, v5
    v_and_b32 v6, 7, v6
    v_xor_b32 v6, v6, v4
    v_add_u32 v7, s43, v3
    v_add_u32 v7, 16, v7
    s_mov_b32 s47, 1728
    v_mul_lo_u32 v7, v7, s47
    v_lshl_add_u32 v11, v6, 4, v7
    v_add_u32 v6, 0, v5
    v_and_b32 v6, 7, v6
    v_xor_b32 v6, v6, v4
    v_add_u32 v7, s43, v3
    v_add_u32 v7, 48, v7
    s_mov_b32 s47, 1728
    v_mul_lo_u32 v7, v7, s47
    v_lshl_add_u32 v12, v6, 4, v7
    s_mov_b32 s50, 0
    s_mov_b32 s51, 0
    s_mov_b32 m0, 0
    s_nop 0
    buffer_load_dwordx4 v8, s[16:19], s50 offen lds
    s_mov_b32 m0, 4096
    s_nop 0
    buffer_load_dwordx4 v9, s[16:19], s50 offen lds
    s_mov_b32 m0, 8192
    s_nop 0
    buffer_load_dwordx4 v10, s[16:19], s50 offen lds
    s_mov_b32 m0, 12288
    s_nop 0
    buffer_load_dwordx4 v11, s[20:23], s50 offen lds
    s_mov_b32 m0, 16384
    s_nop 0
    buffer_load_dwordx4 v12, s[20:23], s50 offen lds
    s_mov_b32 s50, 128
    s_mov_b32 s51, 110592
    s_mov_b32 m0, 18432
    s_nop 0
    buffer_load_dwordx4 v8, s[16:19], s50 offen lds
    s_mov_b32 m0, 22528
    s_nop 0
    buffer_load_dwordx4 v9, s[16:19], s50 offen lds
    s_mov_b32 m0, 26624
    s_nop 0
    buffer_load_dwordx4 v10, s[16:19], s50 offen lds
    s_mov_b32 m0, 30720
    s_nop 0
    buffer_load_dwordx4 v11, s[20:23], s50 offen lds
    s_mov_b32 m0, 34816
    s_nop 0
    buffer_load_dwordx4 v12, s[20:23], s50 offen lds
    s_mov_b32 s50, 256
    s_mov_b32 s51, 221184
    s_mov_b32 m0, 36864
    s_nop 0
    buffer_load_dwordx4 v8, s[16:19], s50 offen lds
    s_mov_b32 m0, 40960
    s_nop 0
    buffer_load_dwordx4 v9, s[16:19], s50 offen lds
    s_mov_b32 m0, 45056
    s_nop 0
    buffer_load_dwordx4 v10, s[16:19], s50 offen lds
    s_mov_b32 m0, 49152
    s_nop 0
    buffer_load_dwordx4 v11, s[20:23], s50 offen lds
    s_mov_b32 m0, 53248
    s_nop 0
    buffer_load_dwordx4 v12, s[20:23], s50 offen lds
    s_mov_b32 s50, 384
    s_mov_b32 s51, 331776
    s_mov_b32 m0, 55296
    s_nop 0
    buffer_load_dwordx4 v8, s[16:19], s50 offen lds
    s_mov_b32 m0, 59392
    s_nop 0
    buffer_load_dwordx4 v9, s[16:19], s50 offen lds
    s_mov_b32 m0, 63488
    s_nop 0
    buffer_load_dwordx4 v10, s[16:19], s50 offen lds
    s_mov_b32 m0, 67584
    s_nop 0
    buffer_load_dwordx4 v11, s[20:23], s50 offen lds
    s_mov_b32 m0, 71680
    s_nop 0
    buffer_load_dwordx4 v12, s[20:23], s50 offen lds
    s_mov_b32 s50, 512
    s_mov_b32 s51, 442368
    s_mov_b32 m0, 73728
    s_nop 0
    buffer_load_dwordx4 v8, s[16:19], s50 offen lds
    s_mov_b32 m0, 77824
    s_nop 0
    buffer_load_dwordx4 v9, s[16:19], s50 offen lds
    s_mov_b32 m0, 81920
    s_nop 0
    buffer_load_dwordx4 v10, s[16:19], s50 offen lds
    s_mov_b32 m0, 86016
    s_nop 0
    buffer_load_dwordx4 v11, s[20:23], s50 offen lds
    s_mov_b32 m0, 90112
    s_nop 0
    buffer_load_dwordx4 v12, s[20:23], s50 offen lds
    s_mov_b32 s50, 640
    s_mov_b32 s51, 552960
    s_mov_b32 m0, 92160
    s_nop 0
    buffer_load_dwordx4 v8, s[16:19], s50 offen lds
    s_mov_b32 m0, 96256
    s_nop 0
    buffer_load_dwordx4 v9, s[16:19], s50 offen lds
    s_mov_b32 m0, 100352
    s_nop 0
    buffer_load_dwordx4 v10, s[16:19], s50 offen lds
    s_mov_b32 m0, 104448
    s_nop 0
    buffer_load_dwordx4 v11, s[20:23], s50 offen lds
    s_mov_b32 m0, 108544
    s_nop 0
    buffer_load_dwordx4 v12, s[20:23], s50 offen lds
    s_waitcnt vmcnt(25)
    s_barrier
    s_waitcnt vmcnt(20)
    s_barrier
    s_mov_b32 s50, 768
    s_mov_b32 s51, 663552
    s_mov_b32 m0, 110592
    s_nop 0
    buffer_load_dwordx4 v8, s[16:19], s50 offen lds
    s_mov_b32 m0, 114688
    s_nop 0
    buffer_load_dwordx4 v9, s[16:19], s50 offen lds
    s_mov_b32 m0, 118784
    s_nop 0
    buffer_load_dwordx4 v10, s[16:19], s50 offen lds
    s_mov_b32 m0, 122880
    s_nop 0
    buffer_load_dwordx4 v11, s[20:23], s50 offen lds
    s_mov_b32 m0, 126976
    s_nop 0
    buffer_load_dwordx4 v12, s[20:23], s50 offen lds
    s_waitcnt vmcnt(20)
    s_barrier
    s_mov_b32 s50, 896
    s_mov_b32 s51, 774144
    s_mov_b32 m0, 0
    s_nop 0
    buffer_load_dwordx4 v8, s[16:19], s50 offen lds
    s_mov_b32 m0, 4096
    s_nop 0
    buffer_load_dwordx4 v9, s[16:19], s50 offen lds
    s_mov_b32 m0, 8192
    s_nop 0
    buffer_load_dwordx4 v10, s[16:19], s50 offen lds
    s_mov_b32 m0, 12288
    s_nop 0
    buffer_load_dwordx4 v11, s[20:23], s50 offen lds
    s_mov_b32 m0, 16384
    s_nop 0
    buffer_load_dwordx4 v12, s[20:23], s50 offen lds
    s_waitcnt vmcnt(20)
    s_barrier
    s_mov_b32 s50, 1024
    s_mov_b32 s51, 884736
    s_mov_b32 m0, 18432
    s_nop 0
    buffer_load_dwordx4 v8, s[16:19], s50 offen lds
    s_mov_b32 m0, 22528
    s_nop 0
    buffer_load_dwordx4 v9, s[16:19], s50 offen lds
    s_mov_b32 m0, 26624
    s_nop 0
    buffer_load_dwordx4 v10, s[16:19], s50 offen lds
    s_mov_b32 m0, 30720
    s_nop 0
    buffer_load_dwordx4 v11, s[20:23], s50 offen lds
    s_mov_b32 m0, 34816
    s_nop 0
    buffer_load_dwordx4 v12, s[20:23], s50 offen lds
    s_waitcnt vmcnt(20)
    s_barrier
    s_mov_b32 s50, 1152
    s_mov_b32 s51, 995328
    s_mov_b32 m0, 36864
    s_nop 0
    buffer_load_dwordx4 v8, s[16:19], s50 offen lds
    s_mov_b32 m0, 40960
    s_nop 0
    buffer_load_dwordx4 v9, s[16:19], s50 offen lds
    s_mov_b32 m0, 45056
    s_nop 0
    buffer_load_dwordx4 v10, s[16:19], s50 offen lds
    s_mov_b32 m0, 49152
    s_nop 0
    buffer_load_dwordx4 v11, s[20:23], s50 offen lds
    s_mov_b32 m0, 53248
    s_nop 0
    buffer_load_dwordx4 v12, s[20:23], s50 offen lds
    s_waitcnt vmcnt(20)
    s_barrier
    s_mov_b32 s50, 1280
    s_mov_b32 s51, 1105920
    s_mov_b32 m0, 55296
    s_nop 0
    buffer_load_dwordx4 v8, s[16:19], s50 offen lds
    s_mov_b32 m0, 59392
    s_nop 0
    buffer_load_dwordx4 v9, s[16:19], s50 offen lds
    s_mov_b32 m0, 63488
    s_nop 0
    buffer_load_dwordx4 v10, s[16:19], s50 offen lds
    s_mov_b32 m0, 67584
    s_nop 0
    buffer_load_dwordx4 v11, s[20:23], s50 offen lds
    s_mov_b32 m0, 71680
    s_nop 0
    buffer_load_dwordx4 v12, s[20:23], s50 offen lds
    s_waitcnt vmcnt(20)
    s_barrier
    s_mov_b32 s50, 1408
    s_mov_b32 s51, 1216512
    s_mov_b32 m0, 73728
    s_nop 0
    buffer_load_dwordx4 v8, s[16:19], s50 offen lds
    s_mov_b32 m0, 77824
    s_nop 0
    buffer_load_dwordx4 v9, s[16:19], s50 offen lds
    s_mov_b32 m0, 81920
    s_nop 0
    buffer_load_dwordx4 v10, s[16:19], s50 offen lds
    s_mov_b32 m0, 86016
    s_nop 0
    buffer_load_dwordx4 v11, s[20:23], s50 offen lds
    s_mov_b32 m0, 90112
    s_nop 0
    buffer_load_dwordx4 v12, s[20:23], s50 offen lds
    s_waitcnt vmcnt(20)
    s_barrier
    s_mov_b32 s50, 1536
    s_mov_b32 s51, 1327104
    s_mov_b32 m0, 92160
    s_nop 0
    buffer_load_dwordx4 v8, s[16:19], s50 offen lds
    s_mov_b32 m0, 96256
    s_nop 0
    buffer_load_dwordx4 v9, s[16:19], s50 offen lds
    s_mov_b32 m0, 100352
    s_nop 0
    buffer_load_dwordx4 v10, s[16:19], s50 offen lds
    s_mov_b32 m0, 104448
    s_nop 0
    buffer_load_dwordx4 v11, s[20:23], s50 offen lds
    s_mov_b32 m0, 108544
    s_nop 0
    buffer_load_dwordx4 v12, s[20:23], s50 offen lds
    s_waitcnt vmcnt(20)
    s_barrier
    s_mov_b32 s50, 1664
    s_mov_b32 s51, 1437696
    s_mov_b32 m0, 110592
    s_nop 0
    buffer_load_dwordx4 v8, s[16:19], s50 offen lds
    s_mov_b32 m0, 114688
    s_nop 0
    buffer_load_dwordx4 v9, s[16:19], s50 offen lds
    s_mov_b32 m0, 118784
    s_nop 0
    buffer_load_dwordx4 v10, s[16:19], s50 offen lds
    s_mov_b32 m0, 122880
    s_nop 0
    buffer_load_dwordx4 v11, s[20:23], s50 offen lds
    s_mov_b32 m0, 126976
    s_nop 0
    buffer_load_dwordx4 v12, s[20:23], s50 offen lds
    s_waitcnt vmcnt(20)
    s_barrier
    s_waitcnt vmcnt(15)
    s_barrier
    s_waitcnt vmcnt(10)
    s_barrier
    s_waitcnt vmcnt(5)
    s_barrier
    s_waitcnt vmcnt(0)
    s_barrier
    s_branch Lend_32
Lld_37:
    v_add_u32 v6, 4, v5
    v_and_b32 v6, 7, v6
    v_xor_b32 v6, v6, v4
    v_add_u32 v7, s42, v3
    v_add_u32 v7, 8, v7
    s_mov_b32 s47, 1728
    v_mul_lo_u32 v7, v7, s47
    v_lshl_add_u32 v8, v6, 4, v7
    v_add_u32 v6, 4, v5
    v_and_b32 v6, 7, v6
    v_xor_b32 v6, v6, v4
    v_add_u32 v7, s42, v3
    v_add_u32 v7, 40, v7
    s_mov_b32 s47, 1728
    v_mul_lo_u32 v7, v7, s47
    v_lshl_add_u32 v9, v6, 4, v7
    v_add_u32 v6, 4, v5
    v_and_b32 v6, 7, v6
    v_xor_b32 v6, v6, v4
    v_add_u32 v7, s42, v3
    v_add_u32 v7, 72, v7
    s_mov_b32 s47, 1728
    v_mul_lo_u32 v7, v7, s47
    v_lshl_add_u32 v10, v6, 4, v7
    v_add_u32 v6, 4, v5
    v_and_b32 v6, 7, v6
    v_xor_b32 v6, v6, v4
    v_add_u32 v7, s43, v3
    v_add_u32 v7, 24, v7
    s_mov_b32 s47, 1728
    v_mul_lo_u32 v7, v7, s47
    v_lshl_add_u32 v11, v6, 4, v7
    v_add_u32 v6, 4, v5
    v_and_b32 v6, 7, v6
    v_xor_b32 v6, v6, v4
    v_add_u32 v7, s43, v3
    v_add_u32 v7, 56, v7
    s_mov_b32 s47, 1728
    v_mul_lo_u32 v7, v7, s47
    v_lshl_add_u32 v12, v6, 4, v7
    s_mov_b32 s50, 0
    s_mov_b32 s51, 0
    s_mov_b32 m0, 1024
    s_nop 0
    buffer_load_dwordx4 v8, s[16:19], s50 offen lds
    s_mov_b32 m0, 5120
    s_nop 0
    buffer_load_dwordx4 v9, s[16:19], s50 offen lds
    s_mov_b32 m0, 9216
    s_nop 0
    buffer_load_dwordx4 v10, s[16:19], s50 offen lds
    s_mov_b32 m0, 13312
    s_nop 0
    buffer_load_dwordx4 v11, s[20:23], s50 offen lds
    s_mov_b32 m0, 17408
    s_nop 0
    buffer_load_dwordx4 v12, s[20:23], s50 offen lds
    s_mov_b32 s50, 128
    s_mov_b32 s51, 110592
    s_mov_b32 m0, 19456
    s_nop 0
    buffer_load_dwordx4 v8, s[16:19], s50 offen lds
    s_mov_b32 m0, 23552
    s_nop 0
    buffer_load_dwordx4 v9, s[16:19], s50 offen lds
    s_mov_b32 m0, 27648
    s_nop 0
    buffer_load_dwordx4 v10, s[16:19], s50 offen lds
    s_mov_b32 m0, 31744
    s_nop 0
    buffer_load_dwordx4 v11, s[20:23], s50 offen lds
    s_mov_b32 m0, 35840
    s_nop 0
    buffer_load_dwordx4 v12, s[20:23], s50 offen lds
    s_mov_b32 s50, 256
    s_mov_b32 s51, 221184
    s_mov_b32 m0, 37888
    s_nop 0
    buffer_load_dwordx4 v8, s[16:19], s50 offen lds
    s_mov_b32 m0, 41984
    s_nop 0
    buffer_load_dwordx4 v9, s[16:19], s50 offen lds
    s_mov_b32 m0, 46080
    s_nop 0
    buffer_load_dwordx4 v10, s[16:19], s50 offen lds
    s_mov_b32 m0, 50176
    s_nop 0
    buffer_load_dwordx4 v11, s[20:23], s50 offen lds
    s_mov_b32 m0, 54272
    s_nop 0
    buffer_load_dwordx4 v12, s[20:23], s50 offen lds
    s_mov_b32 s50, 384
    s_mov_b32 s51, 331776
    s_mov_b32 m0, 56320
    s_nop 0
    buffer_load_dwordx4 v8, s[16:19], s50 offen lds
    s_mov_b32 m0, 60416
    s_nop 0
    buffer_load_dwordx4 v9, s[16:19], s50 offen lds
    s_mov_b32 m0, 64512
    s_nop 0
    buffer_load_dwordx4 v10, s[16:19], s50 offen lds
    s_mov_b32 m0, 68608
    s_nop 0
    buffer_load_dwordx4 v11, s[20:23], s50 offen lds
    s_mov_b32 m0, 72704
    s_nop 0
    buffer_load_dwordx4 v12, s[20:23], s50 offen lds
    s_mov_b32 s50, 512
    s_mov_b32 s51, 442368
    s_mov_b32 m0, 74752
    s_nop 0
    buffer_load_dwordx4 v8, s[16:19], s50 offen lds
    s_mov_b32 m0, 78848
    s_nop 0
    buffer_load_dwordx4 v9, s[16:19], s50 offen lds
    s_mov_b32 m0, 82944
    s_nop 0
    buffer_load_dwordx4 v10, s[16:19], s50 offen lds
    s_mov_b32 m0, 87040
    s_nop 0
    buffer_load_dwordx4 v11, s[20:23], s50 offen lds
    s_mov_b32 m0, 91136
    s_nop 0
    buffer_load_dwordx4 v12, s[20:23], s50 offen lds
    s_mov_b32 s50, 640
    s_mov_b32 s51, 552960
    s_mov_b32 m0, 93184
    s_nop 0
    buffer_load_dwordx4 v8, s[16:19], s50 offen lds
    s_mov_b32 m0, 97280
    s_nop 0
    buffer_load_dwordx4 v9, s[16:19], s50 offen lds
    s_mov_b32 m0, 101376
    s_nop 0
    buffer_load_dwordx4 v10, s[16:19], s50 offen lds
    s_mov_b32 m0, 105472
    s_nop 0
    buffer_load_dwordx4 v11, s[20:23], s50 offen lds
    s_mov_b32 m0, 109568
    s_nop 0
    buffer_load_dwordx4 v12, s[20:23], s50 offen lds
    s_waitcnt vmcnt(25)
    s_barrier
    s_waitcnt vmcnt(20)
    s_barrier
    s_mov_b32 s50, 768
    s_mov_b32 s51, 663552
    s_mov_b32 m0, 111616
    s_nop 0
    buffer_load_dwordx4 v8, s[16:19], s50 offen lds
    s_mov_b32 m0, 115712
    s_nop 0
    buffer_load_dwordx4 v9, s[16:19], s50 offen lds
    s_mov_b32 m0, 119808
    s_nop 0
    buffer_load_dwordx4 v10, s[16:19], s50 offen lds
    s_mov_b32 m0, 123904
    s_nop 0
    buffer_load_dwordx4 v11, s[20:23], s50 offen lds
    s_mov_b32 m0, 128000
    s_nop 0
    buffer_load_dwordx4 v12, s[20:23], s50 offen lds
    s_waitcnt vmcnt(20)
    s_barrier
    s_mov_b32 s50, 896
    s_mov_b32 s51, 774144
    s_mov_b32 m0, 1024
    s_nop 0
    buffer_load_dwordx4 v8, s[16:19], s50 offen lds
    s_mov_b32 m0, 5120
    s_nop 0
    buffer_load_dwordx4 v9, s[16:19], s50 offen lds
    s_mov_b32 m0, 9216
    s_nop 0
    buffer_load_dwordx4 v10, s[16:19], s50 offen lds
    s_mov_b32 m0, 13312
    s_nop 0
    buffer_load_dwordx4 v11, s[20:23], s50 offen lds
    s_mov_b32 m0, 17408
    s_nop 0
    buffer_load_dwordx4 v12, s[20:23], s50 offen lds
    s_waitcnt vmcnt(20)
    s_barrier
    s_mov_b32 s50, 1024
    s_mov_b32 s51, 884736
    s_mov_b32 m0, 19456
    s_nop 0
    buffer_load_dwordx4 v8, s[16:19], s50 offen lds
    s_mov_b32 m0, 23552
    s_nop 0
    buffer_load_dwordx4 v9, s[16:19], s50 offen lds
    s_mov_b32 m0, 27648
    s_nop 0
    buffer_load_dwordx4 v10, s[16:19], s50 offen lds
    s_mov_b32 m0, 31744
    s_nop 0
    buffer_load_dwordx4 v11, s[20:23], s50 offen lds
    s_mov_b32 m0, 35840
    s_nop 0
    buffer_load_dwordx4 v12, s[20:23], s50 offen lds
    s_waitcnt vmcnt(20)
    s_barrier
    s_mov_b32 s50, 1152
    s_mov_b32 s51, 995328
    s_mov_b32 m0, 37888
    s_nop 0
    buffer_load_dwordx4 v8, s[16:19], s50 offen lds
    s_mov_b32 m0, 41984
    s_nop 0
    buffer_load_dwordx4 v9, s[16:19], s50 offen lds
    s_mov_b32 m0, 46080
    s_nop 0
    buffer_load_dwordx4 v10, s[16:19], s50 offen lds
    s_mov_b32 m0, 50176
    s_nop 0
    buffer_load_dwordx4 v11, s[20:23], s50 offen lds
    s_mov_b32 m0, 54272
    s_nop 0
    buffer_load_dwordx4 v12, s[20:23], s50 offen lds
    s_waitcnt vmcnt(20)
    s_barrier
    s_mov_b32 s50, 1280
    s_mov_b32 s51, 1105920
    s_mov_b32 m0, 56320
    s_nop 0
    buffer_load_dwordx4 v8, s[16:19], s50 offen lds
    s_mov_b32 m0, 60416
    s_nop 0
    buffer_load_dwordx4 v9, s[16:19], s50 offen lds
    s_mov_b32 m0, 64512
    s_nop 0
    buffer_load_dwordx4 v10, s[16:19], s50 offen lds
    s_mov_b32 m0, 68608
    s_nop 0
    buffer_load_dwordx4 v11, s[20:23], s50 offen lds
    s_mov_b32 m0, 72704
    s_nop 0
    buffer_load_dwordx4 v12, s[20:23], s50 offen lds
    s_waitcnt vmcnt(20)
    s_barrier
    s_mov_b32 s50, 1408
    s_mov_b32 s51, 1216512
    s_mov_b32 m0, 74752
    s_nop 0
    buffer_load_dwordx4 v8, s[16:19], s50 offen lds
    s_mov_b32 m0, 78848
    s_nop 0
    buffer_load_dwordx4 v9, s[16:19], s50 offen lds
    s_mov_b32 m0, 82944
    s_nop 0
    buffer_load_dwordx4 v10, s[16:19], s50 offen lds
    s_mov_b32 m0, 87040
    s_nop 0
    buffer_load_dwordx4 v11, s[20:23], s50 offen lds
    s_mov_b32 m0, 91136
    s_nop 0
    buffer_load_dwordx4 v12, s[20:23], s50 offen lds
    s_waitcnt vmcnt(20)
    s_barrier
    s_mov_b32 s50, 1536
    s_mov_b32 s51, 1327104
    s_mov_b32 m0, 93184
    s_nop 0
    buffer_load_dwordx4 v8, s[16:19], s50 offen lds
    s_mov_b32 m0, 97280
    s_nop 0
    buffer_load_dwordx4 v9, s[16:19], s50 offen lds
    s_mov_b32 m0, 101376
    s_nop 0
    buffer_load_dwordx4 v10, s[16:19], s50 offen lds
    s_mov_b32 m0, 105472
    s_nop 0
    buffer_load_dwordx4 v11, s[20:23], s50 offen lds
    s_mov_b32 m0, 109568
    s_nop 0
    buffer_load_dwordx4 v12, s[20:23], s50 offen lds
    s_waitcnt vmcnt(20)
    s_barrier
    s_mov_b32 s50, 1664
    s_mov_b32 s51, 1437696
    s_mov_b32 m0, 111616
    s_nop 0
    buffer_load_dwordx4 v8, s[16:19], s50 offen lds
    s_mov_b32 m0, 115712
    s_nop 0
    buffer_load_dwordx4 v9, s[16:19], s50 offen lds
    s_mov_b32 m0, 119808
    s_nop 0
    buffer_load_dwordx4 v10, s[16:19], s50 offen lds
    s_mov_b32 m0, 123904
    s_nop 0
    buffer_load_dwordx4 v11, s[20:23], s50 offen lds
    s_mov_b32 m0, 128000
    s_nop 0
    buffer_load_dwordx4 v12, s[20:23], s50 offen lds
    s_waitcnt vmcnt(20)
    s_barrier
    s_waitcnt vmcnt(15)
    s_barrier
    s_waitcnt vmcnt(10)
    s_barrier
    s_waitcnt vmcnt(5)
    s_barrier
    s_waitcnt vmcnt(0)
    s_barrier
    s_branch Lend_32
Lld_38:
    v_add_u32 v6, 0, v5
    v_and_b32 v6, 7, v6
    v_xor_b32 v6, v6, v4
    v_add_u32 v7, s42, v3
    v_add_u32 v7, 16, v7
    s_mov_b32 s47, 1728
    v_mul_lo_u32 v7, v7, s47
    v_lshl_add_u32 v8, v6, 4, v7
    v_add_u32 v6, 0, v5
    v_and_b32 v6, 7, v6
    v_xor_b32 v6, v6, v4
    v_add_u32 v7, s42, v3
    v_add_u32 v7, 48, v7
    s_mov_b32 s47, 1728
    v_mul_lo_u32 v7, v7, s47
    v_lshl_add_u32 v9, v6, 4, v7
    v_add_u32 v6, 0, v5
    v_and_b32 v6, 7, v6
    v_xor_b32 v6, v6, v4
    v_add_u32 v7, s43, v3
    s_mov_b32 s47, 1728
    v_mul_lo_u32 v7, v7, s47
    v_lshl_add_u32 v10, v6, 4, v7
    v_add_u32 v6, 0, v5
    v_and_b32 v6, 7, v6
    v_xor_b32 v6, v6, v4
    v_add_u32 v7, s43, v3
    v_add_u32 v7, 32, v7
    s_mov_b32 s47, 1728
    v_mul_lo_u32 v7, v7, s47
    v_lshl_add_u32 v11, v6, 4, v7
    s_mov_b32 s50, 0
    s_mov_b32 s51, 0
    s_mov_b32 m0, 2048
    s_nop 0
    buffer_load_dwordx4 v8, s[16:19], s50 offen lds
    s_mov_b32 m0, 6144
    s_nop 0
    buffer_load_dwordx4 v9, s[16:19], s50 offen lds
    s_mov_b32 m0, 10240
    s_nop 0
    buffer_load_dwordx4 v10, s[20:23], s50 offen lds
    s_mov_b32 m0, 14336
    s_nop 0
    buffer_load_dwordx4 v11, s[20:23], s50 offen lds
    s_mov_b32 s50, 128
    s_mov_b32 s51, 110592
    s_mov_b32 m0, 20480
    s_nop 0
    buffer_load_dwordx4 v8, s[16:19], s50 offen lds
    s_mov_b32 m0, 24576
    s_nop 0
    buffer_load_dwordx4 v9, s[16:19], s50 offen lds
    s_mov_b32 m0, 28672
    s_nop 0
    buffer_load_dwordx4 v10, s[20:23], s50 offen lds
    s_mov_b32 m0, 32768
    s_nop 0
    buffer_load_dwordx4 v11, s[20:23], s50 offen lds
    s_mov_b32 s50, 256
    s_mov_b32 s51, 221184
    s_mov_b32 m0, 38912
    s_nop 0
    buffer_load_dwordx4 v8, s[16:19], s50 offen lds
    s_mov_b32 m0, 43008
    s_nop 0
    buffer_load_dwordx4 v9, s[16:19], s50 offen lds
    s_mov_b32 m0, 47104
    s_nop 0
    buffer_load_dwordx4 v10, s[20:23], s50 offen lds
    s_mov_b32 m0, 51200
    s_nop 0
    buffer_load_dwordx4 v11, s[20:23], s50 offen lds
    s_mov_b32 s50, 384
    s_mov_b32 s51, 331776
    s_mov_b32 m0, 57344
    s_nop 0
    buffer_load_dwordx4 v8, s[16:19], s50 offen lds
    s_mov_b32 m0, 61440
    s_nop 0
    buffer_load_dwordx4 v9, s[16:19], s50 offen lds
    s_mov_b32 m0, 65536
    s_nop 0
    buffer_load_dwordx4 v10, s[20:23], s50 offen lds
    s_mov_b32 m0, 69632
    s_nop 0
    buffer_load_dwordx4 v11, s[20:23], s50 offen lds
    s_mov_b32 s50, 512
    s_mov_b32 s51, 442368
    s_mov_b32 m0, 75776
    s_nop 0
    buffer_load_dwordx4 v8, s[16:19], s50 offen lds
    s_mov_b32 m0, 79872
    s_nop 0
    buffer_load_dwordx4 v9, s[16:19], s50 offen lds
    s_mov_b32 m0, 83968
    s_nop 0
    buffer_load_dwordx4 v10, s[20:23], s50 offen lds
    s_mov_b32 m0, 88064
    s_nop 0
    buffer_load_dwordx4 v11, s[20:23], s50 offen lds
    s_mov_b32 s50, 640
    s_mov_b32 s51, 552960
    s_mov_b32 m0, 94208
    s_nop 0
    buffer_load_dwordx4 v8, s[16:19], s50 offen lds
    s_mov_b32 m0, 98304
    s_nop 0
    buffer_load_dwordx4 v9, s[16:19], s50 offen lds
    s_mov_b32 m0, 102400
    s_nop 0
    buffer_load_dwordx4 v10, s[20:23], s50 offen lds
    s_mov_b32 m0, 106496
    s_nop 0
    buffer_load_dwordx4 v11, s[20:23], s50 offen lds
    s_waitcnt vmcnt(20)
    s_barrier
    s_waitcnt vmcnt(16)
    s_barrier
    s_mov_b32 s50, 768
    s_mov_b32 s51, 663552
    s_mov_b32 m0, 112640
    s_nop 0
    buffer_load_dwordx4 v8, s[16:19], s50 offen lds
    s_mov_b32 m0, 116736
    s_nop 0
    buffer_load_dwordx4 v9, s[16:19], s50 offen lds
    s_mov_b32 m0, 120832
    s_nop 0
    buffer_load_dwordx4 v10, s[20:23], s50 offen lds
    s_mov_b32 m0, 124928
    s_nop 0
    buffer_load_dwordx4 v11, s[20:23], s50 offen lds
    s_waitcnt vmcnt(16)
    s_barrier
    s_mov_b32 s50, 896
    s_mov_b32 s51, 774144
    s_mov_b32 m0, 2048
    s_nop 0
    buffer_load_dwordx4 v8, s[16:19], s50 offen lds
    s_mov_b32 m0, 6144
    s_nop 0
    buffer_load_dwordx4 v9, s[16:19], s50 offen lds
    s_mov_b32 m0, 10240
    s_nop 0
    buffer_load_dwordx4 v10, s[20:23], s50 offen lds
    s_mov_b32 m0, 14336
    s_nop 0
    buffer_load_dwordx4 v11, s[20:23], s50 offen lds
    s_waitcnt vmcnt(16)
    s_barrier
    s_mov_b32 s50, 1024
    s_mov_b32 s51, 884736
    s_mov_b32 m0, 20480
    s_nop 0
    buffer_load_dwordx4 v8, s[16:19], s50 offen lds
    s_mov_b32 m0, 24576
    s_nop 0
    buffer_load_dwordx4 v9, s[16:19], s50 offen lds
    s_mov_b32 m0, 28672
    s_nop 0
    buffer_load_dwordx4 v10, s[20:23], s50 offen lds
    s_mov_b32 m0, 32768
    s_nop 0
    buffer_load_dwordx4 v11, s[20:23], s50 offen lds
    s_waitcnt vmcnt(16)
    s_barrier
    s_mov_b32 s50, 1152
    s_mov_b32 s51, 995328
    s_mov_b32 m0, 38912
    s_nop 0
    buffer_load_dwordx4 v8, s[16:19], s50 offen lds
    s_mov_b32 m0, 43008
    s_nop 0
    buffer_load_dwordx4 v9, s[16:19], s50 offen lds
    s_mov_b32 m0, 47104
    s_nop 0
    buffer_load_dwordx4 v10, s[20:23], s50 offen lds
    s_mov_b32 m0, 51200
    s_nop 0
    buffer_load_dwordx4 v11, s[20:23], s50 offen lds
    s_waitcnt vmcnt(16)
    s_barrier
    s_mov_b32 s50, 1280
    s_mov_b32 s51, 1105920
    s_mov_b32 m0, 57344
    s_nop 0
    buffer_load_dwordx4 v8, s[16:19], s50 offen lds
    s_mov_b32 m0, 61440
    s_nop 0
    buffer_load_dwordx4 v9, s[16:19], s50 offen lds
    s_mov_b32 m0, 65536
    s_nop 0
    buffer_load_dwordx4 v10, s[20:23], s50 offen lds
    s_mov_b32 m0, 69632
    s_nop 0
    buffer_load_dwordx4 v11, s[20:23], s50 offen lds
    s_waitcnt vmcnt(16)
    s_barrier
    s_mov_b32 s50, 1408
    s_mov_b32 s51, 1216512
    s_mov_b32 m0, 75776
    s_nop 0
    buffer_load_dwordx4 v8, s[16:19], s50 offen lds
    s_mov_b32 m0, 79872
    s_nop 0
    buffer_load_dwordx4 v9, s[16:19], s50 offen lds
    s_mov_b32 m0, 83968
    s_nop 0
    buffer_load_dwordx4 v10, s[20:23], s50 offen lds
    s_mov_b32 m0, 88064
    s_nop 0
    buffer_load_dwordx4 v11, s[20:23], s50 offen lds
    s_waitcnt vmcnt(16)
    s_barrier
    s_mov_b32 s50, 1536
    s_mov_b32 s51, 1327104
    s_mov_b32 m0, 94208
    s_nop 0
    buffer_load_dwordx4 v8, s[16:19], s50 offen lds
    s_mov_b32 m0, 98304
    s_nop 0
    buffer_load_dwordx4 v9, s[16:19], s50 offen lds
    s_mov_b32 m0, 102400
    s_nop 0
    buffer_load_dwordx4 v10, s[20:23], s50 offen lds
    s_mov_b32 m0, 106496
    s_nop 0
    buffer_load_dwordx4 v11, s[20:23], s50 offen lds
    s_waitcnt vmcnt(16)
    s_barrier
    s_mov_b32 s50, 1664
    s_mov_b32 s51, 1437696
    s_mov_b32 m0, 112640
    s_nop 0
    buffer_load_dwordx4 v8, s[16:19], s50 offen lds
    s_mov_b32 m0, 116736
    s_nop 0
    buffer_load_dwordx4 v9, s[16:19], s50 offen lds
    s_mov_b32 m0, 120832
    s_nop 0
    buffer_load_dwordx4 v10, s[20:23], s50 offen lds
    s_mov_b32 m0, 124928
    s_nop 0
    buffer_load_dwordx4 v11, s[20:23], s50 offen lds
    s_waitcnt vmcnt(16)
    s_barrier
    s_waitcnt vmcnt(12)
    s_barrier
    s_waitcnt vmcnt(8)
    s_barrier
    s_waitcnt vmcnt(4)
    s_barrier
    s_waitcnt vmcnt(0)
    s_barrier
    s_branch Lend_32
Lld_39:
    v_add_u32 v6, 4, v5
    v_and_b32 v6, 7, v6
    v_xor_b32 v6, v6, v4
    v_add_u32 v7, s42, v3
    v_add_u32 v7, 24, v7
    s_mov_b32 s47, 1728
    v_mul_lo_u32 v7, v7, s47
    v_lshl_add_u32 v8, v6, 4, v7
    v_add_u32 v6, 4, v5
    v_and_b32 v6, 7, v6
    v_xor_b32 v6, v6, v4
    v_add_u32 v7, s42, v3
    v_add_u32 v7, 56, v7
    s_mov_b32 s47, 1728
    v_mul_lo_u32 v7, v7, s47
    v_lshl_add_u32 v9, v6, 4, v7
    v_add_u32 v6, 4, v5
    v_and_b32 v6, 7, v6
    v_xor_b32 v6, v6, v4
    v_add_u32 v7, s43, v3
    v_add_u32 v7, 8, v7
    s_mov_b32 s47, 1728
    v_mul_lo_u32 v7, v7, s47
    v_lshl_add_u32 v10, v6, 4, v7
    v_add_u32 v6, 4, v5
    v_and_b32 v6, 7, v6
    v_xor_b32 v6, v6, v4
    v_add_u32 v7, s43, v3
    v_add_u32 v7, 40, v7
    s_mov_b32 s47, 1728
    v_mul_lo_u32 v7, v7, s47
    v_lshl_add_u32 v11, v6, 4, v7
    s_mov_b32 s50, 0
    s_mov_b32 s51, 0
    s_mov_b32 m0, 3072
    s_nop 0
    buffer_load_dwordx4 v8, s[16:19], s50 offen lds
    s_mov_b32 m0, 7168
    s_nop 0
    buffer_load_dwordx4 v9, s[16:19], s50 offen lds
    s_mov_b32 m0, 11264
    s_nop 0
    buffer_load_dwordx4 v10, s[20:23], s50 offen lds
    s_mov_b32 m0, 15360
    s_nop 0
    buffer_load_dwordx4 v11, s[20:23], s50 offen lds
    s_mov_b32 s50, 128
    s_mov_b32 s51, 110592
    s_mov_b32 m0, 21504
    s_nop 0
    buffer_load_dwordx4 v8, s[16:19], s50 offen lds
    s_mov_b32 m0, 25600
    s_nop 0
    buffer_load_dwordx4 v9, s[16:19], s50 offen lds
    s_mov_b32 m0, 29696
    s_nop 0
    buffer_load_dwordx4 v10, s[20:23], s50 offen lds
    s_mov_b32 m0, 33792
    s_nop 0
    buffer_load_dwordx4 v11, s[20:23], s50 offen lds
    s_mov_b32 s50, 256
    s_mov_b32 s51, 221184
    s_mov_b32 m0, 39936
    s_nop 0
    buffer_load_dwordx4 v8, s[16:19], s50 offen lds
    s_mov_b32 m0, 44032
    s_nop 0
    buffer_load_dwordx4 v9, s[16:19], s50 offen lds
    s_mov_b32 m0, 48128
    s_nop 0
    buffer_load_dwordx4 v10, s[20:23], s50 offen lds
    s_mov_b32 m0, 52224
    s_nop 0
    buffer_load_dwordx4 v11, s[20:23], s50 offen lds
    s_mov_b32 s50, 384
    s_mov_b32 s51, 331776
    s_mov_b32 m0, 58368
    s_nop 0
    buffer_load_dwordx4 v8, s[16:19], s50 offen lds
    s_mov_b32 m0, 62464
    s_nop 0
    buffer_load_dwordx4 v9, s[16:19], s50 offen lds
    s_mov_b32 m0, 66560
    s_nop 0
    buffer_load_dwordx4 v10, s[20:23], s50 offen lds
    s_mov_b32 m0, 70656
    s_nop 0
    buffer_load_dwordx4 v11, s[20:23], s50 offen lds
    s_mov_b32 s50, 512
    s_mov_b32 s51, 442368
    s_mov_b32 m0, 76800
    s_nop 0
    buffer_load_dwordx4 v8, s[16:19], s50 offen lds
    s_mov_b32 m0, 80896
    s_nop 0
    buffer_load_dwordx4 v9, s[16:19], s50 offen lds
    s_mov_b32 m0, 84992
    s_nop 0
    buffer_load_dwordx4 v10, s[20:23], s50 offen lds
    s_mov_b32 m0, 89088
    s_nop 0
    buffer_load_dwordx4 v11, s[20:23], s50 offen lds
    s_mov_b32 s50, 640
    s_mov_b32 s51, 552960
    s_mov_b32 m0, 95232
    s_nop 0
    buffer_load_dwordx4 v8, s[16:19], s50 offen lds
    s_mov_b32 m0, 99328
    s_nop 0
    buffer_load_dwordx4 v9, s[16:19], s50 offen lds
    s_mov_b32 m0, 103424
    s_nop 0
    buffer_load_dwordx4 v10, s[20:23], s50 offen lds
    s_mov_b32 m0, 107520
    s_nop 0
    buffer_load_dwordx4 v11, s[20:23], s50 offen lds
    s_waitcnt vmcnt(20)
    s_barrier
    s_waitcnt vmcnt(16)
    s_barrier
    s_mov_b32 s50, 768
    s_mov_b32 s51, 663552
    s_mov_b32 m0, 113664
    s_nop 0
    buffer_load_dwordx4 v8, s[16:19], s50 offen lds
    s_mov_b32 m0, 117760
    s_nop 0
    buffer_load_dwordx4 v9, s[16:19], s50 offen lds
    s_mov_b32 m0, 121856
    s_nop 0
    buffer_load_dwordx4 v10, s[20:23], s50 offen lds
    s_mov_b32 m0, 125952
    s_nop 0
    buffer_load_dwordx4 v11, s[20:23], s50 offen lds
    s_waitcnt vmcnt(16)
    s_barrier
    s_mov_b32 s50, 896
    s_mov_b32 s51, 774144
    s_mov_b32 m0, 3072
    s_nop 0
    buffer_load_dwordx4 v8, s[16:19], s50 offen lds
    s_mov_b32 m0, 7168
    s_nop 0
    buffer_load_dwordx4 v9, s[16:19], s50 offen lds
    s_mov_b32 m0, 11264
    s_nop 0
    buffer_load_dwordx4 v10, s[20:23], s50 offen lds
    s_mov_b32 m0, 15360
    s_nop 0
    buffer_load_dwordx4 v11, s[20:23], s50 offen lds
    s_waitcnt vmcnt(16)
    s_barrier
    s_mov_b32 s50, 1024
    s_mov_b32 s51, 884736
    s_mov_b32 m0, 21504
    s_nop 0
    buffer_load_dwordx4 v8, s[16:19], s50 offen lds
    s_mov_b32 m0, 25600
    s_nop 0
    buffer_load_dwordx4 v9, s[16:19], s50 offen lds
    s_mov_b32 m0, 29696
    s_nop 0
    buffer_load_dwordx4 v10, s[20:23], s50 offen lds
    s_mov_b32 m0, 33792
    s_nop 0
    buffer_load_dwordx4 v11, s[20:23], s50 offen lds
    s_waitcnt vmcnt(16)
    s_barrier
    s_mov_b32 s50, 1152
    s_mov_b32 s51, 995328
    s_mov_b32 m0, 39936
    s_nop 0
    buffer_load_dwordx4 v8, s[16:19], s50 offen lds
    s_mov_b32 m0, 44032
    s_nop 0
    buffer_load_dwordx4 v9, s[16:19], s50 offen lds
    s_mov_b32 m0, 48128
    s_nop 0
    buffer_load_dwordx4 v10, s[20:23], s50 offen lds
    s_mov_b32 m0, 52224
    s_nop 0
    buffer_load_dwordx4 v11, s[20:23], s50 offen lds
    s_waitcnt vmcnt(16)
    s_barrier
    s_mov_b32 s50, 1280
    s_mov_b32 s51, 1105920
    s_mov_b32 m0, 58368
    s_nop 0
    buffer_load_dwordx4 v8, s[16:19], s50 offen lds
    s_mov_b32 m0, 62464
    s_nop 0
    buffer_load_dwordx4 v9, s[16:19], s50 offen lds
    s_mov_b32 m0, 66560
    s_nop 0
    buffer_load_dwordx4 v10, s[20:23], s50 offen lds
    s_mov_b32 m0, 70656
    s_nop 0
    buffer_load_dwordx4 v11, s[20:23], s50 offen lds
    s_waitcnt vmcnt(16)
    s_barrier
    s_mov_b32 s50, 1408
    s_mov_b32 s51, 1216512
    s_mov_b32 m0, 76800
    s_nop 0
    buffer_load_dwordx4 v8, s[16:19], s50 offen lds
    s_mov_b32 m0, 80896
    s_nop 0
    buffer_load_dwordx4 v9, s[16:19], s50 offen lds
    s_mov_b32 m0, 84992
    s_nop 0
    buffer_load_dwordx4 v10, s[20:23], s50 offen lds
    s_mov_b32 m0, 89088
    s_nop 0
    buffer_load_dwordx4 v11, s[20:23], s50 offen lds
    s_waitcnt vmcnt(16)
    s_barrier
    s_mov_b32 s50, 1536
    s_mov_b32 s51, 1327104
    s_mov_b32 m0, 95232
    s_nop 0
    buffer_load_dwordx4 v8, s[16:19], s50 offen lds
    s_mov_b32 m0, 99328
    s_nop 0
    buffer_load_dwordx4 v9, s[16:19], s50 offen lds
    s_mov_b32 m0, 103424
    s_nop 0
    buffer_load_dwordx4 v10, s[20:23], s50 offen lds
    s_mov_b32 m0, 107520
    s_nop 0
    buffer_load_dwordx4 v11, s[20:23], s50 offen lds
    s_waitcnt vmcnt(16)
    s_barrier
    s_mov_b32 s50, 1664
    s_mov_b32 s51, 1437696
    s_mov_b32 m0, 113664
    s_nop 0
    buffer_load_dwordx4 v8, s[16:19], s50 offen lds
    s_mov_b32 m0, 117760
    s_nop 0
    buffer_load_dwordx4 v9, s[16:19], s50 offen lds
    s_mov_b32 m0, 121856
    s_nop 0
    buffer_load_dwordx4 v10, s[20:23], s50 offen lds
    s_mov_b32 m0, 125952
    s_nop 0
    buffer_load_dwordx4 v11, s[20:23], s50 offen lds
    s_waitcnt vmcnt(16)
    s_barrier
    s_waitcnt vmcnt(12)
    s_barrier
    s_waitcnt vmcnt(8)
    s_barrier
    s_waitcnt vmcnt(4)
    s_barrier
    s_waitcnt vmcnt(0)
    s_barrier
    s_branch Lend_32
Lpf_35:
Lend_32:
    s_endpgm
.p2align 8
.type g3b_kernel,@function
g3b_kernel:
    s_cmp_ge_u32 s2, 256
    s_cbranch_scc1 Lend_40
    s_load_dwordx2 s[4:5], s[0:1], 104
    s_load_dwordx2 s[6:7], s[0:1], 88
    s_and_b32 s40, s2, 7
    s_lshr_b32 s41, s2, 3
    s_and_b32 s42, s40, 1
    s_lshr_b32 s43, s40, 1
    s_mov_b32 s45, 0x40000001
    s_mul_hi_u32 s46, s41, s45
    s_mul_i32 s45, s46, 4
    s_sub_u32 s45, s41, s45
    s_mul_i32 s42, s42, 4
    s_add_u32 s42, s42, s45
    s_mul_i32 s43, s43, 8
    s_add_u32 s43, s43, s46
    s_cmp_ge_u32 s42, 8
    s_cbranch_scc1 Lend_40
    s_mov_b32 s39, s42
    s_mul_i32 s42, s42, 80
    s_mul_i32 s43, s43, 64
    v_lshrrev_b32 v1, 6, v0
    s_nop 0
    v_readfirstlane_b32 s44, v1
    v_and_b32 v2, 63, v0
    v_lshrrev_b32 v5, 4, v2
    s_waitcnt lgkmcnt(0)
    s_cmp_ge_u32 s44, 8
    s_cbranch_scc1 Lpf_43
    s_cmp_ge_u32 s44, 4
    s_cbranch_scc1 Lload_41
    v_and_b32 v3, 15, v2
    v_lshrrev_b32 v4, 1, v3
    v_and_b32 v4, 7, v4
    v_xor_b32 v4, v4, v5
    v_lshlrev_b32 v4, 4, v4
    v_lshl_add_u32 v4, v3, 7, v4
    s_and_b32 s45, s44, 0
    s_lshr_b32 s46, s44, 0
    s_mul_i32 s47, s45, 10240
    s_mul_i32 s48, s46, 2048
    s_add_u32 s48, s48, 10240
    v_add_u32 v8, s47, v4
    v_add_u32 v9, s47, v4
    v_add_u32 v9, 36864, v9
    v_add_u32 v10, s47, v4
    v_add_u32 v10, 73728, v10
    v_add_u32 v11, s47, v4
    v_add_u32 v11, 110592, v11
    v_add_u32 v12, s47, v4
    v_xor_b32 v12, 64, v12
    v_add_u32 v13, s47, v4
    v_xor_b32 v13, 64, v13
    v_add_u32 v13, 36864, v13
    v_add_u32 v14, s47, v4
    v_xor_b32 v14, 64, v14
    v_add_u32 v14, 73728, v14
    v_add_u32 v15, s47, v4
    v_xor_b32 v15, 64, v15
    v_add_u32 v15, 110592, v15
    v_add_u32 v16, s48, v4
    v_add_u32 v17, s48, v4
    v_add_u32 v17, 36864, v17
    v_add_u32 v18, s48, v4
    v_add_u32 v18, 73728, v18
    v_add_u32 v19, s48, v4
    v_add_u32 v19, 110592, v19
    v_add_u32 v20, s48, v4
    v_xor_b32 v20, 64, v20
    v_add_u32 v21, s48, v4
    v_xor_b32 v21, 64, v21
    v_add_u32 v21, 36864, v21
    v_add_u32 v22, s48, v4
    v_xor_b32 v22, 64, v22
    v_add_u32 v22, 73728, v22
    v_add_u32 v23, s48, v4
    v_xor_b32 v23, 64, v23
    v_add_u32 v23, 110592, v23
    v_mov_b32 v72, 0
    v_mov_b32 v73, 0
    v_mov_b32 v74, 0
    v_mov_b32 v75, 0
    v_mov_b32 v76, 0
    v_mov_b32 v77, 0
    v_mov_b32 v78, 0
    v_mov_b32 v79, 0
    v_mov_b32 v80, 0
    v_mov_b32 v81, 0
    v_mov_b32 v82, 0
    v_mov_b32 v83, 0
    v_mov_b32 v84, 0
    v_mov_b32 v85, 0
    v_mov_b32 v86, 0
    v_mov_b32 v87, 0
    v_mov_b32 v88, 0
    v_mov_b32 v89, 0
    v_mov_b32 v90, 0
    v_mov_b32 v91, 0
    v_and_b32 v3, 15, v2
    s_mul_i32 s47, s46, 16
    s_add_u32 s47, s47, s43
    v_add_u32 v3, s47, v3
    v_lshrrev_b32 v4, 4, v2
    v_lshlrev_b32 v4, 2, v4
    s_mul_i32 s47, s45, 80
    s_add_u32 s47, s47, s42
    v_add_u32 v4, s47, v4
    s_barrier
    ds_read_b128 v[24:27], v8 offset:0
    ds_read_b128 v[64:67], v16 offset:0
    ds_read_b128 v[28:31], v8 offset:2048
    ds_read_b128 v[32:35], v8 offset:4096
    ds_read_b128 v[36:39], v8 offset:6144
    ds_read_b128 v[40:43], v8 offset:8192
    ds_read_b128 v[44:47], v12 offset:0
    ds_read_b128 v[68:71], v20 offset:0
    ds_read_b128 v[48:51], v12 offset:2048
    ds_read_b128 v[52:55], v12 offset:4096
    ds_read_b128 v[56:59], v12 offset:6144
    ds_read_b128 v[60:63], v12 offset:8192
    s_waitcnt lgkmcnt(6)
    v_mfma_f32_16x16x32_bf16 v[72:75], v[24:27], v[64:67], v[72:75]
    v_mfma_f32_16x16x32_bf16 v[76:79], v[28:31], v[64:67], v[76:79]
    v_mfma_f32_16x16x32_bf16 v[80:83], v[32:35], v[64:67], v[80:83]
    v_mfma_f32_16x16x32_bf16 v[84:87], v[36:39], v[64:67], v[84:87]
    v_mfma_f32_16x16x32_bf16 v[88:91], v[40:43], v[64:67], v[88:91]
    s_waitcnt lgkmcnt(0)
    s_barrier
    ds_read_b128 v[24:27], v8 offset:18432
    ds_read_b128 v[64:67], v16 offset:18432
    ds_read_b128 v[28:31], v8 offset:20480
    ds_read_b128 v[32:35], v8 offset:22528
    ds_read_b128 v[36:39], v8 offset:24576
    ds_read_b128 v[40:43], v8 offset:26624
    v_mfma_f32_16x16x32_bf16 v[72:75], v[44:47], v[68:71], v[72:75]
    v_mfma_f32_16x16x32_bf16 v[76:79], v[48:51], v[68:71], v[76:79]
    v_mfma_f32_16x16x32_bf16 v[80:83], v[52:55], v[68:71], v[80:83]
    v_mfma_f32_16x16x32_bf16 v[84:87], v[56:59], v[68:71], v[84:87]
    v_mfma_f32_16x16x32_bf16 v[88:91], v[60:63], v[68:71], v[88:91]
    ds_read_b128 v[44:47], v12 offset:18432
    ds_read_b128 v[68:71], v20 offset:18432
    ds_read_b128 v[48:51], v12 offset:20480
    ds_read_b128 v[52:55], v12 offset:22528
    ds_read_b128 v[56:59], v12 offset:24576
    ds_read_b128 v[60:63], v12 offset:26624
    s_waitcnt lgkmcnt(6)
    v_mfma_f32_16x16x32_bf16 v[72:75], v[24:27], v[64:67], v[72:75]
    v_mfma_f32_16x16x32_bf16 v[76:79], v[28:31], v[64:67], v[76:79]
    v_mfma_f32_16x16x32_bf16 v[80:83], v[32:35], v[64:67], v[80:83]
    v_mfma_f32_16x16x32_bf16 v[84:87], v[36:39], v[64:67], v[84:87]
    v_mfma_f32_16x16x32_bf16 v[88:91], v[40:43], v[64:67], v[88:91]
    s_waitcnt lgkmcnt(0)
    s_barrier
    ds_read_b128 v[24:27], v9 offset:0
    ds_read_b128 v[64:67], v17 offset:0
    ds_read_b128 v[28:31], v9 offset:2048
    ds_read_b128 v[32:35], v9 offset:4096
    ds_read_b128 v[36:39], v9 offset:6144
    ds_read_b128 v[40:43], v9 offset:8192
    v_mfma_f32_16x16x32_bf16 v[72:75], v[44:47], v[68:71], v[72:75]
    v_mfma_f32_16x16x32_bf16 v[76:79], v[48:51], v[68:71], v[76:79]
    v_mfma_f32_16x16x32_bf16 v[80:83], v[52:55], v[68:71], v[80:83]
    v_mfma_f32_16x16x32_bf16 v[84:87], v[56:59], v[68:71], v[84:87]
    v_mfma_f32_16x16x32_bf16 v[88:91], v[60:63], v[68:71], v[88:91]
    ds_read_b128 v[44:47], v13 offset:0
    ds_read_b128 v[68:71], v21 offset:0
    ds_read_b128 v[48:51], v13 offset:2048
    ds_read_b128 v[52:55], v13 offset:4096
    ds_read_b128 v[56:59], v13 offset:6144
    ds_read_b128 v[60:63], v13 offset:8192
    s_waitcnt lgkmcnt(6)
    v_mfma_f32_16x16x32_bf16 v[72:75], v[24:27], v[64:67], v[72:75]
    v_mfma_f32_16x16x32_bf16 v[76:79], v[28:31], v[64:67], v[76:79]
    v_mfma_f32_16x16x32_bf16 v[80:83], v[32:35], v[64:67], v[80:83]
    v_mfma_f32_16x16x32_bf16 v[84:87], v[36:39], v[64:67], v[84:87]
    v_mfma_f32_16x16x32_bf16 v[88:91], v[40:43], v[64:67], v[88:91]
    s_waitcnt lgkmcnt(0)
    s_barrier
    ds_read_b128 v[24:27], v9 offset:18432
    ds_read_b128 v[64:67], v17 offset:18432
    ds_read_b128 v[28:31], v9 offset:20480
    ds_read_b128 v[32:35], v9 offset:22528
    ds_read_b128 v[36:39], v9 offset:24576
    ds_read_b128 v[40:43], v9 offset:26624
    s_add_u32 s24, s4, 0x1ab3000
    s_addc_u32 s25, s5, 0
    s_mov_b32 s26, 0x280000
    s_mov_b32 s27, 0x00020000
    s_mov_b32 s28, s6
    s_mov_b32 s29, s7
    s_mov_b32 s30, 0x280000
    s_mov_b32 s31, 0x00020000
    v_mul_u32_u24 v5, 1280, v3
    v_lshl_add_u32 v5, v4, 1, v5
    v_mov_b32 v6, v5
    buffer_load_dwordx2 v[92:93], v5, s[24:27], 0 offen offset:0
    buffer_load_dwordx2 v[94:95], v5, s[24:27], 0 offen offset:32
    buffer_load_dwordx2 v[96:97], v5, s[24:27], 0 offen offset:64
    buffer_load_dwordx2 v[98:99], v5, s[24:27], 0 offen offset:96
    buffer_load_dwordx2 v[100:101], v5, s[24:27], 0 offen offset:128
    v_add_u32 v5, 20480, v5
    v_mfma_f32_16x16x32_bf16 v[72:75], v[44:47], v[68:71], v[72:75]
    v_mfma_f32_16x16x32_bf16 v[76:79], v[48:51], v[68:71], v[76:79]
    v_mfma_f32_16x16x32_bf16 v[80:83], v[52:55], v[68:71], v[80:83]
    v_mfma_f32_16x16x32_bf16 v[84:87], v[56:59], v[68:71], v[84:87]
    v_mfma_f32_16x16x32_bf16 v[88:91], v[60:63], v[68:71], v[88:91]
    ds_read_b128 v[44:47], v13 offset:18432
    ds_read_b128 v[68:71], v21 offset:18432
    ds_read_b128 v[48:51], v13 offset:20480
    ds_read_b128 v[52:55], v13 offset:22528
    ds_read_b128 v[56:59], v13 offset:24576
    ds_read_b128 v[60:63], v13 offset:26624
    s_waitcnt lgkmcnt(6)
    v_mfma_f32_16x16x32_bf16 v[72:75], v[24:27], v[64:67], v[72:75]
    v_mfma_f32_16x16x32_bf16 v[76:79], v[28:31], v[64:67], v[76:79]
    v_mfma_f32_16x16x32_bf16 v[80:83], v[32:35], v[64:67], v[80:83]
    v_mfma_f32_16x16x32_bf16 v[84:87], v[36:39], v[64:67], v[84:87]
    v_mfma_f32_16x16x32_bf16 v[88:91], v[40:43], v[64:67], v[88:91]
    s_waitcnt lgkmcnt(0)
    s_barrier
    ds_read_b128 v[24:27], v10 offset:0
    ds_read_b128 v[64:67], v18 offset:0
    ds_read_b128 v[28:31], v10 offset:2048
    ds_read_b128 v[32:35], v10 offset:4096
    ds_read_b128 v[36:39], v10 offset:6144
    ds_read_b128 v[40:43], v10 offset:8192
    v_mfma_f32_16x16x32_bf16 v[72:75], v[44:47], v[68:71], v[72:75]
    v_mfma_f32_16x16x32_bf16 v[76:79], v[48:51], v[68:71], v[76:79]
    v_mfma_f32_16x16x32_bf16 v[80:83], v[52:55], v[68:71], v[80:83]
    v_mfma_f32_16x16x32_bf16 v[84:87], v[56:59], v[68:71], v[84:87]
    v_mfma_f32_16x16x32_bf16 v[88:91], v[60:63], v[68:71], v[88:91]
    ds_read_b128 v[44:47], v14 offset:0
    ds_read_b128 v[68:71], v22 offset:0
    ds_read_b128 v[48:51], v14 offset:2048
    ds_read_b128 v[52:55], v14 offset:4096
    ds_read_b128 v[56:59], v14 offset:6144
    ds_read_b128 v[60:63], v14 offset:8192
    s_waitcnt lgkmcnt(6)
    v_mfma_f32_16x16x32_bf16 v[72:75], v[24:27], v[64:67], v[72:75]
    v_mfma_f32_16x16x32_bf16 v[76:79], v[28:31], v[64:67], v[76:79]
    v_mfma_f32_16x16x32_bf16 v[80:83], v[32:35], v[64:67], v[80:83]
    v_mfma_f32_16x16x32_bf16 v[84:87], v[36:39], v[64:67], v[84:87]
    v_mfma_f32_16x16x32_bf16 v[88:91], v[40:43], v[64:67], v[88:91]
    s_waitcnt lgkmcnt(0)
    s_barrier
    ds_read_b128 v[24:27], v10 offset:18432
    ds_read_b128 v[64:67], v18 offset:18432
    ds_read_b128 v[28:31], v10 offset:20480
    ds_read_b128 v[32:35], v10 offset:22528
    ds_read_b128 v[36:39], v10 offset:24576
    ds_read_b128 v[40:43], v10 offset:26624
    v_mfma_f32_16x16x32_bf16 v[72:75], v[44:47], v[68:71], v[72:75]
    v_mfma_f32_16x16x32_bf16 v[76:79], v[48:51], v[68:71], v[76:79]
    v_mfma_f32_16x16x32_bf16 v[80:83], v[52:55], v[68:71], v[80:83]
    v_mfma_f32_16x16x32_bf16 v[84:87], v[56:59], v[68:71], v[84:87]
    v_mfma_f32_16x16x32_bf16 v[88:91], v[60:63], v[68:71], v[88:91]
    ds_read_b128 v[44:47], v14 offset:18432
    ds_read_b128 v[68:71], v22 offset:18432
    ds_read_b128 v[48:51], v14 offset:20480
    ds_read_b128 v[52:55], v14 offset:22528
    ds_read_b128 v[56:59], v14 offset:24576
    ds_read_b128 v[60:63], v14 offset:26624
    s_waitcnt lgkmcnt(6)
    v_mfma_f32_16x16x32_bf16 v[72:75], v[24:27], v[64:67], v[72:75]
    v_mfma_f32_16x16x32_bf16 v[76:79], v[28:31], v[64:67], v[76:79]
    v_mfma_f32_16x16x32_bf16 v[80:83], v[32:35], v[64:67], v[80:83]
    v_mfma_f32_16x16x32_bf16 v[84:87], v[36:39], v[64:67], v[84:87]
    v_mfma_f32_16x16x32_bf16 v[88:91], v[40:43], v[64:67], v[88:91]
    s_waitcnt lgkmcnt(0)
    s_barrier
    ds_read_b128 v[24:27], v11 offset:0
    ds_read_b128 v[64:67], v19 offset:0
    ds_read_b128 v[28:31], v11 offset:2048
    ds_read_b128 v[32:35], v11 offset:4096
    ds_read_b128 v[36:39], v11 offset:6144
    ds_read_b128 v[40:43], v11 offset:8192
    v_mfma_f32_16x16x32_bf16 v[72:75], v[44:47], v[68:71], v[72:75]
    v_mfma_f32_16x16x32_bf16 v[76:79], v[48:51], v[68:71], v[76:79]
    v_mfma_f32_16x16x32_bf16 v[80:83], v[52:55], v[68:71], v[80:83]
    v_mfma_f32_16x16x32_bf16 v[84:87], v[56:59], v[68:71], v[84:87]
    v_mfma_f32_16x16x32_bf16 v[88:91], v[60:63], v[68:71], v[88:91]
    ds_read_b128 v[44:47], v15 offset:0
    ds_read_b128 v[68:71], v23 offset:0
    ds_read_b128 v[48:51], v15 offset:2048
    ds_read_b128 v[52:55], v15 offset:4096
    ds_read_b128 v[56:59], v15 offset:6144
    ds_read_b128 v[60:63], v15 offset:8192
    s_waitcnt lgkmcnt(6)
    v_mfma_f32_16x16x32_bf16 v[72:75], v[24:27], v[64:67], v[72:75]
    v_mfma_f32_16x16x32_bf16 v[76:79], v[28:31], v[64:67], v[76:79]
    v_mfma_f32_16x16x32_bf16 v[80:83], v[32:35], v[64:67], v[80:83]
    v_mfma_f32_16x16x32_bf16 v[84:87], v[36:39], v[64:67], v[84:87]
    v_mfma_f32_16x16x32_bf16 v[88:91], v[40:43], v[64:67], v[88:91]
    s_waitcnt lgkmcnt(0)
    s_barrier
    ds_read_b128 v[24:27], v8 offset:0
    ds_read_b128 v[64:67], v16 offset:0
    ds_read_b128 v[28:31], v8 offset:2048
    ds_read_b128 v[32:35], v8 offset:4096
    ds_read_b128 v[36:39], v8 offset:6144
    ds_read_b128 v[40:43], v8 offset:8192
    v_mfma_f32_16x16x32_bf16 v[72:75], v[44:47], v[68:71], v[72:75]
    v_mfma_f32_16x16x32_bf16 v[76:79], v[48:51], v[68:71], v[76:79]
    v_mfma_f32_16x16x32_bf16 v[80:83], v[52:55], v[68:71], v[80:83]
    v_mfma_f32_16x16x32_bf16 v[84:87], v[56:59], v[68:71], v[84:87]
    v_mfma_f32_16x16x32_bf16 v[88:91], v[60:63], v[68:71], v[88:91]
    ds_read_b128 v[44:47], v12 offset:0
    ds_read_b128 v[68:71], v20 offset:0
    ds_read_b128 v[48:51], v12 offset:2048
    ds_read_b128 v[52:55], v12 offset:4096
    ds_read_b128 v[56:59], v12 offset:6144
    ds_read_b128 v[60:63], v12 offset:8192
    s_waitcnt lgkmcnt(6)
    v_mfma_f32_16x16x32_bf16 v[72:75], v[24:27], v[64:67], v[72:75]
    v_mfma_f32_16x16x32_bf16 v[76:79], v[28:31], v[64:67], v[76:79]
    v_mfma_f32_16x16x32_bf16 v[80:83], v[32:35], v[64:67], v[80:83]
    v_mfma_f32_16x16x32_bf16 v[84:87], v[36:39], v[64:67], v[84:87]
    v_mfma_f32_16x16x32_bf16 v[88:91], v[40:43], v[64:67], v[88:91]
    s_waitcnt lgkmcnt(0)
    s_barrier
    ds_read_b128 v[24:27], v8 offset:18432
    ds_read_b128 v[64:67], v16 offset:18432
    ds_read_b128 v[28:31], v8 offset:20480
    ds_read_b128 v[32:35], v8 offset:22528
    ds_read_b128 v[36:39], v8 offset:24576
    ds_read_b128 v[40:43], v8 offset:26624
    v_mfma_f32_16x16x32_bf16 v[72:75], v[44:47], v[68:71], v[72:75]
    v_mfma_f32_16x16x32_bf16 v[76:79], v[48:51], v[68:71], v[76:79]
    v_mfma_f32_16x16x32_bf16 v[80:83], v[52:55], v[68:71], v[80:83]
    v_mfma_f32_16x16x32_bf16 v[84:87], v[56:59], v[68:71], v[84:87]
    v_mfma_f32_16x16x32_bf16 v[88:91], v[60:63], v[68:71], v[88:91]
    ds_read_b128 v[44:47], v12 offset:18432
    ds_read_b128 v[68:71], v20 offset:18432
    ds_read_b128 v[48:51], v12 offset:20480
    ds_read_b128 v[52:55], v12 offset:22528
    ds_read_b128 v[56:59], v12 offset:24576
    ds_read_b128 v[60:63], v12 offset:26624
    s_waitcnt lgkmcnt(6)
    v_mfma_f32_16x16x32_bf16 v[72:75], v[24:27], v[64:67], v[72:75]
    v_mfma_f32_16x16x32_bf16 v[76:79], v[28:31], v[64:67], v[76:79]
    v_mfma_f32_16x16x32_bf16 v[80:83], v[32:35], v[64:67], v[80:83]
    v_mfma_f32_16x16x32_bf16 v[84:87], v[36:39], v[64:67], v[84:87]
    v_mfma_f32_16x16x32_bf16 v[88:91], v[40:43], v[64:67], v[88:91]
    s_waitcnt lgkmcnt(0)
    s_barrier
    ds_read_b128 v[24:27], v9 offset:0
    ds_read_b128 v[64:67], v17 offset:0
    ds_read_b128 v[28:31], v9 offset:2048
    ds_read_b128 v[32:35], v9 offset:4096
    ds_read_b128 v[36:39], v9 offset:6144
    ds_read_b128 v[40:43], v9 offset:8192
    v_mfma_f32_16x16x32_bf16 v[72:75], v[44:47], v[68:71], v[72:75]
    v_mfma_f32_16x16x32_bf16 v[76:79], v[48:51], v[68:71], v[76:79]
    v_mfma_f32_16x16x32_bf16 v[80:83], v[52:55], v[68:71], v[80:83]
    v_mfma_f32_16x16x32_bf16 v[84:87], v[56:59], v[68:71], v[84:87]
    v_mfma_f32_16x16x32_bf16 v[88:91], v[60:63], v[68:71], v[88:91]
    ds_read_b128 v[44:47], v13 offset:0
    ds_read_b128 v[68:71], v21 offset:0
    ds_read_b128 v[48:51], v13 offset:2048
    ds_read_b128 v[52:55], v13 offset:4096
    ds_read_b128 v[56:59], v13 offset:6144
    ds_read_b128 v[60:63], v13 offset:8192
    s_waitcnt lgkmcnt(6)
    v_mfma_f32_16x16x32_bf16 v[72:75], v[24:27], v[64:67], v[72:75]
    v_mfma_f32_16x16x32_bf16 v[76:79], v[28:31], v[64:67], v[76:79]
    v_mfma_f32_16x16x32_bf16 v[80:83], v[32:35], v[64:67], v[80:83]
    v_mfma_f32_16x16x32_bf16 v[84:87], v[36:39], v[64:67], v[84:87]
    v_mfma_f32_16x16x32_bf16 v[88:91], v[40:43], v[64:67], v[88:91]
    s_waitcnt lgkmcnt(0)
    s_barrier
    ds_read_b128 v[24:27], v9 offset:18432
    ds_read_b128 v[64:67], v17 offset:18432
    ds_read_b128 v[28:31], v9 offset:20480
    ds_read_b128 v[32:35], v9 offset:22528
    ds_read_b128 v[36:39], v9 offset:24576
    ds_read_b128 v[40:43], v9 offset:26624
    v_mfma_f32_16x16x32_bf16 v[72:75], v[44:47], v[68:71], v[72:75]
    v_mfma_f32_16x16x32_bf16 v[76:79], v[48:51], v[68:71], v[76:79]
    v_mfma_f32_16x16x32_bf16 v[80:83], v[52:55], v[68:71], v[80:83]
    v_mfma_f32_16x16x32_bf16 v[84:87], v[56:59], v[68:71], v[84:87]
    v_mfma_f32_16x16x32_bf16 v[88:91], v[60:63], v[68:71], v[88:91]
    ds_read_b128 v[44:47], v13 offset:18432
    ds_read_b128 v[68:71], v21 offset:18432
    ds_read_b128 v[48:51], v13 offset:20480
    ds_read_b128 v[52:55], v13 offset:22528
    ds_read_b128 v[56:59], v13 offset:24576
    ds_read_b128 v[60:63], v13 offset:26624
    s_waitcnt lgkmcnt(6)
    v_mfma_f32_16x16x32_bf16 v[72:75], v[24:27], v[64:67], v[72:75]
    v_mfma_f32_16x16x32_bf16 v[76:79], v[28:31], v[64:67], v[76:79]
    v_mfma_f32_16x16x32_bf16 v[80:83], v[32:35], v[64:67], v[80:83]
    v_mfma_f32_16x16x32_bf16 v[84:87], v[36:39], v[64:67], v[84:87]
    v_mfma_f32_16x16x32_bf16 v[88:91], v[40:43], v[64:67], v[88:91]
    s_waitcnt lgkmcnt(0)
    s_barrier
    ds_read_b128 v[24:27], v10 offset:0
    ds_read_b128 v[64:67], v18 offset:0
    ds_read_b128 v[28:31], v10 offset:2048
    ds_read_b128 v[32:35], v10 offset:4096
    ds_read_b128 v[36:39], v10 offset:6144
    ds_read_b128 v[40:43], v10 offset:8192
    v_mfma_f32_16x16x32_bf16 v[72:75], v[44:47], v[68:71], v[72:75]
    v_mfma_f32_16x16x32_bf16 v[76:79], v[48:51], v[68:71], v[76:79]
    v_mfma_f32_16x16x32_bf16 v[80:83], v[52:55], v[68:71], v[80:83]
    v_mfma_f32_16x16x32_bf16 v[84:87], v[56:59], v[68:71], v[84:87]
    v_mfma_f32_16x16x32_bf16 v[88:91], v[60:63], v[68:71], v[88:91]
    ds_read_b128 v[44:47], v14 offset:0
    ds_read_b128 v[68:71], v22 offset:0
    ds_read_b128 v[48:51], v14 offset:2048
    ds_read_b128 v[52:55], v14 offset:4096
    ds_read_b128 v[56:59], v14 offset:6144
    ds_read_b128 v[60:63], v14 offset:8192
    s_waitcnt lgkmcnt(6)
    v_mfma_f32_16x16x32_bf16 v[72:75], v[24:27], v[64:67], v[72:75]
    v_mfma_f32_16x16x32_bf16 v[76:79], v[28:31], v[64:67], v[76:79]
    v_mfma_f32_16x16x32_bf16 v[80:83], v[32:35], v[64:67], v[80:83]
    v_mfma_f32_16x16x32_bf16 v[84:87], v[36:39], v[64:67], v[84:87]
    v_mfma_f32_16x16x32_bf16 v[88:91], v[40:43], v[64:67], v[88:91]
    s_waitcnt lgkmcnt(0)
    s_barrier
    ds_read_b128 v[24:27], v10 offset:18432
    ds_read_b128 v[64:67], v18 offset:18432
    ds_read_b128 v[28:31], v10 offset:20480
    ds_read_b128 v[32:35], v10 offset:22528
    ds_read_b128 v[36:39], v10 offset:24576
    ds_read_b128 v[40:43], v10 offset:26624
    v_mfma_f32_16x16x32_bf16 v[72:75], v[44:47], v[68:71], v[72:75]
    v_mfma_f32_16x16x32_bf16 v[76:79], v[48:51], v[68:71], v[76:79]
    v_mfma_f32_16x16x32_bf16 v[80:83], v[52:55], v[68:71], v[80:83]
    v_mfma_f32_16x16x32_bf16 v[84:87], v[56:59], v[68:71], v[84:87]
    v_mfma_f32_16x16x32_bf16 v[88:91], v[60:63], v[68:71], v[88:91]
    ds_read_b128 v[44:47], v14 offset:18432
    ds_read_b128 v[68:71], v22 offset:18432
    ds_read_b128 v[48:51], v14 offset:20480
    ds_read_b128 v[52:55], v14 offset:22528
    ds_read_b128 v[56:59], v14 offset:24576
    ds_read_b128 v[60:63], v14 offset:26624
    s_waitcnt lgkmcnt(6)
    v_mfma_f32_16x16x32_bf16 v[72:75], v[24:27], v[64:67], v[72:75]
    v_mfma_f32_16x16x32_bf16 v[76:79], v[28:31], v[64:67], v[76:79]
    v_mfma_f32_16x16x32_bf16 v[80:83], v[32:35], v[64:67], v[80:83]
    v_mfma_f32_16x16x32_bf16 v[84:87], v[36:39], v[64:67], v[84:87]
    v_mfma_f32_16x16x32_bf16 v[88:91], v[40:43], v[64:67], v[88:91]
    s_waitcnt lgkmcnt(0)
    s_barrier
    ds_read_b128 v[24:27], v11 offset:0
    ds_read_b128 v[64:67], v19 offset:0
    ds_read_b128 v[28:31], v11 offset:2048
    ds_read_b128 v[32:35], v11 offset:4096
    ds_read_b128 v[36:39], v11 offset:6144
    ds_read_b128 v[40:43], v11 offset:8192
    v_mfma_f32_16x16x32_bf16 v[72:75], v[44:47], v[68:71], v[72:75]
    v_mfma_f32_16x16x32_bf16 v[76:79], v[48:51], v[68:71], v[76:79]
    v_mfma_f32_16x16x32_bf16 v[80:83], v[52:55], v[68:71], v[80:83]
    v_mfma_f32_16x16x32_bf16 v[84:87], v[56:59], v[68:71], v[84:87]
    v_mfma_f32_16x16x32_bf16 v[88:91], v[60:63], v[68:71], v[88:91]
    s_waitcnt lgkmcnt(0)
    v_mfma_f32_16x16x32_bf16 v[72:75], v[24:27], v[64:67], v[72:75]
    v_mfma_f32_16x16x32_bf16 v[76:79], v[28:31], v[64:67], v[76:79]
    v_mfma_f32_16x16x32_bf16 v[80:83], v[32:35], v[64:67], v[80:83]
    v_mfma_f32_16x16x32_bf16 v[84:87], v[36:39], v[64:67], v[84:87]
    v_mfma_f32_16x16x32_bf16 v[88:91], v[40:43], v[64:67], v[88:91]
    s_nop 15
    s_waitcnt vmcnt(0)
    v_cvt_pk_bf16_f32 v24, v72, v73
    v_lshlrev_b32 v72, 16, v24
    v_and_b32 v73, 0xffff0000, v24
    v_cvt_pk_bf16_f32 v24, v74, v75
    v_lshlrev_b32 v74, 16, v24
    v_and_b32 v75, 0xffff0000, v24
    v_lshlrev_b32 v24, 16, v92
    v_and_b32 v25, 0xffff0000, v92
    v_lshlrev_b32 v26, 16, v93
    v_and_b32 v27, 0xffff0000, v93
    v_pk_add_f32 v[72:73], v[72:73], v[24:25]
    v_pk_add_f32 v[74:75], v[74:75], v[26:27]
    v_cvt_pk_bf16_f32 v72, v72, v73
    v_cvt_pk_bf16_f32 v73, v74, v75
    buffer_store_dwordx2 v[72:73], v6, s[28:31], 0 offen offset:0
    v_cvt_pk_bf16_f32 v24, v76, v77
    v_lshlrev_b32 v76, 16, v24
    v_and_b32 v77, 0xffff0000, v24
    v_cvt_pk_bf16_f32 v24, v78, v79
    v_lshlrev_b32 v78, 16, v24
    v_and_b32 v79, 0xffff0000, v24
    v_lshlrev_b32 v24, 16, v94
    v_and_b32 v25, 0xffff0000, v94
    v_lshlrev_b32 v26, 16, v95
    v_and_b32 v27, 0xffff0000, v95
    v_pk_add_f32 v[76:77], v[76:77], v[24:25]
    v_pk_add_f32 v[78:79], v[78:79], v[26:27]
    v_cvt_pk_bf16_f32 v76, v76, v77
    v_cvt_pk_bf16_f32 v77, v78, v79
    buffer_store_dwordx2 v[76:77], v6, s[28:31], 0 offen offset:32
    v_cvt_pk_bf16_f32 v24, v80, v81
    v_lshlrev_b32 v80, 16, v24
    v_and_b32 v81, 0xffff0000, v24
    v_cvt_pk_bf16_f32 v24, v82, v83
    v_lshlrev_b32 v82, 16, v24
    v_and_b32 v83, 0xffff0000, v24
    v_lshlrev_b32 v24, 16, v96
    v_and_b32 v25, 0xffff0000, v96
    v_lshlrev_b32 v26, 16, v97
    v_and_b32 v27, 0xffff0000, v97
    v_pk_add_f32 v[80:81], v[80:81], v[24:25]
    v_pk_add_f32 v[82:83], v[82:83], v[26:27]
    v_cvt_pk_bf16_f32 v80, v80, v81
    v_cvt_pk_bf16_f32 v81, v82, v83
    buffer_store_dwordx2 v[80:81], v6, s[28:31], 0 offen offset:64
    v_cvt_pk_bf16_f32 v24, v84, v85
    v_lshlrev_b32 v84, 16, v24
    v_and_b32 v85, 0xffff0000, v24
    v_cvt_pk_bf16_f32 v24, v86, v87
    v_lshlrev_b32 v86, 16, v24
    v_and_b32 v87, 0xffff0000, v24
    v_lshlrev_b32 v24, 16, v98
    v_and_b32 v25, 0xffff0000, v98
    v_lshlrev_b32 v26, 16, v99
    v_and_b32 v27, 0xffff0000, v99
    v_pk_add_f32 v[84:85], v[84:85], v[24:25]
    v_pk_add_f32 v[86:87], v[86:87], v[26:27]
    v_cvt_pk_bf16_f32 v84, v84, v85
    v_cvt_pk_bf16_f32 v85, v86, v87
    buffer_store_dwordx2 v[84:85], v6, s[28:31], 0 offen offset:96
    v_cvt_pk_bf16_f32 v24, v88, v89
    v_lshlrev_b32 v88, 16, v24
    v_and_b32 v89, 0xffff0000, v24
    v_cvt_pk_bf16_f32 v24, v90, v91
    v_lshlrev_b32 v90, 16, v24
    v_and_b32 v91, 0xffff0000, v24
    v_lshlrev_b32 v24, 16, v100
    v_and_b32 v25, 0xffff0000, v100
    v_lshlrev_b32 v26, 16, v101
    v_and_b32 v27, 0xffff0000, v101
    v_pk_add_f32 v[88:89], v[88:89], v[24:25]
    v_pk_add_f32 v[90:91], v[90:91], v[26:27]
    v_cvt_pk_bf16_f32 v88, v88, v89
    v_cvt_pk_bf16_f32 v89, v90, v91
    buffer_store_dwordx2 v[88:89], v6, s[28:31], 0 offen offset:128
    v_add_u32 v6, 20480, v6
    s_branch Lend_40
Lload_41:
    s_add_u32 s16, s4, 0x49e000
    s_addc_u32 s17, s5, 0
    s_mov_b32 s18, 0x10f000
    s_mov_b32 s19, 0x00020000
    s_add_u32 s20, s4, 0x14d1000
    s_addc_u32 s21, s5, 0
    s_mov_b32 s22, 0x361000
    s_mov_b32 s23, 0x00020000
    v_lshrrev_b32 v3, 3, v2
    v_and_b32 v4, 7, v2
    s_cmp_eq_u32 s44, 5
    s_cbranch_scc1 Lld_45
    s_cmp_eq_u32 s44, 6
    s_cbranch_scc1 Lld_46
    s_cmp_eq_u32 s44, 7
    s_cbranch_scc1 Lld_47
Lld_44:
    v_add_u32 v6, 0, v5
    v_and_b32 v6, 7, v6
    v_xor_b32 v6, v6, v4
    v_add_u32 v7, s42, v3
    s_mov_b32 s47, 1728
    v_mul_lo_u32 v7, v7, s47
    v_lshl_add_u32 v8, v6, 4, v7
    v_add_u32 v6, 0, v5
    v_and_b32 v6, 7, v6
    v_xor_b32 v6, v6, v4
    v_add_u32 v7, s42, v3
    v_add_u32 v7, 32, v7
    s_mov_b32 s47, 1728
    v_mul_lo_u32 v7, v7, s47
    v_lshl_add_u32 v9, v6, 4, v7
    v_add_u32 v6, 0, v5
    v_and_b32 v6, 7, v6
    v_xor_b32 v6, v6, v4
    v_add_u32 v7, s42, v3
    v_add_u32 v7, 64, v7
    s_mov_b32 s47, 1728
    v_mul_lo_u32 v7, v7, s47
    v_lshl_add_u32 v10, v6, 4, v7
    v_add_u32 v6, 0, v5
    v_and_b32 v6, 7, v6
    v_xor_b32 v6, v6, v4
    v_add_u32 v7, s43, v3
    v_add_u32 v7, 16, v7
    s_mov_b32 s47, 1728
    v_mul_lo_u32 v7, v7, s47
    v_lshl_add_u32 v11, v6, 4, v7
    v_add_u32 v6, 0, v5
    v_and_b32 v6, 7, v6
    v_xor_b32 v6, v6, v4
    v_add_u32 v7, s43, v3
    v_add_u32 v7, 48, v7
    s_mov_b32 s47, 1728
    v_mul_lo_u32 v7, v7, s47
    v_lshl_add_u32 v12, v6, 4, v7
    s_mov_b32 s50, 0
    s_mov_b32 s51, 0
    s_mov_b32 m0, 0
    s_nop 0
    buffer_load_dwordx4 v8, s[16:19], s50 offen lds
    s_mov_b32 m0, 4096
    s_nop 0
    buffer_load_dwordx4 v9, s[16:19], s50 offen lds
    s_mov_b32 m0, 8192
    s_nop 0
    buffer_load_dwordx4 v10, s[16:19], s50 offen lds
    s_mov_b32 m0, 12288
    s_nop 0
    buffer_load_dwordx4 v11, s[20:23], s50 offen lds
    s_mov_b32 m0, 16384
    s_nop 0
    buffer_load_dwordx4 v12, s[20:23], s50 offen lds
    s_mov_b32 s50, 128
    s_mov_b32 s51, 110592
    s_mov_b32 m0, 18432
    s_nop 0
    buffer_load_dwordx4 v8, s[16:19], s50 offen lds
    s_mov_b32 m0, 22528
    s_nop 0
    buffer_load_dwordx4 v9, s[16:19], s50 offen lds
    s_mov_b32 m0, 26624
    s_nop 0
    buffer_load_dwordx4 v10, s[16:19], s50 offen lds
    s_mov_b32 m0, 30720
    s_nop 0
    buffer_load_dwordx4 v11, s[20:23], s50 offen lds
    s_mov_b32 m0, 34816
    s_nop 0
    buffer_load_dwordx4 v12, s[20:23], s50 offen lds
    s_mov_b32 s50, 256
    s_mov_b32 s51, 221184
    s_mov_b32 m0, 36864
    s_nop 0
    buffer_load_dwordx4 v8, s[16:19], s50 offen lds
    s_mov_b32 m0, 40960
    s_nop 0
    buffer_load_dwordx4 v9, s[16:19], s50 offen lds
    s_mov_b32 m0, 45056
    s_nop 0
    buffer_load_dwordx4 v10, s[16:19], s50 offen lds
    s_mov_b32 m0, 49152
    s_nop 0
    buffer_load_dwordx4 v11, s[20:23], s50 offen lds
    s_mov_b32 m0, 53248
    s_nop 0
    buffer_load_dwordx4 v12, s[20:23], s50 offen lds
    s_mov_b32 s50, 384
    s_mov_b32 s51, 331776
    s_mov_b32 m0, 55296
    s_nop 0
    buffer_load_dwordx4 v8, s[16:19], s50 offen lds
    s_mov_b32 m0, 59392
    s_nop 0
    buffer_load_dwordx4 v9, s[16:19], s50 offen lds
    s_mov_b32 m0, 63488
    s_nop 0
    buffer_load_dwordx4 v10, s[16:19], s50 offen lds
    s_mov_b32 m0, 67584
    s_nop 0
    buffer_load_dwordx4 v11, s[20:23], s50 offen lds
    s_mov_b32 m0, 71680
    s_nop 0
    buffer_load_dwordx4 v12, s[20:23], s50 offen lds
    s_mov_b32 s50, 512
    s_mov_b32 s51, 442368
    s_mov_b32 m0, 73728
    s_nop 0
    buffer_load_dwordx4 v8, s[16:19], s50 offen lds
    s_mov_b32 m0, 77824
    s_nop 0
    buffer_load_dwordx4 v9, s[16:19], s50 offen lds
    s_mov_b32 m0, 81920
    s_nop 0
    buffer_load_dwordx4 v10, s[16:19], s50 offen lds
    s_mov_b32 m0, 86016
    s_nop 0
    buffer_load_dwordx4 v11, s[20:23], s50 offen lds
    s_mov_b32 m0, 90112
    s_nop 0
    buffer_load_dwordx4 v12, s[20:23], s50 offen lds
    s_mov_b32 s50, 640
    s_mov_b32 s51, 552960
    s_mov_b32 m0, 92160
    s_nop 0
    buffer_load_dwordx4 v8, s[16:19], s50 offen lds
    s_mov_b32 m0, 96256
    s_nop 0
    buffer_load_dwordx4 v9, s[16:19], s50 offen lds
    s_mov_b32 m0, 100352
    s_nop 0
    buffer_load_dwordx4 v10, s[16:19], s50 offen lds
    s_mov_b32 m0, 104448
    s_nop 0
    buffer_load_dwordx4 v11, s[20:23], s50 offen lds
    s_mov_b32 m0, 108544
    s_nop 0
    buffer_load_dwordx4 v12, s[20:23], s50 offen lds
    s_waitcnt vmcnt(25)
    s_barrier
    s_waitcnt vmcnt(20)
    s_barrier
    s_mov_b32 s50, 768
    s_mov_b32 s51, 663552
    s_mov_b32 m0, 110592
    s_nop 0
    buffer_load_dwordx4 v8, s[16:19], s50 offen lds
    s_mov_b32 m0, 114688
    s_nop 0
    buffer_load_dwordx4 v9, s[16:19], s50 offen lds
    s_mov_b32 m0, 118784
    s_nop 0
    buffer_load_dwordx4 v10, s[16:19], s50 offen lds
    s_mov_b32 m0, 122880
    s_nop 0
    buffer_load_dwordx4 v11, s[20:23], s50 offen lds
    s_mov_b32 m0, 126976
    s_nop 0
    buffer_load_dwordx4 v12, s[20:23], s50 offen lds
    s_waitcnt vmcnt(20)
    s_barrier
    s_mov_b32 s50, 896
    s_mov_b32 s51, 774144
    s_mov_b32 m0, 0
    s_nop 0
    buffer_load_dwordx4 v8, s[16:19], s50 offen lds
    s_mov_b32 m0, 4096
    s_nop 0
    buffer_load_dwordx4 v9, s[16:19], s50 offen lds
    s_mov_b32 m0, 8192
    s_nop 0
    buffer_load_dwordx4 v10, s[16:19], s50 offen lds
    s_mov_b32 m0, 12288
    s_nop 0
    buffer_load_dwordx4 v11, s[20:23], s50 offen lds
    s_mov_b32 m0, 16384
    s_nop 0
    buffer_load_dwordx4 v12, s[20:23], s50 offen lds
    s_waitcnt vmcnt(20)
    s_barrier
    s_mov_b32 s50, 1024
    s_mov_b32 s51, 884736
    s_mov_b32 m0, 18432
    s_nop 0
    buffer_load_dwordx4 v8, s[16:19], s50 offen lds
    s_mov_b32 m0, 22528
    s_nop 0
    buffer_load_dwordx4 v9, s[16:19], s50 offen lds
    s_mov_b32 m0, 26624
    s_nop 0
    buffer_load_dwordx4 v10, s[16:19], s50 offen lds
    s_mov_b32 m0, 30720
    s_nop 0
    buffer_load_dwordx4 v11, s[20:23], s50 offen lds
    s_mov_b32 m0, 34816
    s_nop 0
    buffer_load_dwordx4 v12, s[20:23], s50 offen lds
    s_waitcnt vmcnt(20)
    s_barrier
    s_mov_b32 s50, 1152
    s_mov_b32 s51, 995328
    s_mov_b32 m0, 36864
    s_nop 0
    buffer_load_dwordx4 v8, s[16:19], s50 offen lds
    s_mov_b32 m0, 40960
    s_nop 0
    buffer_load_dwordx4 v9, s[16:19], s50 offen lds
    s_mov_b32 m0, 45056
    s_nop 0
    buffer_load_dwordx4 v10, s[16:19], s50 offen lds
    s_mov_b32 m0, 49152
    s_nop 0
    buffer_load_dwordx4 v11, s[20:23], s50 offen lds
    s_mov_b32 m0, 53248
    s_nop 0
    buffer_load_dwordx4 v12, s[20:23], s50 offen lds
    s_waitcnt vmcnt(20)
    s_barrier
    s_mov_b32 s50, 1280
    s_mov_b32 s51, 1105920
    s_mov_b32 m0, 55296
    s_nop 0
    buffer_load_dwordx4 v8, s[16:19], s50 offen lds
    s_mov_b32 m0, 59392
    s_nop 0
    buffer_load_dwordx4 v9, s[16:19], s50 offen lds
    s_mov_b32 m0, 63488
    s_nop 0
    buffer_load_dwordx4 v10, s[16:19], s50 offen lds
    s_mov_b32 m0, 67584
    s_nop 0
    buffer_load_dwordx4 v11, s[20:23], s50 offen lds
    s_mov_b32 m0, 71680
    s_nop 0
    buffer_load_dwordx4 v12, s[20:23], s50 offen lds
    s_waitcnt vmcnt(20)
    s_barrier
    s_mov_b32 s50, 1408
    s_mov_b32 s51, 1216512
    s_mov_b32 m0, 73728
    s_nop 0
    buffer_load_dwordx4 v8, s[16:19], s50 offen lds
    s_mov_b32 m0, 77824
    s_nop 0
    buffer_load_dwordx4 v9, s[16:19], s50 offen lds
    s_mov_b32 m0, 81920
    s_nop 0
    buffer_load_dwordx4 v10, s[16:19], s50 offen lds
    s_mov_b32 m0, 86016
    s_nop 0
    buffer_load_dwordx4 v11, s[20:23], s50 offen lds
    s_mov_b32 m0, 90112
    s_nop 0
    buffer_load_dwordx4 v12, s[20:23], s50 offen lds
    s_waitcnt vmcnt(20)
    s_barrier
    s_mov_b32 s50, 1536
    s_mov_b32 s51, 1327104
    s_mov_b32 m0, 92160
    s_nop 0
    buffer_load_dwordx4 v8, s[16:19], s50 offen lds
    s_mov_b32 m0, 96256
    s_nop 0
    buffer_load_dwordx4 v9, s[16:19], s50 offen lds
    s_mov_b32 m0, 100352
    s_nop 0
    buffer_load_dwordx4 v10, s[16:19], s50 offen lds
    s_mov_b32 m0, 104448
    s_nop 0
    buffer_load_dwordx4 v11, s[20:23], s50 offen lds
    s_mov_b32 m0, 108544
    s_nop 0
    buffer_load_dwordx4 v12, s[20:23], s50 offen lds
    s_waitcnt vmcnt(20)
    s_barrier
    s_mov_b32 s50, 1664
    s_mov_b32 s51, 1437696
    s_mov_b32 m0, 110592
    s_nop 0
    buffer_load_dwordx4 v8, s[16:19], s50 offen lds
    s_mov_b32 m0, 114688
    s_nop 0
    buffer_load_dwordx4 v9, s[16:19], s50 offen lds
    s_mov_b32 m0, 118784
    s_nop 0
    buffer_load_dwordx4 v10, s[16:19], s50 offen lds
    s_mov_b32 m0, 122880
    s_nop 0
    buffer_load_dwordx4 v11, s[20:23], s50 offen lds
    s_mov_b32 m0, 126976
    s_nop 0
    buffer_load_dwordx4 v12, s[20:23], s50 offen lds
    s_waitcnt vmcnt(20)
    s_barrier
    s_waitcnt vmcnt(15)
    s_barrier
    s_waitcnt vmcnt(10)
    s_barrier
    s_waitcnt vmcnt(5)
    s_barrier
    s_waitcnt vmcnt(0)
    s_barrier
    s_branch Lend_40
Lld_45:
    v_add_u32 v6, 4, v5
    v_and_b32 v6, 7, v6
    v_xor_b32 v6, v6, v4
    v_add_u32 v7, s42, v3
    v_add_u32 v7, 8, v7
    s_mov_b32 s47, 1728
    v_mul_lo_u32 v7, v7, s47
    v_lshl_add_u32 v8, v6, 4, v7
    v_add_u32 v6, 4, v5
    v_and_b32 v6, 7, v6
    v_xor_b32 v6, v6, v4
    v_add_u32 v7, s42, v3
    v_add_u32 v7, 40, v7
    s_mov_b32 s47, 1728
    v_mul_lo_u32 v7, v7, s47
    v_lshl_add_u32 v9, v6, 4, v7
    v_add_u32 v6, 4, v5
    v_and_b32 v6, 7, v6
    v_xor_b32 v6, v6, v4
    v_add_u32 v7, s42, v3
    v_add_u32 v7, 72, v7
    s_mov_b32 s47, 1728
    v_mul_lo_u32 v7, v7, s47
    v_lshl_add_u32 v10, v6, 4, v7
    v_add_u32 v6, 4, v5
    v_and_b32 v6, 7, v6
    v_xor_b32 v6, v6, v4
    v_add_u32 v7, s43, v3
    v_add_u32 v7, 24, v7
    s_mov_b32 s47, 1728
    v_mul_lo_u32 v7, v7, s47
    v_lshl_add_u32 v11, v6, 4, v7
    v_add_u32 v6, 4, v5
    v_and_b32 v6, 7, v6
    v_xor_b32 v6, v6, v4
    v_add_u32 v7, s43, v3
    v_add_u32 v7, 56, v7
    s_mov_b32 s47, 1728
    v_mul_lo_u32 v7, v7, s47
    v_lshl_add_u32 v12, v6, 4, v7
    s_mov_b32 s50, 0
    s_mov_b32 s51, 0
    s_mov_b32 m0, 1024
    s_nop 0
    buffer_load_dwordx4 v8, s[16:19], s50 offen lds
    s_mov_b32 m0, 5120
    s_nop 0
    buffer_load_dwordx4 v9, s[16:19], s50 offen lds
    s_mov_b32 m0, 9216
    s_nop 0
    buffer_load_dwordx4 v10, s[16:19], s50 offen lds
    s_mov_b32 m0, 13312
    s_nop 0
    buffer_load_dwordx4 v11, s[20:23], s50 offen lds
    s_mov_b32 m0, 17408
    s_nop 0
    buffer_load_dwordx4 v12, s[20:23], s50 offen lds
    s_mov_b32 s50, 128
    s_mov_b32 s51, 110592
    s_mov_b32 m0, 19456
    s_nop 0
    buffer_load_dwordx4 v8, s[16:19], s50 offen lds
    s_mov_b32 m0, 23552
    s_nop 0
    buffer_load_dwordx4 v9, s[16:19], s50 offen lds
    s_mov_b32 m0, 27648
    s_nop 0
    buffer_load_dwordx4 v10, s[16:19], s50 offen lds
    s_mov_b32 m0, 31744
    s_nop 0
    buffer_load_dwordx4 v11, s[20:23], s50 offen lds
    s_mov_b32 m0, 35840
    s_nop 0
    buffer_load_dwordx4 v12, s[20:23], s50 offen lds
    s_mov_b32 s50, 256
    s_mov_b32 s51, 221184
    s_mov_b32 m0, 37888
    s_nop 0
    buffer_load_dwordx4 v8, s[16:19], s50 offen lds
    s_mov_b32 m0, 41984
    s_nop 0
    buffer_load_dwordx4 v9, s[16:19], s50 offen lds
    s_mov_b32 m0, 46080
    s_nop 0
    buffer_load_dwordx4 v10, s[16:19], s50 offen lds
    s_mov_b32 m0, 50176
    s_nop 0
    buffer_load_dwordx4 v11, s[20:23], s50 offen lds
    s_mov_b32 m0, 54272
    s_nop 0
    buffer_load_dwordx4 v12, s[20:23], s50 offen lds
    s_mov_b32 s50, 384
    s_mov_b32 s51, 331776
    s_mov_b32 m0, 56320
    s_nop 0
    buffer_load_dwordx4 v8, s[16:19], s50 offen lds
    s_mov_b32 m0, 60416
    s_nop 0
    buffer_load_dwordx4 v9, s[16:19], s50 offen lds
    s_mov_b32 m0, 64512
    s_nop 0
    buffer_load_dwordx4 v10, s[16:19], s50 offen lds
    s_mov_b32 m0, 68608
    s_nop 0
    buffer_load_dwordx4 v11, s[20:23], s50 offen lds
    s_mov_b32 m0, 72704
    s_nop 0
    buffer_load_dwordx4 v12, s[20:23], s50 offen lds
    s_mov_b32 s50, 512
    s_mov_b32 s51, 442368
    s_mov_b32 m0, 74752
    s_nop 0
    buffer_load_dwordx4 v8, s[16:19], s50 offen lds
    s_mov_b32 m0, 78848
    s_nop 0
    buffer_load_dwordx4 v9, s[16:19], s50 offen lds
    s_mov_b32 m0, 82944
    s_nop 0
    buffer_load_dwordx4 v10, s[16:19], s50 offen lds
    s_mov_b32 m0, 87040
    s_nop 0
    buffer_load_dwordx4 v11, s[20:23], s50 offen lds
    s_mov_b32 m0, 91136
    s_nop 0
    buffer_load_dwordx4 v12, s[20:23], s50 offen lds
    s_mov_b32 s50, 640
    s_mov_b32 s51, 552960
    s_mov_b32 m0, 93184
    s_nop 0
    buffer_load_dwordx4 v8, s[16:19], s50 offen lds
    s_mov_b32 m0, 97280
    s_nop 0
    buffer_load_dwordx4 v9, s[16:19], s50 offen lds
    s_mov_b32 m0, 101376
    s_nop 0
    buffer_load_dwordx4 v10, s[16:19], s50 offen lds
    s_mov_b32 m0, 105472
    s_nop 0
    buffer_load_dwordx4 v11, s[20:23], s50 offen lds
    s_mov_b32 m0, 109568
    s_nop 0
    buffer_load_dwordx4 v12, s[20:23], s50 offen lds
    s_waitcnt vmcnt(25)
    s_barrier
    s_waitcnt vmcnt(20)
    s_barrier
    s_mov_b32 s50, 768
    s_mov_b32 s51, 663552
    s_mov_b32 m0, 111616
    s_nop 0
    buffer_load_dwordx4 v8, s[16:19], s50 offen lds
    s_mov_b32 m0, 115712
    s_nop 0
    buffer_load_dwordx4 v9, s[16:19], s50 offen lds
    s_mov_b32 m0, 119808
    s_nop 0
    buffer_load_dwordx4 v10, s[16:19], s50 offen lds
    s_mov_b32 m0, 123904
    s_nop 0
    buffer_load_dwordx4 v11, s[20:23], s50 offen lds
    s_mov_b32 m0, 128000
    s_nop 0
    buffer_load_dwordx4 v12, s[20:23], s50 offen lds
    s_waitcnt vmcnt(20)
    s_barrier
    s_mov_b32 s50, 896
    s_mov_b32 s51, 774144
    s_mov_b32 m0, 1024
    s_nop 0
    buffer_load_dwordx4 v8, s[16:19], s50 offen lds
    s_mov_b32 m0, 5120
    s_nop 0
    buffer_load_dwordx4 v9, s[16:19], s50 offen lds
    s_mov_b32 m0, 9216
    s_nop 0
    buffer_load_dwordx4 v10, s[16:19], s50 offen lds
    s_mov_b32 m0, 13312
    s_nop 0
    buffer_load_dwordx4 v11, s[20:23], s50 offen lds
    s_mov_b32 m0, 17408
    s_nop 0
    buffer_load_dwordx4 v12, s[20:23], s50 offen lds
    s_waitcnt vmcnt(20)
    s_barrier
    s_mov_b32 s50, 1024
    s_mov_b32 s51, 884736
    s_mov_b32 m0, 19456
    s_nop 0
    buffer_load_dwordx4 v8, s[16:19], s50 offen lds
    s_mov_b32 m0, 23552
    s_nop 0
    buffer_load_dwordx4 v9, s[16:19], s50 offen lds
    s_mov_b32 m0, 27648
    s_nop 0
    buffer_load_dwordx4 v10, s[16:19], s50 offen lds
    s_mov_b32 m0, 31744
    s_nop 0
    buffer_load_dwordx4 v11, s[20:23], s50 offen lds
    s_mov_b32 m0, 35840
    s_nop 0
    buffer_load_dwordx4 v12, s[20:23], s50 offen lds
    s_waitcnt vmcnt(20)
    s_barrier
    s_mov_b32 s50, 1152
    s_mov_b32 s51, 995328
    s_mov_b32 m0, 37888
    s_nop 0
    buffer_load_dwordx4 v8, s[16:19], s50 offen lds
    s_mov_b32 m0, 41984
    s_nop 0
    buffer_load_dwordx4 v9, s[16:19], s50 offen lds
    s_mov_b32 m0, 46080
    s_nop 0
    buffer_load_dwordx4 v10, s[16:19], s50 offen lds
    s_mov_b32 m0, 50176
    s_nop 0
    buffer_load_dwordx4 v11, s[20:23], s50 offen lds
    s_mov_b32 m0, 54272
    s_nop 0
    buffer_load_dwordx4 v12, s[20:23], s50 offen lds
    s_waitcnt vmcnt(20)
    s_barrier
    s_mov_b32 s50, 1280
    s_mov_b32 s51, 1105920
    s_mov_b32 m0, 56320
    s_nop 0
    buffer_load_dwordx4 v8, s[16:19], s50 offen lds
    s_mov_b32 m0, 60416
    s_nop 0
    buffer_load_dwordx4 v9, s[16:19], s50 offen lds
    s_mov_b32 m0, 64512
    s_nop 0
    buffer_load_dwordx4 v10, s[16:19], s50 offen lds
    s_mov_b32 m0, 68608
    s_nop 0
    buffer_load_dwordx4 v11, s[20:23], s50 offen lds
    s_mov_b32 m0, 72704
    s_nop 0
    buffer_load_dwordx4 v12, s[20:23], s50 offen lds
    s_waitcnt vmcnt(20)
    s_barrier
    s_mov_b32 s50, 1408
    s_mov_b32 s51, 1216512
    s_mov_b32 m0, 74752
    s_nop 0
    buffer_load_dwordx4 v8, s[16:19], s50 offen lds
    s_mov_b32 m0, 78848
    s_nop 0
    buffer_load_dwordx4 v9, s[16:19], s50 offen lds
    s_mov_b32 m0, 82944
    s_nop 0
    buffer_load_dwordx4 v10, s[16:19], s50 offen lds
    s_mov_b32 m0, 87040
    s_nop 0
    buffer_load_dwordx4 v11, s[20:23], s50 offen lds
    s_mov_b32 m0, 91136
    s_nop 0
    buffer_load_dwordx4 v12, s[20:23], s50 offen lds
    s_waitcnt vmcnt(20)
    s_barrier
    s_mov_b32 s50, 1536
    s_mov_b32 s51, 1327104
    s_mov_b32 m0, 93184
    s_nop 0
    buffer_load_dwordx4 v8, s[16:19], s50 offen lds
    s_mov_b32 m0, 97280
    s_nop 0
    buffer_load_dwordx4 v9, s[16:19], s50 offen lds
    s_mov_b32 m0, 101376
    s_nop 0
    buffer_load_dwordx4 v10, s[16:19], s50 offen lds
    s_mov_b32 m0, 105472
    s_nop 0
    buffer_load_dwordx4 v11, s[20:23], s50 offen lds
    s_mov_b32 m0, 109568
    s_nop 0
    buffer_load_dwordx4 v12, s[20:23], s50 offen lds
    s_waitcnt vmcnt(20)
    s_barrier
    s_mov_b32 s50, 1664
    s_mov_b32 s51, 1437696
    s_mov_b32 m0, 111616
    s_nop 0
    buffer_load_dwordx4 v8, s[16:19], s50 offen lds
    s_mov_b32 m0, 115712
    s_nop 0
    buffer_load_dwordx4 v9, s[16:19], s50 offen lds
    s_mov_b32 m0, 119808
    s_nop 0
    buffer_load_dwordx4 v10, s[16:19], s50 offen lds
    s_mov_b32 m0, 123904
    s_nop 0
    buffer_load_dwordx4 v11, s[20:23], s50 offen lds
    s_mov_b32 m0, 128000
    s_nop 0
    buffer_load_dwordx4 v12, s[20:23], s50 offen lds
    s_waitcnt vmcnt(20)
    s_barrier
    s_waitcnt vmcnt(15)
    s_barrier
    s_waitcnt vmcnt(10)
    s_barrier
    s_waitcnt vmcnt(5)
    s_barrier
    s_waitcnt vmcnt(0)
    s_barrier
    s_branch Lend_40
Lld_46:
    v_add_u32 v6, 0, v5
    v_and_b32 v6, 7, v6
    v_xor_b32 v6, v6, v4
    v_add_u32 v7, s42, v3
    v_add_u32 v7, 16, v7
    s_mov_b32 s47, 1728
    v_mul_lo_u32 v7, v7, s47
    v_lshl_add_u32 v8, v6, 4, v7
    v_add_u32 v6, 0, v5
    v_and_b32 v6, 7, v6
    v_xor_b32 v6, v6, v4
    v_add_u32 v7, s42, v3
    v_add_u32 v7, 48, v7
    s_mov_b32 s47, 1728
    v_mul_lo_u32 v7, v7, s47
    v_lshl_add_u32 v9, v6, 4, v7
    v_add_u32 v6, 0, v5
    v_and_b32 v6, 7, v6
    v_xor_b32 v6, v6, v4
    v_add_u32 v7, s43, v3
    s_mov_b32 s47, 1728
    v_mul_lo_u32 v7, v7, s47
    v_lshl_add_u32 v10, v6, 4, v7
    v_add_u32 v6, 0, v5
    v_and_b32 v6, 7, v6
    v_xor_b32 v6, v6, v4
    v_add_u32 v7, s43, v3
    v_add_u32 v7, 32, v7
    s_mov_b32 s47, 1728
    v_mul_lo_u32 v7, v7, s47
    v_lshl_add_u32 v11, v6, 4, v7
    s_mov_b32 s50, 0
    s_mov_b32 s51, 0
    s_mov_b32 m0, 2048
    s_nop 0
    buffer_load_dwordx4 v8, s[16:19], s50 offen lds
    s_mov_b32 m0, 6144
    s_nop 0
    buffer_load_dwordx4 v9, s[16:19], s50 offen lds
    s_mov_b32 m0, 10240
    s_nop 0
    buffer_load_dwordx4 v10, s[20:23], s50 offen lds
    s_mov_b32 m0, 14336
    s_nop 0
    buffer_load_dwordx4 v11, s[20:23], s50 offen lds
    s_mov_b32 s50, 128
    s_mov_b32 s51, 110592
    s_mov_b32 m0, 20480
    s_nop 0
    buffer_load_dwordx4 v8, s[16:19], s50 offen lds
    s_mov_b32 m0, 24576
    s_nop 0
    buffer_load_dwordx4 v9, s[16:19], s50 offen lds
    s_mov_b32 m0, 28672
    s_nop 0
    buffer_load_dwordx4 v10, s[20:23], s50 offen lds
    s_mov_b32 m0, 32768
    s_nop 0
    buffer_load_dwordx4 v11, s[20:23], s50 offen lds
    s_mov_b32 s50, 256
    s_mov_b32 s51, 221184
    s_mov_b32 m0, 38912
    s_nop 0
    buffer_load_dwordx4 v8, s[16:19], s50 offen lds
    s_mov_b32 m0, 43008
    s_nop 0
    buffer_load_dwordx4 v9, s[16:19], s50 offen lds
    s_mov_b32 m0, 47104
    s_nop 0
    buffer_load_dwordx4 v10, s[20:23], s50 offen lds
    s_mov_b32 m0, 51200
    s_nop 0
    buffer_load_dwordx4 v11, s[20:23], s50 offen lds
    s_mov_b32 s50, 384
    s_mov_b32 s51, 331776
    s_mov_b32 m0, 57344
    s_nop 0
    buffer_load_dwordx4 v8, s[16:19], s50 offen lds
    s_mov_b32 m0, 61440
    s_nop 0
    buffer_load_dwordx4 v9, s[16:19], s50 offen lds
    s_mov_b32 m0, 65536
    s_nop 0
    buffer_load_dwordx4 v10, s[20:23], s50 offen lds
    s_mov_b32 m0, 69632
    s_nop 0
    buffer_load_dwordx4 v11, s[20:23], s50 offen lds
    s_mov_b32 s50, 512
    s_mov_b32 s51, 442368
    s_mov_b32 m0, 75776
    s_nop 0
    buffer_load_dwordx4 v8, s[16:19], s50 offen lds
    s_mov_b32 m0, 79872
    s_nop 0
    buffer_load_dwordx4 v9, s[16:19], s50 offen lds
    s_mov_b32 m0, 83968
    s_nop 0
    buffer_load_dwordx4 v10, s[20:23], s50 offen lds
    s_mov_b32 m0, 88064
    s_nop 0
    buffer_load_dwordx4 v11, s[20:23], s50 offen lds
    s_mov_b32 s50, 640
    s_mov_b32 s51, 552960
    s_mov_b32 m0, 94208
    s_nop 0
    buffer_load_dwordx4 v8, s[16:19], s50 offen lds
    s_mov_b32 m0, 98304
    s_nop 0
    buffer_load_dwordx4 v9, s[16:19], s50 offen lds
    s_mov_b32 m0, 102400
    s_nop 0
    buffer_load_dwordx4 v10, s[20:23], s50 offen lds
    s_mov_b32 m0, 106496
    s_nop 0
    buffer_load_dwordx4 v11, s[20:23], s50 offen lds
    s_waitcnt vmcnt(20)
    s_barrier
    s_waitcnt vmcnt(16)
    s_barrier
    s_mov_b32 s50, 768
    s_mov_b32 s51, 663552
    s_mov_b32 m0, 112640
    s_nop 0
    buffer_load_dwordx4 v8, s[16:19], s50 offen lds
    s_mov_b32 m0, 116736
    s_nop 0
    buffer_load_dwordx4 v9, s[16:19], s50 offen lds
    s_mov_b32 m0, 120832
    s_nop 0
    buffer_load_dwordx4 v10, s[20:23], s50 offen lds
    s_mov_b32 m0, 124928
    s_nop 0
    buffer_load_dwordx4 v11, s[20:23], s50 offen lds
    s_waitcnt vmcnt(16)
    s_barrier
    s_mov_b32 s50, 896
    s_mov_b32 s51, 774144
    s_mov_b32 m0, 2048
    s_nop 0
    buffer_load_dwordx4 v8, s[16:19], s50 offen lds
    s_mov_b32 m0, 6144
    s_nop 0
    buffer_load_dwordx4 v9, s[16:19], s50 offen lds
    s_mov_b32 m0, 10240
    s_nop 0
    buffer_load_dwordx4 v10, s[20:23], s50 offen lds
    s_mov_b32 m0, 14336
    s_nop 0
    buffer_load_dwordx4 v11, s[20:23], s50 offen lds
    s_waitcnt vmcnt(16)
    s_barrier
    s_mov_b32 s50, 1024
    s_mov_b32 s51, 884736
    s_mov_b32 m0, 20480
    s_nop 0
    buffer_load_dwordx4 v8, s[16:19], s50 offen lds
    s_mov_b32 m0, 24576
    s_nop 0
    buffer_load_dwordx4 v9, s[16:19], s50 offen lds
    s_mov_b32 m0, 28672
    s_nop 0
    buffer_load_dwordx4 v10, s[20:23], s50 offen lds
    s_mov_b32 m0, 32768
    s_nop 0
    buffer_load_dwordx4 v11, s[20:23], s50 offen lds
    s_waitcnt vmcnt(16)
    s_barrier
    s_mov_b32 s50, 1152
    s_mov_b32 s51, 995328
    s_mov_b32 m0, 38912
    s_nop 0
    buffer_load_dwordx4 v8, s[16:19], s50 offen lds
    s_mov_b32 m0, 43008
    s_nop 0
    buffer_load_dwordx4 v9, s[16:19], s50 offen lds
    s_mov_b32 m0, 47104
    s_nop 0
    buffer_load_dwordx4 v10, s[20:23], s50 offen lds
    s_mov_b32 m0, 51200
    s_nop 0
    buffer_load_dwordx4 v11, s[20:23], s50 offen lds
    s_waitcnt vmcnt(16)
    s_barrier
    s_mov_b32 s50, 1280
    s_mov_b32 s51, 1105920
    s_mov_b32 m0, 57344
    s_nop 0
    buffer_load_dwordx4 v8, s[16:19], s50 offen lds
    s_mov_b32 m0, 61440
    s_nop 0
    buffer_load_dwordx4 v9, s[16:19], s50 offen lds
    s_mov_b32 m0, 65536
    s_nop 0
    buffer_load_dwordx4 v10, s[20:23], s50 offen lds
    s_mov_b32 m0, 69632
    s_nop 0
    buffer_load_dwordx4 v11, s[20:23], s50 offen lds
    s_waitcnt vmcnt(16)
    s_barrier
    s_mov_b32 s50, 1408
    s_mov_b32 s51, 1216512
    s_mov_b32 m0, 75776
    s_nop 0
    buffer_load_dwordx4 v8, s[16:19], s50 offen lds
    s_mov_b32 m0, 79872
    s_nop 0
    buffer_load_dwordx4 v9, s[16:19], s50 offen lds
    s_mov_b32 m0, 83968
    s_nop 0
    buffer_load_dwordx4 v10, s[20:23], s50 offen lds
    s_mov_b32 m0, 88064
    s_nop 0
    buffer_load_dwordx4 v11, s[20:23], s50 offen lds
    s_waitcnt vmcnt(16)
    s_barrier
    s_mov_b32 s50, 1536
    s_mov_b32 s51, 1327104
    s_mov_b32 m0, 94208
    s_nop 0
    buffer_load_dwordx4 v8, s[16:19], s50 offen lds
    s_mov_b32 m0, 98304
    s_nop 0
    buffer_load_dwordx4 v9, s[16:19], s50 offen lds
    s_mov_b32 m0, 102400
    s_nop 0
    buffer_load_dwordx4 v10, s[20:23], s50 offen lds
    s_mov_b32 m0, 106496
    s_nop 0
    buffer_load_dwordx4 v11, s[20:23], s50 offen lds
    s_waitcnt vmcnt(16)
    s_barrier
    s_mov_b32 s50, 1664
    s_mov_b32 s51, 1437696
    s_mov_b32 m0, 112640
    s_nop 0
    buffer_load_dwordx4 v8, s[16:19], s50 offen lds
    s_mov_b32 m0, 116736
    s_nop 0
    buffer_load_dwordx4 v9, s[16:19], s50 offen lds
    s_mov_b32 m0, 120832
    s_nop 0
    buffer_load_dwordx4 v10, s[20:23], s50 offen lds
    s_mov_b32 m0, 124928
    s_nop 0
    buffer_load_dwordx4 v11, s[20:23], s50 offen lds
    s_waitcnt vmcnt(16)
    s_barrier
    s_waitcnt vmcnt(12)
    s_barrier
    s_waitcnt vmcnt(8)
    s_barrier
    s_waitcnt vmcnt(4)
    s_barrier
    s_waitcnt vmcnt(0)
    s_barrier
    s_branch Lend_40
Lld_47:
    v_add_u32 v6, 4, v5
    v_and_b32 v6, 7, v6
    v_xor_b32 v6, v6, v4
    v_add_u32 v7, s42, v3
    v_add_u32 v7, 24, v7
    s_mov_b32 s47, 1728
    v_mul_lo_u32 v7, v7, s47
    v_lshl_add_u32 v8, v6, 4, v7
    v_add_u32 v6, 4, v5
    v_and_b32 v6, 7, v6
    v_xor_b32 v6, v6, v4
    v_add_u32 v7, s42, v3
    v_add_u32 v7, 56, v7
    s_mov_b32 s47, 1728
    v_mul_lo_u32 v7, v7, s47
    v_lshl_add_u32 v9, v6, 4, v7
    v_add_u32 v6, 4, v5
    v_and_b32 v6, 7, v6
    v_xor_b32 v6, v6, v4
    v_add_u32 v7, s43, v3
    v_add_u32 v7, 8, v7
    s_mov_b32 s47, 1728
    v_mul_lo_u32 v7, v7, s47
    v_lshl_add_u32 v10, v6, 4, v7
    v_add_u32 v6, 4, v5
    v_and_b32 v6, 7, v6
    v_xor_b32 v6, v6, v4
    v_add_u32 v7, s43, v3
    v_add_u32 v7, 40, v7
    s_mov_b32 s47, 1728
    v_mul_lo_u32 v7, v7, s47
    v_lshl_add_u32 v11, v6, 4, v7
    s_mov_b32 s50, 0
    s_mov_b32 s51, 0
    s_mov_b32 m0, 3072
    s_nop 0
    buffer_load_dwordx4 v8, s[16:19], s50 offen lds
    s_mov_b32 m0, 7168
    s_nop 0
    buffer_load_dwordx4 v9, s[16:19], s50 offen lds
    s_mov_b32 m0, 11264
    s_nop 0
    buffer_load_dwordx4 v10, s[20:23], s50 offen lds
    s_mov_b32 m0, 15360
    s_nop 0
    buffer_load_dwordx4 v11, s[20:23], s50 offen lds
    s_mov_b32 s50, 128
    s_mov_b32 s51, 110592
    s_mov_b32 m0, 21504
    s_nop 0
    buffer_load_dwordx4 v8, s[16:19], s50 offen lds
    s_mov_b32 m0, 25600
    s_nop 0
    buffer_load_dwordx4 v9, s[16:19], s50 offen lds
    s_mov_b32 m0, 29696
    s_nop 0
    buffer_load_dwordx4 v10, s[20:23], s50 offen lds
    s_mov_b32 m0, 33792
    s_nop 0
    buffer_load_dwordx4 v11, s[20:23], s50 offen lds
    s_mov_b32 s50, 256
    s_mov_b32 s51, 221184
    s_mov_b32 m0, 39936
    s_nop 0
    buffer_load_dwordx4 v8, s[16:19], s50 offen lds
    s_mov_b32 m0, 44032
    s_nop 0
    buffer_load_dwordx4 v9, s[16:19], s50 offen lds
    s_mov_b32 m0, 48128
    s_nop 0
    buffer_load_dwordx4 v10, s[20:23], s50 offen lds
    s_mov_b32 m0, 52224
    s_nop 0
    buffer_load_dwordx4 v11, s[20:23], s50 offen lds
    s_mov_b32 s50, 384
    s_mov_b32 s51, 331776
    s_mov_b32 m0, 58368
    s_nop 0
    buffer_load_dwordx4 v8, s[16:19], s50 offen lds
    s_mov_b32 m0, 62464
    s_nop 0
    buffer_load_dwordx4 v9, s[16:19], s50 offen lds
    s_mov_b32 m0, 66560
    s_nop 0
    buffer_load_dwordx4 v10, s[20:23], s50 offen lds
    s_mov_b32 m0, 70656
    s_nop 0
    buffer_load_dwordx4 v11, s[20:23], s50 offen lds
    s_mov_b32 s50, 512
    s_mov_b32 s51, 442368
    s_mov_b32 m0, 76800
    s_nop 0
    buffer_load_dwordx4 v8, s[16:19], s50 offen lds
    s_mov_b32 m0, 80896
    s_nop 0
    buffer_load_dwordx4 v9, s[16:19], s50 offen lds
    s_mov_b32 m0, 84992
    s_nop 0
    buffer_load_dwordx4 v10, s[20:23], s50 offen lds
    s_mov_b32 m0, 89088
    s_nop 0
    buffer_load_dwordx4 v11, s[20:23], s50 offen lds
    s_mov_b32 s50, 640
    s_mov_b32 s51, 552960
    s_mov_b32 m0, 95232
    s_nop 0
    buffer_load_dwordx4 v8, s[16:19], s50 offen lds
    s_mov_b32 m0, 99328
    s_nop 0
    buffer_load_dwordx4 v9, s[16:19], s50 offen lds
    s_mov_b32 m0, 103424
    s_nop 0
    buffer_load_dwordx4 v10, s[20:23], s50 offen lds
    s_mov_b32 m0, 107520
    s_nop 0
    buffer_load_dwordx4 v11, s[20:23], s50 offen lds
    s_waitcnt vmcnt(20)
    s_barrier
    s_waitcnt vmcnt(16)
    s_barrier
    s_mov_b32 s50, 768
    s_mov_b32 s51, 663552
    s_mov_b32 m0, 113664
    s_nop 0
    buffer_load_dwordx4 v8, s[16:19], s50 offen lds
    s_mov_b32 m0, 117760
    s_nop 0
    buffer_load_dwordx4 v9, s[16:19], s50 offen lds
    s_mov_b32 m0, 121856
    s_nop 0
    buffer_load_dwordx4 v10, s[20:23], s50 offen lds
    s_mov_b32 m0, 125952
    s_nop 0
    buffer_load_dwordx4 v11, s[20:23], s50 offen lds
    s_waitcnt vmcnt(16)
    s_barrier
    s_mov_b32 s50, 896
    s_mov_b32 s51, 774144
    s_mov_b32 m0, 3072
    s_nop 0
    buffer_load_dwordx4 v8, s[16:19], s50 offen lds
    s_mov_b32 m0, 7168
    s_nop 0
    buffer_load_dwordx4 v9, s[16:19], s50 offen lds
    s_mov_b32 m0, 11264
    s_nop 0
    buffer_load_dwordx4 v10, s[20:23], s50 offen lds
    s_mov_b32 m0, 15360
    s_nop 0
    buffer_load_dwordx4 v11, s[20:23], s50 offen lds
    s_waitcnt vmcnt(16)
    s_barrier
    s_mov_b32 s50, 1024
    s_mov_b32 s51, 884736
    s_mov_b32 m0, 21504
    s_nop 0
    buffer_load_dwordx4 v8, s[16:19], s50 offen lds
    s_mov_b32 m0, 25600
    s_nop 0
    buffer_load_dwordx4 v9, s[16:19], s50 offen lds
    s_mov_b32 m0, 29696
    s_nop 0
    buffer_load_dwordx4 v10, s[20:23], s50 offen lds
    s_mov_b32 m0, 33792
    s_nop 0
    buffer_load_dwordx4 v11, s[20:23], s50 offen lds
    s_waitcnt vmcnt(16)
    s_barrier
    s_mov_b32 s50, 1152
    s_mov_b32 s51, 995328
    s_mov_b32 m0, 39936
    s_nop 0
    buffer_load_dwordx4 v8, s[16:19], s50 offen lds
    s_mov_b32 m0, 44032
    s_nop 0
    buffer_load_dwordx4 v9, s[16:19], s50 offen lds
    s_mov_b32 m0, 48128
    s_nop 0
    buffer_load_dwordx4 v10, s[20:23], s50 offen lds
    s_mov_b32 m0, 52224
    s_nop 0
    buffer_load_dwordx4 v11, s[20:23], s50 offen lds
    s_waitcnt vmcnt(16)
    s_barrier
    s_mov_b32 s50, 1280
    s_mov_b32 s51, 1105920
    s_mov_b32 m0, 58368
    s_nop 0
    buffer_load_dwordx4 v8, s[16:19], s50 offen lds
    s_mov_b32 m0, 62464
    s_nop 0
    buffer_load_dwordx4 v9, s[16:19], s50 offen lds
    s_mov_b32 m0, 66560
    s_nop 0
    buffer_load_dwordx4 v10, s[20:23], s50 offen lds
    s_mov_b32 m0, 70656
    s_nop 0
    buffer_load_dwordx4 v11, s[20:23], s50 offen lds
    s_waitcnt vmcnt(16)
    s_barrier
    s_mov_b32 s50, 1408
    s_mov_b32 s51, 1216512
    s_mov_b32 m0, 76800
    s_nop 0
    buffer_load_dwordx4 v8, s[16:19], s50 offen lds
    s_mov_b32 m0, 80896
    s_nop 0
    buffer_load_dwordx4 v9, s[16:19], s50 offen lds
    s_mov_b32 m0, 84992
    s_nop 0
    buffer_load_dwordx4 v10, s[20:23], s50 offen lds
    s_mov_b32 m0, 89088
    s_nop 0
    buffer_load_dwordx4 v11, s[20:23], s50 offen lds
    s_waitcnt vmcnt(16)
    s_barrier
    s_mov_b32 s50, 1536
    s_mov_b32 s51, 1327104
    s_mov_b32 m0, 95232
    s_nop 0
    buffer_load_dwordx4 v8, s[16:19], s50 offen lds
    s_mov_b32 m0, 99328
    s_nop 0
    buffer_load_dwordx4 v9, s[16:19], s50 offen lds
    s_mov_b32 m0, 103424
    s_nop 0
    buffer_load_dwordx4 v10, s[20:23], s50 offen lds
    s_mov_b32 m0, 107520
    s_nop 0
    buffer_load_dwordx4 v11, s[20:23], s50 offen lds
    s_waitcnt vmcnt(16)
    s_barrier
    s_mov_b32 s50, 1664
    s_mov_b32 s51, 1437696
    s_mov_b32 m0, 113664
    s_nop 0
    buffer_load_dwordx4 v8, s[16:19], s50 offen lds
    s_mov_b32 m0, 117760
    s_nop 0
    buffer_load_dwordx4 v9, s[16:19], s50 offen lds
    s_mov_b32 m0, 121856
    s_nop 0
    buffer_load_dwordx4 v10, s[20:23], s50 offen lds
    s_mov_b32 m0, 125952
    s_nop 0
    buffer_load_dwordx4 v11, s[20:23], s50 offen lds
    s_waitcnt vmcnt(16)
    s_barrier
    s_waitcnt vmcnt(12)
    s_barrier
    s_waitcnt vmcnt(8)
    s_barrier
    s_waitcnt vmcnt(4)
    s_barrier
    s_waitcnt vmcnt(0)
    s_barrier
    s_branch Lend_40
Lpf_43:
Lend_40:
    s_endpgm
.section .rodata,"a"
.p2align 6
.amdhsa_kernel prepa_kernel
  .amdhsa_next_free_vgpr 144
  .amdhsa_next_free_sgpr 40
  .amdhsa_accum_offset 144
  .amdhsa_group_segment_fixed_size 0
  .amdhsa_kernarg_size 112
  .amdhsa_user_sgpr_count 2
  .amdhsa_user_sgpr_kernarg_segment_ptr 1
  .amdhsa_system_sgpr_workgroup_id_x 1
.end_amdhsa_kernel
.p2align 6
.amdhsa_kernel conv_kernel
  .amdhsa_next_free_vgpr 176
  .amdhsa_next_free_sgpr 102
  .amdhsa_accum_offset 176
  .amdhsa_group_segment_fixed_size 0
  .amdhsa_kernarg_size 112
  .amdhsa_user_sgpr_count 2
  .amdhsa_user_sgpr_kernarg_segment_ptr 1
  .amdhsa_system_sgpr_workgroup_id_x 1
.end_amdhsa_kernel
.p2align 6
.amdhsa_kernel e1_kernel
  .amdhsa_next_free_vgpr 64
  .amdhsa_next_free_sgpr 40
  .amdhsa_accum_offset 64
  .amdhsa_group_segment_fixed_size 0
  .amdhsa_kernarg_size 112
  .amdhsa_user_sgpr_count 2
  .amdhsa_user_sgpr_kernarg_segment_ptr 1
  .amdhsa_system_sgpr_workgroup_id_x 1
.end_amdhsa_kernel
.p2align 6
.amdhsa_kernel e2_kernel
  .amdhsa_next_free_vgpr 64
  .amdhsa_next_free_sgpr 40
  .amdhsa_accum_offset 64
  .amdhsa_group_segment_fixed_size 0
  .amdhsa_kernarg_size 112
  .amdhsa_user_sgpr_count 2
  .amdhsa_user_sgpr_kernarg_segment_ptr 1
  .amdhsa_system_sgpr_workgroup_id_x 1
.end_amdhsa_kernel
.p2align 6
.amdhsa_kernel g1_kernel
  .amdhsa_next_free_vgpr 152
  .amdhsa_next_free_sgpr 96
  .amdhsa_accum_offset 152
  .amdhsa_group_segment_fixed_size 0
  .amdhsa_kernarg_size 112
  .amdhsa_user_sgpr_count 2
  .amdhsa_user_sgpr_kernarg_segment_ptr 1
  .amdhsa_system_sgpr_workgroup_id_x 1
.end_amdhsa_kernel
.p2align 6
.amdhsa_kernel ln2_kernel
  .amdhsa_next_free_vgpr 96
  .amdhsa_next_free_sgpr 40
  .amdhsa_accum_offset 96
  .amdhsa_group_segment_fixed_size 0
  .amdhsa_kernarg_size 112
  .amdhsa_user_sgpr_count 2
  .amdhsa_user_sgpr_kernarg_segment_ptr 1
  .amdhsa_system_sgpr_workgroup_id_x 1
.end_amdhsa_kernel
.p2align 6
.amdhsa_kernel g2_kernel
  .amdhsa_next_free_vgpr 136
  .amdhsa_next_free_sgpr 96
  .amdhsa_accum_offset 136
  .amdhsa_group_segment_fixed_size 0
  .amdhsa_kernarg_size 112
  .amdhsa_user_sgpr_count 2
  .amdhsa_user_sgpr_kernarg_segment_ptr 1
  .amdhsa_system_sgpr_workgroup_id_x 1
.end_amdhsa_kernel
.p2align 6
.amdhsa_kernel g3a_kernel
  .amdhsa_next_free_vgpr 104
  .amdhsa_next_free_sgpr 96
  .amdhsa_accum_offset 104
  .amdhsa_group_segment_fixed_size 0
  .amdhsa_kernarg_size 112
  .amdhsa_user_sgpr_count 2
  .amdhsa_user_sgpr_kernarg_segment_ptr 1
  .amdhsa_system_sgpr_workgroup_id_x 1
.end_amdhsa_kernel
.p2align 6
.amdhsa_kernel g3b_kernel
  .amdhsa_next_free_vgpr 104
  .amdhsa_next_free_sgpr 96
  .amdhsa_accum_offset 104
  .amdhsa_group_segment_fixed_size 0
  .amdhsa_kernarg_size 112
  .amdhsa_user_sgpr_count 2
  .amdhsa_user_sgpr_kernarg_segment_ptr 1
  .amdhsa_system_sgpr_workgroup_id_x 1
.end_amdhsa_kernel
```
